```python
import torch

def _softmax(x, axis=-1):
    return torch.softmax(x, dim=axis)
def _gelu(x):
    return torch.nn.functional.gelu(x, approximate="tanh")
def _silu(x):
    return torch.nn.functional.silu(x)
def _sigmoid(x):
    return torch.sigmoid(x)
def _layernorm(x, axis=-1, eps=1e-5):
    m = x.mean(dim=axis, keepdim=True)
    v = x.var(dim=axis, keepdim=True, unbiased=False)
    return (x - m) / torch.sqrt(v + eps)
def _scatter_add(tgt, idx, src, axis=0):
    return tgt.clone().index_add_(axis, idx, src)
def _segment_sum(src, seg, n):
    out = torch.zeros((n,) + src.shape[1:], dtype=src.dtype)
    return out.index_add_(0, seg, src)
def _pad(x, pw):
    flat = tuple(v for pair in reversed(pw) for v in pair)
    return torch.nn.functional.pad(x, flat)

kernel_name = 'parallel_sum__sliding_local_dilated__dense_activation_gelu__prompt'

def setup_inputs():

    _w = (lambda a: (lambda t: t.to(torch.bfloat16) if t.is_floating_point() else t)(torch.as_tensor(a)))
    def _A_setup():
        B, S, D = 1, 2048, 512
        return {
            "x": _w((lambda *s: torch.randn(*s, dtype=torch.bfloat16) * 0.05)(B, S, D)),
            "wqkv": _w((lambda *s: torch.randn(*s, dtype=torch.bfloat16) * 0.05)(D, 3 * D)),
            "wo": _w((lambda *s: torch.randn(*s, dtype=torch.bfloat16) * 0.05)(D, D)),
        }
    _A_in = _A_setup()

    def _B_setup():
        B, S, D, F = 1, 2048, 512, 1376
        return {
            "x": _w((lambda *s: torch.randn(*s, dtype=torch.bfloat16) * 0.05)(B, S, D)),
            "w1": _w((lambda *s: torch.randn(*s, dtype=torch.bfloat16) * 0.8)(D, F) * (D ** -0.5)),
            "b1": _w((lambda *s: torch.randn(*s, dtype=torch.bfloat16) * 0.8)(F) * 0.01),
            "w2": _w((lambda *s: torch.randn(*s, dtype=torch.bfloat16) * 0.8)(F, D) * (F ** -0.5)),
            "b2": _w((lambda *s: torch.randn(*s, dtype=torch.bfloat16) * 0.8)(D) * 0.01),
        }
    _B_in = _B_setup()

    return {
        "A_x": _A_in["x"],
        "A_wqkv": _A_in["wqkv"],
        "A_wo": _A_in["wo"],
        "B_x": _B_in["x"],
        "B_w1": _B_in["w1"],
        "B_b1": _B_in["b1"],
        "B_w2": _B_in["w2"],
        "B_b2": _B_in["b2"],
    }

def reference(A_x, A_wqkv, A_wo, B_x, B_w1, B_b1, B_w2, B_b2):
    def _A_ref(x, wqkv, wo):
        B, S, D = x.shape
        H = 32; Dh = D // H
        W, dil = 8, 2
        qkv = (lambda x, *d: x.permute(*d))((x @ wqkv).reshape(B, S, 3, H, Dh), 2, 0, 3, 1, 4)
        q, k, v = qkv[0], qkv[1], qkv[2]
        scale = Dh ** -0.5
        pos = torch.arange(S)
        off = torch.arange(W) * dil
        idx = pos[:, None] - off[None, :]
        mask = idx >= 0
        idx_c = torch.where(mask, idx, 0).reshape(-1)
        kg = k[:, :, idx_c, :].reshape(B, H, S, W, Dh)
        vg = v[:, :, idx_c, :].reshape(B, H, S, W, Dh)
        logits = torch.einsum("bhsd,bhswd->bhsw", q, kg) * scale
        logits = torch.where(mask[None, None, :, :], logits, -1e9)
        attn = _softmax(logits, axis=-1)
        o = torch.einsum("bhsw,bhswd->bhsd", attn, vg)
        return (lambda x, *d: x.permute(*d))(o, 0, 2, 1, 3).reshape(B, S, D) @ wo

    def _B_ref(x, w1, b1, w2, b2):
        h = torch.einsum("bsd,df->bsf", x, w1) + b1
        h = _gelu(h)
        return torch.einsum("bsf,fd->bsd", h, w2) + b2

    x = A_x
    xn = _layernorm(x, axis=-1)
    return x + _A_ref(xn, A_wqkv, A_wo) + _B_ref(xn, B_w1, B_b1, B_w2, B_b2)
```

```asm
; @launch grid=(256,1,1) block=(256,1,1) lds=163840
.amdgcn_target "amdgcn-amd-amdhsa--gfx950"
.text
.globl parallel_sum__sliding_local_dilated__dense_activation_gelu__prompt_kernel
.p2align 8
.type parallel_sum__sliding_local_dilated__dense_activation_gelu__prompt_kernel,@function
parallel_sum__sliding_local_dilated__dense_activation_gelu__prompt_kernel:
  s_load_dwordx16 s[4:19], s[0:1], 0
  s_load_dwordx4 s[20:23], s[0:1], 64
  s_load_dwordx2 s[24:25], s[0:1], 80
  s_cmp_ge_u32 s2, 256
  s_cbranch_scc1 L_end
  v_lshrrev_b32 v1, 6, v0
  v_and_b32 v2, 63, v0
  s_lshr_b32 s70, s2, 3
  s_getpc_b64 s[84:85]
L_pc:
  s_lshl_b32 s71, s70, 8
  v_lshlrev_b32 v3, 6, v1
  v_lshl_add_u32 v3, v2, 13, v3
  s_mov_b32 s86, L_end-L_pc
  s_mov_b32 s87, 0x20000
  buffer_load_dword v206, v3, s[84:87], s71 offen
  s_and_b32 s71, s2, 1
  s_lshl_b32 s71, s71, 3
  v_readfirstlane_b32 s26, v1
  s_and_b32 s72, s70, 7
  s_add_u32 s27, s71, s72
  s_and_b32 s58, s2, 6
  s_bfe_u32 s74, s2, 0x10006
  s_add_u32 s58, s58, s74
  v_lshrrev_b32 v3, 3, v2
  v_lshrrev_b32 v164, 4, v2
  v_and_b32 v5, 7, v2
  v_xor_b32 v6, v164, v5
  v_lshlrev_b32 v6, 4, v6
  v_lshl_add_u32 v6, v3, 11, v6
  s_and_b32 s74, s27, 1
  s_lshl_b32 s74, s74, 10
  v_add_u32 v6, s74, v6
  v_lshl_add_u32 v128, v1, 15, v6
  v_xor_b32 v7, 64, v128
  v_add_u32 v129, 15360, v7
  s_lshr_b32 s75, s27, 1
  s_lshl_b32 s76, s75, 18
  s_add_u32 s59, s76, s74
  s_lshr_b32 s77, s2, 6
  s_lshl_b32 s77, s77, 1
  s_add_u32 s77, s77, s27
  s_bfe_u32 s72, s2, 0x10001
  s_add_u32 s77, s77, s72
  s_and_b32 s77, s77, 6
  s_lshl_b32 s72, s77, 7
  s_add_u32 s60, s76, s72
  s_lshl_b32 s67, s26, 11
  s_add_u32 s66, s67, 24576
  s_mov_b32 s35, 0x20000
  v_lshl_add_u32 v8, v1, 4, v3
  v_and_b32 v9, 1, v164
  v_lshlrev_b32 v9, 1, v9
  v_xor_b32 v9, v9, v5
  v_lshlrev_b32 v10, 4, v9
  v_xor_b32 v9, 64, v10
  s_mov_b32 s30, 0x200000
  s_mov_b32 s31, 0x20000
  s_bitcmp1_b32 s2, 7
  s_movk_i32 s78, 3072
  s_cmov_b32 s78, 2752
  s_movk_i32 s79, 1024
  s_cmov_b32 s79, 128
  s_movk_i32 s73, 128
  s_cmov_b32 s73, 384
  s_mul_i32 s73, s58, s73
  v_mul_u32_u24 v8, s78, v8
  s_lshl_b32 s80, s78, 3
  s_sub_u32 s80, s80, 1024
  v_add_u32 v132, v8, v10
  v_add_u32 v9, s80, v9
  s_lshl_b32 s80, s78, 9
  s_sub_u32 s34, s80, s73
  v_add_u32 v133, v8, v9
  s_lshl_b32 s80, s78, 6
  s_mul_i32 s63, s77, s80
  v_add_u32 v80, s79, v132
  v_add_u32 v81, s79, v133
  v_lshl_add_u32 v82, s79, 1, v132
  v_lshl_add_u32 v83, s79, 1, v133
  s_bitcmp1_b32 s2, 7
  s_waitcnt lgkmcnt(0)
  s_cselect_b64 s[32:33], s[12:13], s[6:7]
  s_mov_b64 s[28:29], s[4:5]
  s_add_u32 s32, s32, s73
  s_addc_u32 s33, s33, 0
  s_add_u32 m0, s67, 0
  s_nop 0
  buffer_load_dwordx4 v132, s[32:35], s63 offen offset:0 lds
  buffer_load_dwordx4 v133, s[32:35], s63 offen offset:1024 lds
  s_add_u32 m0, s66, 0
  s_nop 0
  buffer_load_dwordx4 v128, s[28:31], s60 offen offset:0 lds
  buffer_load_dwordx4 v129, s[28:31], s60 offen offset:1024 lds
  s_add_u32 m0, s67, 8192
  s_nop 0
  buffer_load_dwordx4 v80, s[32:35], s63 offen offset:0 lds
  buffer_load_dwordx4 v81, s[32:35], s63 offen offset:1024 lds
  s_add_u32 m0, s67, 16384
  s_nop 0
  buffer_load_dwordx4 v82, s[32:35], s63 offen offset:0 lds
  buffer_load_dwordx4 v83, s[32:35], s63 offen offset:1024 lds
  s_bitcmp1_b32 s2, 7
  s_cbranch_scc1 L_ffn
  s_mov_b32 s61, -16384
  s_cmp_eq_u32 s75, 0
  s_cmov_b32 s61, 1073741824
  s_lshl_b32 s68, s26, 8
  s_add_u32 s68, s68, 132096
  v_lshrrev_b32 v8, 5, v2
  v_lshl_add_u32 v8, v1, 1, v8
  v_bfe_u32 v9, v2, 2, 3
  v_xor_b32 v9, v9, v1
  v_xor_b32 v9, 4, v9
  v_and_b32 v11, 3, v2
  v_lshl_add_u32 v9, v9, 2, v11
  v_lshlrev_b32 v9, 2, v9
  v_lshl_add_u32 v131, v8, 11, v9
  v_add_u32 v131, s74, v131
  s_mov_b32 s3, s58
  s_add_u32 m0, s68, 0
  s_add_u32 s64, s60, s61
  buffer_load_dword v131, s[28:31], s64 offen lds
  s_and_b32 s74, s2, 1
  s_lshl_b32 s74, s74, 7
  s_bfe_u32 s75, s2, 0x20001
  s_lshl_b32 s75, s75, 5
  s_add_u32 s74, s74, s75
  s_add_u32 s74, s74, s70
  s_cmp_eq_u32 s26, 3
  s_cselect_b32 s82, s16, s8
  s_cselect_b32 s83, s17, s9
  s_cselect_b32 s75, 43, 16
  s_mul_i32 s72, s74, s75
  s_sub_u32 s75, s75, 1
  v_min_u32 v12, s75, v2
  v_add_lshl_u32 v221, v12, s72, 7
  s_bfe_u32 s4, s2, 0x20001
  s_lshl_b32 s4, s4, 2
  s_and_b32 s5, s2, 1
  s_xor_b32 s5, s5, 1
  s_lshl_b32 s5, s5, 4
  s_add_u32 s4, s4, s5
  s_and_b32 s5, s70, 3
  s_add_u32 s6, s4, s5
  s_lshr_b32 s7, s70, 2
  s_xor_b32 s7, s7, 2
  s_lshl_b32 s72, s7, 7
  s_mul_i32 s12, s26, 491520
  s_add_u32 s12, s12, s72
  s_sub_u32 s13, s12, 524288
  s_cmp_lt_u32 s26, 2
  s_cselect_b32 s44, s8, s16
  s_cselect_b32 s45, s9, s17
  s_cselect_b32 s75, s12, s13
  s_mov_b32 s76, 1409024
  s_cmov_b32 s76, 524288
  s_add_u32 m0, s67, 32768
  s_add_u32 s63, s63, 196608
  s_sub_u32 s65, s63, 1572864
  s_min_u32 s63, s63, s65
  buffer_load_dwordx4 v132, s[32:35], s63 offen offset:0 lds
  s_add_u32 s44, s44, s75
  s_addc_u32 s45, s45, 0
  s_sub_u32 s46, s76, s75
  s_mov_b32 s47, 0x20000
  s_add_u32 s12, s12, 32768
  s_add_u32 s13, s13, 32768
  s_cmp_lt_u32 s26, 1
  s_cselect_b32 s48, s8, s16
  s_cselect_b32 s49, s9, s17
  s_cselect_b32 s75, s12, s13
  s_mov_b32 s76, 1409024
  s_cmov_b32 s76, 524288
  s_add_u32 s48, s48, s75
  s_addc_u32 s49, s49, 0
  s_sub_u32 s50, s76, s75
  s_mov_b32 s51, 0x20000
  s_mov_b32 s12, s18
  s_mov_b32 s13, s19
  s_mov_b32 s14, 1024
  s_mov_b32 s15, 0x20000
  s_mov_b32 s16, s24
  s_mov_b32 s17, s25
  s_mov_b32 s18, 7882752
  s_mov_b32 s19, 0x20000
  s_mov_b32 s84, s22
  s_mov_b32 s85, s23
  s_mov_b32 s86, 256
  s_mov_b32 s87, 0x20000
  v_and_b32 v165, 15, v2
  v_lshlrev_b32 v166, 2, v165
  s_lshl_b32 s74, s27, 7
  s_add_u32 s22, s74, 7864320
  s_lshl_b32 s75, s26, 5
  buffer_load_dwordx4 v133, s[32:35], s63 offen offset:1024 lds
  s_add_u32 s9, s72, s75
  s_lshr_b32 s74, s6, 2
  s_lshl_b32 s74, s74, 18
  s_bfe_u32 s75, s6, 0x10001
  s_lshl_b32 s75, s75, 10
  s_add_u32 s74, s74, s75
  s_and_b32 s75, s6, 1
  s_lshl_b32 s75, s75, 15
  s_add_u32 s74, s74, s75
  s_add_u32 s8, s74, s9
  s_add_u32 s52, s20, s8
  s_addc_u32 s53, s21, 0
  s_sub_u32 s54, 0x200000, s8
  s_mov_b32 s55, 0x20000
  s_lshl_b32 s74, s3, 2
  s_add_u32 s75, s74, s26
  s_lshl_b32 s76, s75, 11
  s_add_u32 s76, s76, s59
  s_add_u32 s69, s76, 131072
  v_lshlrev_b32 v20, 4, v2
  s_add_u32 s20, s22, s74
  s_lshl_b32 s57, s27, 10
  s_add_u32 s57, s57, 7866368
  s_lshl_b32 s75, s75, 2
  s_add_u32 s56, s57, s75
  s_lshr_b32 s75, s6, 1
  s_lshl_b32 s21, s75, 7
  s_add_u32 m0, s66, 32768
  s_add_u32 s60, s60, 128
  s_bitset0_b32 s60, 10
  buffer_load_dwordx4 v128, s[28:31], s60 offen offset:0 lds
  s_add_u32 s21, s21, 7864320
  s_lshl_b32 s10, s26, 12
  s_lshl_b32 s62, s26, 10
  s_mov_b32 s81, 30000
  s_and_b32 s74, s6, 3
  s_lshl_b32 s74, s74, 1
  s_add_u32 s74, s74, s7
  s_lshl_b32 s74, s74, 2
  s_and_b32 s75, s2, 7
  s_add_u32 s74, s74, s75
  s_and_b32 s74, s74, 31
  s_mul_i32 s74, s74, 7
  s_lshr_b32 s23, s74, 4
  s_lshl_b32 s23, s23, 15
  v_and_b32 v12, 1, v1
  v_lshlrev_b32 v12, 6, v12
  v_xor_b32 v12, v12, v6
  v_lshl_add_u32 v12, v1, 14, v12
  v_add_u32 v130, 131072, v12
  v_lshl_add_u32 v158, v3, 10, v10
  v_xor_b32 v12, 64, v158
  v_add_u32 v159, 7168, v12
  v_add_u32 v160, 14336, v158
  v_add_u32 v161, 21504, v12
  s_mul_i32 s75, s27, 491520
  s_mul_i32 s76, s58, 2048
  buffer_load_dwordx4 v129, s[28:31], s60 offen offset:1024 lds
  s_add_u32 s74, s75, s76
  s_add_u32 s36, s24, s74
  s_addc_u32 s37, s25, 0
  s_mov_b32 s38, 491520
  s_mov_b32 s39, 0x20000
  v_mov_b32 v76, 0x3f803f80
  v_mov_b32 v77, 0x3f803f80
  v_mov_b32 v78, 0x3f803f80
  v_mov_b32 v79, 0x3f803f80
  v_lshlrev_b32 v8, 2, v0
  v_add_u32 v8, 131072, v8
  ds_write_b32 v8, v76 offset:0
  ds_write_b32 v8, v76 offset:2048
  ds_write_b32 v8, v76 offset:4096
  ds_write_b32 v8, v76 offset:6144
  v_mov_b32 v9, 0
  ds_write_b32 v8, v9 offset:9728
  v_bfe_u32 v12, v2, 1, 3
  v_xor_b32 v12, v12, v164
  v_lshlrev_b32 v12, 4, v12
  v_lshl_add_u32 v134, v165, 7, v12
  v_xor_b32 v135, 64, v134
  v_add_u32 v136, 0x10000, v134
  v_add_u32 v137, 0x10000, v135
  v_add_u32 v138, 131072, v134
  v_add_u32 v139, 131072, v135
  v_lshl_add_u32 v140, v1, 11, v134
  s_add_u32 m0, s67, 40960
  s_nop 0
  buffer_load_dwordx4 v80, s[32:35], s63 offen offset:0 lds
  v_lshl_add_u32 v141, v1, 11, v135
  v_lshl_add_u32 v142, v1, 11, v136
  v_lshl_add_u32 v143, v1, 11, v137
  v_bfe_u32 v15, v2, 2, 2
  v_lshl_add_u32 v12, v164, 3, v15
  v_bfe_u32 v13, v2, 1, 1
  v_lshl_add_u32 v13, v1, 1, v13
  v_and_b32 v14, 2, v15
  v_xor_b32 v13, v13, v14
  v_and_b32 v14, 1, v164
  v_lshlrev_b32 v14, 2, v14
  v_xor_b32 v13, v13, v14
  v_and_b32 v14, 1, v2
  v_lshl_add_u32 v13, v13, 1, v14
  v_lshlrev_b32 v13, 3, v13
  v_lshl_add_u32 v13, v12, 7, v13
  v_add_u32 v144, 0, v13
  v_add_u32 v145, 65536, v13
  v_and_b32 v16, 1, v164
  v_mul_u32_u24 v16, 61440, v16
  v_and_b32 v12, 1, v1
  v_lshlrev_b32 v12, 1, v12
  v_lshrrev_b32 v13, 1, v164
  v_add_u32 v12, v12, v13
  v_lshl_add_u32 v16, v12, 8, v16
  v_lshl_add_u32 v16, v165, 4, v16
  buffer_load_dwordx4 v81, s[32:35], s63 offen offset:1024 lds
  v_lshrrev_b32 v12, 1, v1
  v_lshl_add_u32 v163, v12, 10, v16
  v_lshlrev_b32 v169, 24, v2
  v_mov_b32 v170, 140800
  s_lshr_b32 s75, s6, 1
  s_lshl_b32 s75, s75, 3
  s_and_b32 s76, s6, 1
  s_add_u32 s75, s75, s76
  s_mul_i32 s75, s75, 61440
  s_mul_i32 s76, s26, 15360
  s_add_u32 s75, s75, s76
  v_lshlrev_b32 v12, 4, v2
  v_add_u32 v162, s75, v12
  v_bfe_u32 v150, v2, 2, 2
  v_lshl_add_u32 v151, v164, 3, v150
  v_bfe_u32 v152, v2, 1, 1
  v_and_b32 v150, 2, v150
  v_xor_b32 v152, v152, v150
  v_and_b32 v150, 1, v164
  v_lshlrev_b32 v150, 2, v150
  v_xor_b32 v152, v152, v150
  v_and_b32 v150, 1, v2
  v_lshl_add_u32 v152, v152, 1, v150
  v_lshlrev_b32 v152, 3, v152
  v_lshl_add_u32 v152, v151, 7, v152
  v_add_u32 v152, s10, v152
  s_add_u32 m0, s67, 49152
  s_nop 0
  buffer_load_dwordx4 v82, s[32:35], s63 offen offset:0 lds
  s_add_u32 s4, s26, 0
  s_and_b32 s4, s4, 3
  s_lshl_b32 s4, s4, 5
  v_xor_b32 v146, s4, v152
  s_add_u32 s4, s26, 1
  s_and_b32 s4, s4, 3
  s_lshl_b32 s4, s4, 5
  v_xor_b32 v147, s4, v152
  s_add_u32 s4, s26, 2
  s_and_b32 s4, s4, 3
  s_lshl_b32 s4, s4, 5
  v_xor_b32 v148, s4, v152
  s_add_u32 s4, s26, 3
  s_and_b32 s4, s4, 3
  s_lshl_b32 s4, s4, 5
  v_xor_b32 v149, s4, v152
  v_add_u32 v150, 65536, v146
  v_add_u32 v151, 65536, v147
  v_add_u32 v152, 65536, v148
  v_add_u32 v153, 65536, v149
  v_add_u32 v154, 131072, v146
  v_add_u32 v155, 131072, v147
  v_add_u32 v156, 131072, v148
  v_add_u32 v157, 131072, v149
  v_mov_b32 v13, 0xf149f2ca
  v_mov_b32 v5, 0xffff
  v_mov_b32 v18, 0xffff0000
  v_lshlrev_b32 v7, 2, v164
  v_sub_u32 v7, v165, v7
  s_cmp_lt_u32 s27, 2
  s_cselect_b64 s[4:5], 0, -1
  v_subrev_u32 v8, 0, v7
  v_cmp_gt_u32 vcc, 8, v8
  v_cmp_gt_i32 s[74:75], -8, v8
  s_nop 0
  v_cndmask_b32 v246, v13, 0, vcc
  buffer_load_dwordx4 v83, s[32:35], s63 offen offset:1024 lds
  v_cndmask_b32 v250, v13, 0, s[74:75]
  v_cndmask_b32 v14, 0, v5, s[74:75]
  v_cndmask_b32 v186, v13, v250, s[4:5]
  v_subrev_u32 v8, 1, v7
  v_cmp_gt_u32 vcc, 8, v8
  v_cmp_gt_i32 s[74:75], -8, v8
  s_nop 0
  v_cndmask_b32 v247, v13, 0, vcc
  v_cndmask_b32 v251, v13, 0, s[74:75]
  v_cndmask_b32 v15, 0, v18, s[74:75]
  v_cndmask_b32 v187, v13, v251, s[4:5]
  v_subrev_u32 v8, 2, v7
  v_cmp_gt_u32 vcc, 8, v8
  v_cmp_gt_i32 s[74:75], -8, v8
  s_nop 0
  v_cndmask_b32 v248, v13, 0, vcc
  v_cndmask_b32 v252, v13, 0, s[74:75]
  v_cndmask_b32 v16, 0, v5, s[74:75]
  v_cndmask_b32 v188, v13, v252, s[4:5]
  v_subrev_u32 v8, 3, v7
  v_cmp_gt_u32 vcc, 8, v8
  v_cmp_gt_i32 s[74:75], -8, v8
  s_nop 0
  v_cndmask_b32 v249, v13, 0, vcc
  v_cndmask_b32 v253, v13, 0, s[74:75]
  v_cndmask_b32 v17, 0, v18, s[74:75]
  v_cndmask_b32 v189, v13, v253, s[4:5]
  v_or_b32 v254, v14, v15
  v_or_b32 v255, v16, v17
  s_add_u32 m0, s68, 2048
  s_add_u32 s64, s60, s61
  buffer_load_dword v131, s[28:31], s64 offen lds
  s_mov_b32 s78, 0
  v_and_b32 v11, 3, v2
  v_bfe_u32 v15, v2, 2, 2
  v_cmp_eq_u32 s[70:71], 1, v11
  v_cmp_eq_u32 s[72:73], 2, v11
  v_cmp_eq_u32 s[74:75], 3, v11
  v_cmp_eq_u32 s[76:77], v15, v164
  v_lshl_add_u32 v12, v1, 4, v165
  v_lshlrev_b32 v13, 3, v12
  v_add_u32 v13, 139264, v13
  v_lshlrev_b32 v14, 2, v12
  v_add_u32 v14, 139904, v14
  v_lshlrev_b32 v175, 3, v165
  v_add_u32 v15, 139776, v175
  v_add_u32 v16, 140160, v166
  v_mov_b32 v17, 140544
  v_cndmask_b32 v171, v17, v13, s[76:77]
  v_cndmask_b32 v172, v17, v14, s[76:77]
  v_cndmask_b32 v173, v17, v15, s[76:77]
  v_cndmask_b32 v174, v17, v16, s[76:77]
  v_add_u32 v175, 139264, v175
  buffer_load_dword v222, v166, s[16:19], s22 offen sc1
  buffer_load_dwordx4 v[210:213], v20, s[28:31], s69 offen
  buffer_load_dword v167, v166, s[84:87], 0 offen offset:0 sc1
  s_waitcnt vmcnt(12) lgkmcnt(0)
  s_barrier
  ds_read_b128 a[212:215], v140 offset:24576
  ds_read_b128 a[208:211], v138 offset:0
  ds_read_b64_tr_b16 a[0:1], v144 offset:0
  ds_read_b64_tr_b16 a[2:3], v144 offset:512
  ds_read_b128 a[192:195], v134 offset:24576
  ds_read_b64_tr_b16 a[4:5], v144 offset:8192
  ds_read_b64_tr_b16 a[6:7], v144 offset:8704
  ds_read_b64_tr_b16 a[8:9], v144 offset:16384
  ds_read_b64_tr_b16 a[10:11], v144 offset:16896
  ds_read_b128 a[196:199], v134 offset:26624
  ds_read_b128 a[200:203], v134 offset:28672
  ds_read_b128 a[204:207], v134 offset:30720
  s_waitcnt lgkmcnt(7)
  v_mfma_f32_16x16x32_bf16 v[4:7], a[0:3], a[192:195], 0
  s_add_u32 m0, s67, 65536
  ds_read_b128 a[236:239], v141 offset:24576
  s_waitcnt lgkmcnt(6)
  v_mfma_f32_16x16x32_bf16 v[24:27], a[4:7], a[192:195], 0
  s_add_u32 s63, s63, 196608
  s_sub_u32 s65, s63, 1572864
  s_min_u32 s63, s63, s65
  s_waitcnt lgkmcnt(4)
  v_mfma_f32_16x16x32_bf16 v[44:47], a[192:195], a[8:11], 0
  buffer_load_dwordx4 v132, s[32:35], s63 offen offset:0 lds
  s_waitcnt lgkmcnt(3)
  v_mfma_f32_16x16x32_bf16 v[8:11], a[0:3], a[196:199], 0
  ds_read_b128 a[232:235], v139 offset:0
  v_mfma_f32_16x16x32_bf16 v[28:31], a[4:7], a[196:199], 0
  ds_read_b64_tr_b16 a[12:13], v144 offset:4096
  v_mfma_f32_16x16x32_bf16 v[48:51], a[196:199], a[8:11], 0
  buffer_load_dwordx4 v133, s[32:35], s63 offen offset:1024 lds
  s_waitcnt lgkmcnt(4)
  v_mfma_f32_16x16x32_bf16 v[12:15], a[0:3], a[200:203], 0
  s_add_u32 m0, s66, 65536
  ds_read_b64_tr_b16 a[14:15], v144 offset:4608
  v_mfma_f32_16x16x32_bf16 v[32:35], a[4:7], a[200:203], 0
  s_add_u32 s60, s60, 128
  s_bitset0_b32 s60, 10
  v_mfma_f32_16x16x32_bf16 v[52:55], a[200:203], a[8:11], 0
  ds_read_b128 a[216:219], v135 offset:24576
  s_waitcnt lgkmcnt(5)
  v_mfma_f32_16x16x32_bf16 v[16:19], a[0:3], a[204:207], 0
  buffer_load_dwordx4 v128, s[28:31], s60 offen offset:0 lds
  v_mfma_f32_16x16x32_bf16 v[36:39], a[4:7], a[204:207], 0
  ds_read_b64_tr_b16 a[16:17], v144 offset:12288
  v_mfma_f32_16x16x32_bf16 v[56:59], a[204:207], a[8:11], 0
  ds_read_b64_tr_b16 a[18:19], v144 offset:12800
  v_mfma_f32_16x16x32_bf16 v[20:23], a[0:3], a[208:211], 0
  buffer_load_dwordx4 v129, s[28:31], s60 offen offset:1024 lds
  v_mfma_f32_16x16x32_bf16 v[40:43], a[4:7], a[208:211], 0
  s_add_u32 m0, s67, 73728
  ds_read_b64_tr_b16 a[20:21], v144 offset:20480
  v_mfma_f32_16x16x32_bf16 v[60:63], a[208:211], a[8:11], 0
  ds_read_b64_tr_b16 a[22:23], v144 offset:20992
  v_mfma_f32_16x16x32_bf16 v[64:67], v[76:79], a[212:215], 0
  buffer_load_dwordx4 v80, s[32:35], s63 offen offset:0 lds
  v_mfma_f32_16x16x32_bf16 v[68:71], a[212:215], a[212:215], 0
  ds_read_b128 a[220:223], v135 offset:26624
  v_mfma_f32_16x16x32_bf16 v[72:75], a[208:211], a[208:211], 0
  ds_read_b128 a[224:227], v135 offset:28672
  s_waitcnt lgkmcnt(10)
  v_mfma_f32_16x16x32_bf16 v[64:67], v[76:79], a[236:239], v[64:67]
  buffer_load_dwordx4 v81, s[32:35], s63 offen offset:1024 lds
  v_mfma_f32_16x16x32_bf16 v[68:71], a[236:239], a[236:239], v[68:71]
  s_waitcnt lgkmcnt(1)
  ds_read_b128 a[228:231], v135 offset:30720
  s_add_u32 m0, s67, 81920
  v_mfma_f32_16x16x32_bf16 v[72:75], a[232:235], a[232:235], v[72:75]
  buffer_load_dwordx4 v82, s[32:35], s63 offen offset:0 lds
  v_mfma_f32_16x16x32_bf16 v[4:7], a[12:15], a[216:219], v[4:7]
  buffer_load_dwordx4 v83, s[32:35], s63 offen offset:1024 lds
  v_mfma_f32_16x16x32_bf16 v[24:27], a[16:19], a[216:219], v[24:27]
  s_waitcnt vmcnt(11) lgkmcnt(0)
  s_barrier
  s_add_u32 m0, s68, 4096
  v_mfma_f32_16x16x32_bf16 v[44:47], a[216:219], a[20:23], v[44:47]
  s_add_u32 s64, s60, s61
  ds_read_b128 a[212:215], v140 offset:57344
  v_mfma_f32_16x16x32_bf16 v[8:11], a[12:15], a[220:223], v[8:11]
  ds_read_b128 a[208:211], v138 offset:2048
  v_mfma_f32_16x16x32_bf16 v[28:31], a[16:19], a[220:223], v[28:31]
  ds_read_b64_tr_b16 a[24:25], v144 offset:32768
  v_mfma_f32_16x16x32_bf16 v[48:51], a[220:223], a[20:23], v[48:51]
  buffer_load_dword v131, s[28:31], s64 offen lds
  v_mfma_f32_16x16x32_bf16 v[12:15], a[12:15], a[224:227], v[12:15]
  s_add_u32 m0, s67, 98304
  ds_read_b64_tr_b16 a[26:27], v144 offset:33280
  v_mfma_f32_16x16x32_bf16 v[32:35], a[16:19], a[224:227], v[32:35]
  s_add_u32 s63, s63, 196608
  s_sub_u32 s65, s63, 1572864
  s_min_u32 s63, s63, s65
  v_mfma_f32_16x16x32_bf16 v[52:55], a[224:227], a[20:23], v[52:55]
  ds_read_b128 a[192:195], v134 offset:57344
  v_mfma_f32_16x16x32_bf16 v[16:19], a[12:15], a[228:231], v[16:19]
  ds_read_b64_tr_b16 a[28:29], v144 offset:40960
  buffer_load_dwordx4 v132, s[32:35], s63 offen offset:0 lds
  v_mfma_f32_16x16x32_bf16 v[36:39], a[16:19], a[228:231], v[36:39]
  ds_read_b64_tr_b16 a[30:31], v144 offset:41472
  v_mfma_f32_16x16x32_bf16 v[56:59], a[228:231], a[20:23], v[56:59]
  ds_read_b64_tr_b16 a[32:33], v144 offset:49152
  v_mfma_f32_16x16x32_bf16 v[20:23], a[12:15], a[232:235], v[20:23]
  buffer_load_dwordx4 v133, s[32:35], s63 offen offset:1024 lds
  v_mfma_f32_16x16x32_bf16 v[40:43], a[16:19], a[232:235], v[40:43]
  s_add_u32 m0, s66, 98304
  ds_read_b64_tr_b16 a[34:35], v144 offset:49664
  s_add_u32 s60, s60, 128
  s_bitset0_b32 s60, 10
  v_mfma_f32_16x16x32_bf16 v[60:63], a[232:235], a[20:23], v[60:63]
  ds_read_b128 a[196:199], v134 offset:59392
  s_waitcnt lgkmcnt(9)
  v_mfma_f32_16x16x32_bf16 v[64:67], v[76:79], a[212:215], v[64:67]
  ds_read_b128 a[200:203], v134 offset:61440
  buffer_load_dwordx4 v128, s[28:31], s60 offen offset:0 lds
  v_mfma_f32_16x16x32_bf16 v[68:71], a[212:215], a[212:215], v[68:71]
  s_waitcnt lgkmcnt(1)
  ds_read_b128 a[204:207], v134 offset:63488
  v_mfma_f32_16x16x32_bf16 v[72:75], a[208:211], a[208:211], v[72:75]
  buffer_load_dwordx4 v129, s[28:31], s60 offen offset:1024 lds
  v_mfma_f32_16x16x32_bf16 v[4:7], a[24:27], a[192:195], v[4:7]
  s_add_u32 m0, s67, 106496
  ds_read_b128 a[236:239], v141 offset:57344
  v_mfma_f32_16x16x32_bf16 v[24:27], a[28:31], a[192:195], v[24:27]
  buffer_load_dwordx4 v80, s[32:35], s63 offen offset:0 lds
  v_mfma_f32_16x16x32_bf16 v[44:47], a[192:195], a[32:35], v[44:47]
  ds_read_b128 a[232:235], v139 offset:2048
  v_mfma_f32_16x16x32_bf16 v[8:11], a[24:27], a[196:199], v[8:11]
  s_waitcnt lgkmcnt(2)
  ds_read_b64_tr_b16 a[36:37], v144 offset:36864
  v_mfma_f32_16x16x32_bf16 v[28:31], a[28:31], a[196:199], v[28:31]
  ds_read_b64_tr_b16 a[38:39], v144 offset:37376
  v_mfma_f32_16x16x32_bf16 v[48:51], a[196:199], a[32:35], v[48:51]
  buffer_load_dwordx4 v81, s[32:35], s63 offen offset:1024 lds
  v_mfma_f32_16x16x32_bf16 v[12:15], a[24:27], a[200:203], v[12:15]
  s_add_u32 m0, s67, 114688
  ds_read_b128 a[216:219], v135 offset:57344
  v_mfma_f32_16x16x32_bf16 v[32:35], a[28:31], a[200:203], v[32:35]
  ds_read_b64_tr_b16 a[40:41], v144 offset:45056
  v_mfma_f32_16x16x32_bf16 v[52:55], a[200:203], a[32:35], v[52:55]
  buffer_load_dwordx4 v82, s[32:35], s63 offen offset:0 lds
  v_mfma_f32_16x16x32_bf16 v[16:19], a[24:27], a[204:207], v[16:19]
  ds_read_b64_tr_b16 a[42:43], v144 offset:45568
  v_mfma_f32_16x16x32_bf16 v[36:39], a[28:31], a[204:207], v[36:39]
  ds_read_b64_tr_b16 a[44:45], v144 offset:53248
  v_mfma_f32_16x16x32_bf16 v[56:59], a[204:207], a[32:35], v[56:59]
  ds_read_b64_tr_b16 a[46:47], v144 offset:53760
  v_mfma_f32_16x16x32_bf16 v[20:23], a[24:27], a[208:211], v[20:23]
  buffer_load_dwordx4 v83, s[32:35], s63 offen offset:1024 lds
  v_mfma_f32_16x16x32_bf16 v[40:43], a[28:31], a[208:211], v[40:43]
  s_add_u32 m0, s68, 6144
  s_add_u32 s64, s60, s61
  v_mfma_f32_16x16x32_bf16 v[60:63], a[208:211], a[32:35], v[60:63]
  ds_read_b128 a[220:223], v135 offset:59392
  s_waitcnt lgkmcnt(9)
  v_mfma_f32_16x16x32_bf16 v[64:67], v[76:79], a[236:239], v[64:67]
  ds_read_b128 a[224:227], v135 offset:61440
  buffer_load_dword v131, s[28:31], s64 offen lds
  v_mfma_f32_16x16x32_bf16 v[68:71], a[236:239], a[236:239], v[68:71]
  s_waitcnt lgkmcnt(1)
  ds_read_b128 a[228:231], v135 offset:63488
  s_add_u32 m0, s67, 0
  s_add_u32 s63, s63, 196608
  s_sub_u32 s65, s63, 1572864
  s_min_u32 s63, s63, s65
  v_mfma_f32_16x16x32_bf16 v[72:75], a[232:235], a[232:235], v[72:75]
  buffer_load_dwordx4 v132, s[32:35], s63 offen offset:0 lds
  v_mfma_f32_16x16x32_bf16 v[4:7], a[36:39], a[216:219], v[4:7]
  buffer_load_dwordx4 v133, s[32:35], s63 offen offset:1024 lds
  v_mfma_f32_16x16x32_bf16 v[24:27], a[40:43], a[216:219], v[24:27]
  s_waitcnt vmcnt(11) lgkmcnt(0)
  s_barrier
  s_add_u32 m0, s66, 0
  v_mfma_f32_16x16x32_bf16 v[44:47], a[216:219], a[44:47], v[44:47]
  s_add_u32 s60, s60, 128
  ds_read_b128 a[212:215], v142 offset:24576
  v_mfma_f32_16x16x32_bf16 v[8:11], a[36:39], a[220:223], v[8:11]
  s_bitset0_b32 s60, 10
  ds_read_b128 a[208:211], v138 offset:4096
  v_mfma_f32_16x16x32_bf16 v[28:31], a[40:43], a[220:223], v[28:31]
  ds_read_b64_tr_b16 a[48:49], v145 offset:0
  v_mfma_f32_16x16x32_bf16 v[48:51], a[220:223], a[44:47], v[48:51]
  buffer_load_dwordx4 v128, s[28:31], s60 offen offset:0 lds
  v_mfma_f32_16x16x32_bf16 v[12:15], a[36:39], a[224:227], v[12:15]
  ds_read_b64_tr_b16 a[50:51], v145 offset:512
  v_mfma_f32_16x16x32_bf16 v[32:35], a[40:43], a[224:227], v[32:35]
  ds_read_b128 a[192:195], v136 offset:24576
  v_mfma_f32_16x16x32_bf16 v[52:55], a[224:227], a[44:47], v[52:55]
  ds_read_b64_tr_b16 a[52:53], v145 offset:8192
  v_mfma_f32_16x16x32_bf16 v[16:19], a[36:39], a[228:231], v[16:19]
  buffer_load_dwordx4 v129, s[28:31], s60 offen offset:1024 lds
  v_mfma_f32_16x16x32_bf16 v[36:39], a[40:43], a[228:231], v[36:39]
  s_add_u32 m0, s67, 8192
  ds_read_b64_tr_b16 a[54:55], v145 offset:8704
  v_mfma_f32_16x16x32_bf16 v[56:59], a[228:231], a[44:47], v[56:59]
  ds_read_b64_tr_b16 a[56:57], v145 offset:16384
  v_mfma_f32_16x16x32_bf16 v[20:23], a[36:39], a[232:235], v[20:23]
  buffer_load_dwordx4 v80, s[32:35], s63 offen offset:0 lds
  v_mfma_f32_16x16x32_bf16 v[40:43], a[40:43], a[232:235], v[40:43]
  ds_read_b64_tr_b16 a[58:59], v145 offset:16896
  v_mfma_f32_16x16x32_bf16 v[60:63], a[232:235], a[44:47], v[60:63]
  ds_read_b128 a[196:199], v136 offset:26624
  s_waitcnt lgkmcnt(9)
  v_mfma_f32_16x16x32_bf16 v[64:67], v[76:79], a[212:215], v[64:67]
  ds_read_b128 a[200:203], v136 offset:28672
  buffer_load_dwordx4 v81, s[32:35], s63 offen offset:1024 lds
  v_mfma_f32_16x16x32_bf16 v[68:71], a[212:215], a[212:215], v[68:71]
  s_waitcnt lgkmcnt(1)
  ds_read_b128 a[204:207], v136 offset:30720
  s_add_u32 m0, s67, 16384
  v_mfma_f32_16x16x32_bf16 v[72:75], a[208:211], a[208:211], v[72:75]
  buffer_load_dwordx4 v82, s[32:35], s63 offen offset:0 lds
  v_mfma_f32_16x16x32_bf16 v[4:7], a[48:51], a[192:195], v[4:7]
  ds_read_b128 a[236:239], v143 offset:24576
  v_mfma_f32_16x16x32_bf16 v[24:27], a[52:55], a[192:195], v[24:27]
  buffer_load_dwordx4 v83, s[32:35], s63 offen offset:1024 lds
  v_mfma_f32_16x16x32_bf16 v[44:47], a[192:195], a[56:59], v[44:47]
  s_add_u32 m0, s68, 0
  ds_read_b128 a[232:235], v139 offset:4096
  v_mfma_f32_16x16x32_bf16 v[8:11], a[48:51], a[196:199], v[8:11]
  s_waitcnt lgkmcnt(2)
  s_add_u32 s64, s60, s61
  v_mfma_f32_16x16x32_bf16 v[28:31], a[52:55], a[196:199], v[28:31]
  ds_read_b64_tr_b16 a[60:61], v145 offset:4096
  v_mfma_f32_16x16x32_bf16 v[48:51], a[196:199], a[56:59], v[48:51]
  ds_read_b64_tr_b16 a[62:63], v145 offset:4608
  v_mfma_f32_16x16x32_bf16 v[12:15], a[48:51], a[200:203], v[12:15]
  buffer_load_dword v131, s[28:31], s64 offen lds
  v_mfma_f32_16x16x32_bf16 v[32:35], a[52:55], a[200:203], v[32:35]
  s_add_u32 m0, s67, 32768
  ds_read_b128 a[216:219], v137 offset:24576
  s_add_u32 s63, s63, 196608
  s_sub_u32 s65, s63, 1572864
  s_min_u32 s63, s63, s65
  v_mfma_f32_16x16x32_bf16 v[52:55], a[200:203], a[56:59], v[52:55]
  ds_read_b64_tr_b16 a[64:65], v145 offset:12288
  v_mfma_f32_16x16x32_bf16 v[16:19], a[48:51], a[204:207], v[16:19]
  buffer_load_dwordx4 v132, s[32:35], s63 offen offset:0 lds
  v_mfma_f32_16x16x32_bf16 v[36:39], a[52:55], a[204:207], v[36:39]
  ds_read_b64_tr_b16 a[66:67], v145 offset:12800
  v_mfma_f32_16x16x32_bf16 v[56:59], a[204:207], a[56:59], v[56:59]
  ds_read_b64_tr_b16 a[68:69], v145 offset:20480
  v_mfma_f32_16x16x32_bf16 v[20:23], a[48:51], a[208:211], v[20:23]
  ds_read_b64_tr_b16 a[70:71], v145 offset:20992
  buffer_load_dwordx4 v133, s[32:35], s63 offen offset:1024 lds
  v_mfma_f32_16x16x32_bf16 v[40:43], a[52:55], a[208:211], v[40:43]
  s_add_u32 m0, s66, 32768
  s_add_u32 s60, s60, 128
  s_bitset0_b32 s60, 10
  v_mfma_f32_16x16x32_bf16 v[60:63], a[208:211], a[56:59], v[60:63]
  ds_read_b128 a[220:223], v137 offset:26624
  s_waitcnt lgkmcnt(9)
  v_mfma_f32_16x16x32_bf16 v[64:67], v[76:79], a[236:239], v[64:67]
  ds_read_b128 a[224:227], v137 offset:28672
  buffer_load_dwordx4 v128, s[28:31], s60 offen offset:0 lds
  v_mfma_f32_16x16x32_bf16 v[68:71], a[236:239], a[236:239], v[68:71]
  s_waitcnt lgkmcnt(1)
  ds_read_b128 a[228:231], v137 offset:30720
  v_mfma_f32_16x16x32_bf16 v[72:75], a[232:235], a[232:235], v[72:75]
  buffer_load_dwordx4 v129, s[28:31], s60 offen offset:1024 lds
  v_mfma_f32_16x16x32_bf16 v[4:7], a[60:63], a[216:219], v[4:7]
  s_add_u32 m0, s67, 40960
  v_lshrrev_b32 v222, 3, v222
  v_lshlrev_b32 v222, v222, 1
  v_mfma_f32_16x16x32_bf16 v[24:27], a[64:67], a[216:219], v[24:27]
  s_waitcnt vmcnt(13) lgkmcnt(0)
  s_barrier
  v_or_b32_dpp v222, v222, v222 row_ror:8 row_mask:0xf bank_mask:0xf
  v_mfma_f32_16x16x32_bf16 v[44:47], a[216:219], a[68:71], v[44:47]
  ds_read_b128 a[212:215], v142 offset:57344
  v_or_b32_dpp v222, v222, v222 row_ror:4 row_mask:0xf bank_mask:0xf
  v_mfma_f32_16x16x32_bf16 v[8:11], a[60:63], a[220:223], v[8:11]
  buffer_load_dwordx4 v80, s[32:35], s63 offen offset:0 lds
  v_mfma_f32_16x16x32_bf16 v[28:31], a[64:67], a[220:223], v[28:31]
  ds_read_b128 a[208:211], v138 offset:6144
  v_or_b32_dpp v222, v222, v222 row_ror:2 row_mask:0xf bank_mask:0xf
  v_mfma_f32_16x16x32_bf16 v[48:51], a[220:223], a[68:71], v[48:51]
  ds_read_b64_tr_b16 a[72:73], v145 offset:32768
  v_or_b32_dpp v222, v222, v222 row_ror:1 row_mask:0xf bank_mask:0xf
  v_mfma_f32_16x16x32_bf16 v[12:15], a[60:63], a[224:227], v[12:15]
  buffer_load_dwordx4 v81, s[32:35], s63 offen offset:1024 lds
  v_mfma_f32_16x16x32_bf16 v[32:35], a[64:67], a[224:227], v[32:35]
  s_add_u32 m0, s67, 49152
  ds_read_b64_tr_b16 a[74:75], v145 offset:33280
  v_mfma_f32_16x16x32_bf16 v[52:55], a[224:227], a[68:71], v[52:55]
  ds_read_b128 a[192:195], v136 offset:57344
  v_lshlrev_b32 v223, 24, v0
  v_mfma_f32_16x16x32_bf16 v[16:19], a[60:63], a[228:231], v[16:19]
  ds_read_b64_tr_b16 a[76:77], v145 offset:40960
  buffer_load_dwordx4 v82, s[32:35], s63 offen offset:0 lds
  v_readfirstlane_b32 s4, v222
  v_mfma_f32_16x16x32_bf16 v[36:39], a[64:67], a[228:231], v[36:39]
  s_lshl_b32 s5, s27, 2
  ds_read_b64_tr_b16 a[78:79], v145 offset:41472
  v_mfma_f32_16x16x32_bf16 v[56:59], a[228:231], a[68:71], v[56:59]
  s_ff0_i32_b32 s4, s4
  ds_read_b64_tr_b16 a[80:81], v145 offset:49152
  v_mfma_f32_16x16x32_bf16 v[20:23], a[60:63], a[232:235], v[20:23]
  s_or_b32 s4, s4, 32
  buffer_load_dwordx4 v83, s[32:35], s63 offen offset:1024 lds
  v_mfma_f32_16x16x32_bf16 v[40:43], a[64:67], a[232:235], v[40:43]
  s_add_u32 m0, s68, 2048
  ds_read_b64_tr_b16 a[82:83], v145 offset:49664
  s_add_u32 s64, s60, s61
  v_mfma_f32_16x16x32_bf16 v[60:63], a[232:235], a[68:71], v[60:63]
  s_lshl_b32 s4, s4, 3
  ds_read_b128 a[196:199], v136 offset:59392
  s_waitcnt lgkmcnt(9)
  v_mfma_f32_16x16x32_bf16 v[64:67], v[76:79], a[212:215], v[64:67]
  ds_read_b128 a[200:203], v136 offset:61440
  buffer_load_dword v131, s[28:31], s64 offen lds
  v_mov_b32 v222, s4
  v_mfma_f32_16x16x32_bf16 v[68:71], a[212:215], a[212:215], v[68:71]
  s_waitcnt lgkmcnt(1)
  ds_read_b128 a[204:207], v136 offset:63488
  s_add_u32 m0, s67, 65536
  s_add_u32 s63, s63, 196608
  s_sub_u32 s65, s63, 1572864
  s_min_u32 s63, s63, s65
  v_mfma_f32_16x16x32_bf16 v[72:75], a[208:211], a[208:211], v[72:75]
  s_cmp_lg_u32 s3, 0
  s_cmov_b32 s5, 1073741824
  v_mfma_f32_16x16x32_bf16 v[4:7], a[72:75], a[192:195], v[4:7]
  buffer_load_dwordx4 v132, s[32:35], s63 offen offset:0 lds
  v_mfma_f32_16x16x32_bf16 v[24:27], a[76:79], a[192:195], v[24:27]
  buffer_store_dword v222, v223, s[84:87], s5 offen offset:0 sc1
  v_mfma_f32_16x16x32_bf16 v[44:47], a[192:195], a[80:83], v[44:47]
  ds_read_b128 a[236:239], v143 offset:57344
  v_dot2_f32_bf16 v215, v210, v76, 0
  v_mfma_f32_16x16x32_bf16 v[8:11], a[72:75], a[196:199], v[8:11]
  s_waitcnt lgkmcnt(1)
  buffer_load_dwordx4 v133, s[32:35], s63 offen offset:1024 lds
  v_mfma_f32_16x16x32_bf16 v[28:31], a[76:79], a[196:199], v[28:31]
  s_add_u32 m0, s66, 65536
  ds_read_b128 a[232:235], v139 offset:6144
  s_add_u32 s60, s60, 128
  s_bitset0_b32 s60, 10
  v_mfma_f32_16x16x32_bf16 v[48:51], a[196:199], a[80:83], v[48:51]
  ds_read_b64_tr_b16 a[84:85], v145 offset:36864
  v_dot2_f32_bf16 v214, v210, v210, 0
  v_mfma_f32_16x16x32_bf16 v[12:15], a[72:75], a[200:203], v[12:15]
  ds_read_b64_tr_b16 a[86:87], v145 offset:37376
  buffer_load_dwordx4 v128, s[28:31], s60 offen offset:0 lds
  v_dot2_f32_bf16 v215, v211, v76, v215
  v_mfma_f32_16x16x32_bf16 v[32:35], a[76:79], a[200:203], v[32:35]
  ds_read_b128 a[216:219], v137 offset:57344
  v_dot2_f32_bf16 v214, v211, v211, v214
  v_mfma_f32_16x16x32_bf16 v[52:55], a[200:203], a[80:83], v[52:55]
  ds_read_b64_tr_b16 a[88:89], v145 offset:45056
  v_dot2_f32_bf16 v215, v212, v76, v215
  v_mfma_f32_16x16x32_bf16 v[16:19], a[72:75], a[204:207], v[16:19]
  buffer_load_dwordx4 v129, s[28:31], s60 offen offset:1024 lds
  v_mfma_f32_16x16x32_bf16 v[36:39], a[76:79], a[204:207], v[36:39]
  s_add_u32 m0, s67, 73728
  ds_read_b64_tr_b16 a[90:91], v145 offset:45568
  v_dot2_f32_bf16 v214, v212, v212, v214
  v_mfma_f32_16x16x32_bf16 v[56:59], a[204:207], a[80:83], v[56:59]
  ds_read_b64_tr_b16 a[92:93], v145 offset:53248
  v_dot2_f32_bf16 v215, v213, v76, v215
  v_mfma_f32_16x16x32_bf16 v[20:23], a[72:75], a[208:211], v[20:23]
  ds_read_b64_tr_b16 a[94:95], v145 offset:53760
  buffer_load_dwordx4 v80, s[32:35], s63 offen offset:0 lds
  v_dot2_f32_bf16 v214, v213, v213, v214
  v_mfma_f32_16x16x32_bf16 v[40:43], a[76:79], a[208:211], v[40:43]
  ds_read_b128 a[220:223], v137 offset:59392
  v_mfma_f32_16x16x32_bf16 v[60:63], a[208:211], a[80:83], v[60:63]
  v_permlane32_swap_b32 v215, v214
  s_waitcnt lgkmcnt(9)
  v_mfma_f32_16x16x32_bf16 v[64:67], v[76:79], a[236:239], v[64:67]
  ds_read_b128 a[224:227], v137 offset:61440
  buffer_load_dwordx4 v81, s[32:35], s63 offen offset:1024 lds
  v_add_f32 v215, v215, v214
  v_mfma_f32_16x16x32_bf16 v[68:71], a[236:239], a[236:239], v[68:71]
  s_waitcnt lgkmcnt(1)
  ds_read_b128 a[228:231], v137 offset:63488
  s_add_u32 m0, s67, 81920
  v_mfma_f32_16x16x32_bf16 v[72:75], a[232:235], a[232:235], v[72:75]
  v_mov_b32 v214, v215
  v_mfma_f32_16x16x32_bf16 v[4:7], a[84:87], a[216:219], v[4:7]
  buffer_load_dwordx4 v82, s[32:35], s63 offen offset:0 lds
  v_mfma_f32_16x16x32_bf16 v[24:27], a[88:91], a[216:219], v[24:27]
  s_waitcnt vmcnt(17) lgkmcnt(0)
  s_barrier
  v_mfma_f32_16x16x32_bf16 v[44:47], a[216:219], a[92:95], v[44:47]
  v_permlane16_swap_b32 v215, v214
  v_mfma_f32_16x16x32_bf16 v[8:11], a[84:87], a[220:223], v[8:11]
  ds_read_b128 a[212:215], v140 offset:24576
  buffer_load_dwordx4 v83, s[32:35], s63 offen offset:1024 lds
  v_add_f32 v215, v215, v214
  v_mfma_f32_16x16x32_bf16 v[28:31], a[88:91], a[220:223], v[28:31]
  s_add_u32 m0, s68, 4096
  v_add_f32_dpp v215, v215, v215 row_ror:8 row_mask:0xf bank_mask:0xf
  s_add_u32 s64, s60, s61
  v_mfma_f32_16x16x32_bf16 v[48:51], a[220:223], a[92:95], v[48:51]
  ds_read_b128 a[208:211], v138 offset:0
  v_add_f32_dpp v215, v215, v215 row_ror:4 row_mask:0xf bank_mask:0xf
  v_mfma_f32_16x16x32_bf16 v[12:15], a[84:87], a[224:227], v[12:15]
  ds_read_b64_tr_b16 a[96:97], v144 offset:0
  buffer_load_dword v131, s[28:31], s64 offen lds
  v_add_f32_dpp v215, v215, v215 row_ror:2 row_mask:0xf bank_mask:0xf
  v_mfma_f32_16x16x32_bf16 v[32:35], a[88:91], a[224:227], v[32:35]
  s_add_u32 m0, s67, 98304
  ds_read_b64_tr_b16 a[98:99], v144 offset:512
  s_add_u32 s63, s63, 196608
  s_sub_u32 s65, s63, 1572864
  s_min_u32 s63, s63, s65
  v_mfma_f32_16x16x32_bf16 v[52:55], a[224:227], a[92:95], v[52:55]
  ds_read_b128 a[192:195], v134 offset:24576
  v_add_f32_dpp v215, v215, v215 row_ror:1 row_mask:0xf bank_mask:0xf
  v_mfma_f32_16x16x32_bf16 v[16:19], a[84:87], a[228:231], v[16:19]
  ds_read_b64_tr_b16 a[100:101], v144 offset:8192
  buffer_load_dwordx4 v132, s[32:35], s63 offen offset:0 lds
  v_mul_f32 v215, 0x3b000000, v215
  v_mfma_f32_16x16x32_bf16 v[36:39], a[88:91], a[228:231], v[36:39]
  ds_read_b64_tr_b16 a[102:103], v144 offset:8704
  v_mov_b32 v214, v215
  v_mfma_f32_16x16x32_bf16 v[56:59], a[228:231], a[92:95], v[56:59]
  s_nop 0
  v_permlane32_swap_b32 v215, v214
  v_mfma_f32_16x16x32_bf16 v[20:23], a[84:87], a[232:235], v[20:23]
  ds_read_b64_tr_b16 a[104:105], v144 offset:16384
  buffer_load_dwordx4 v133, s[32:35], s63 offen offset:1024 lds
  v_fma_f32 v214, -v215, v215, v214
  v_mfma_f32_16x16x32_bf16 v[40:43], a[88:91], a[232:235], v[40:43]
  s_add_u32 m0, s66, 98304
  ds_read_b64_tr_b16 a[106:107], v144 offset:16896
  s_add_u32 s60, s60, 128
  s_bitset0_b32 s60, 10
  v_mfma_f32_16x16x32_bf16 v[60:63], a[232:235], a[92:95], v[60:63]
  ds_read_b128 a[196:199], v134 offset:26624
  v_max_f32 v214, 0, v214
  s_waitcnt lgkmcnt(9)
  v_mfma_f32_16x16x32_bf16 v[64:67], v[76:79], a[212:215], v[64:67]
  ds_read_b128 a[200:203], v134 offset:28672
  buffer_load_dwordx4 v128, s[28:31], s60 offen offset:0 lds
  v_cvt_pk_bf16_f32 v214, v215, v214
  v_mfma_f32_16x16x32_bf16 v[68:71], a[212:215], a[212:215], v[68:71]
  s_waitcnt lgkmcnt(1)
  ds_read_b128 a[204:207], v134 offset:30720
  v_mfma_f32_16x16x32_bf16 v[72:75], a[208:211], a[208:211], v[72:75]
  v_lshlrev_b32 v215, 16, v214
  v_and_b32 v214, 0xffff0000, v214
  v_mfma_f32_16x16x32_bf16 v[4:7], a[96:99], a[192:195], v[4:7]
  buffer_load_dwordx4 v129, s[28:31], s60 offen offset:1024 lds
  v_mfma_f32_16x16x32_bf16 v[24:27], a[100:103], a[192:195], v[24:27]
  s_add_u32 m0, s67, 106496
  v_add_f32 v214, 0x3727c5ac, v214
  v_cvt_pk_bf16_f32 v214, v214, v214
  v_mfma_f32_16x16x32_bf16 v[44:47], a[192:195], a[104:107], v[44:47]
  ds_read_b128 a[236:239], v141 offset:24576
  v_and_b32 v214, 0xffff0000, v214
  v_mfma_f32_16x16x32_bf16 v[8:11], a[96:99], a[196:199], v[8:11]
  s_waitcnt lgkmcnt(1)
  buffer_load_dwordx4 v80, s[32:35], s63 offen offset:0 lds
  v_mfma_f32_16x16x32_bf16 v[28:31], a[100:103], a[196:199], v[28:31]
  ds_read_b128 a[232:235], v139 offset:0
  v_mfma_f32_16x16x32_bf16 v[48:51], a[196:199], a[104:107], v[48:51]
  ds_read_b64_tr_b16 a[108:109], v144 offset:4096
  v_sqrt_f32 v214, v214
  v_mfma_f32_16x16x32_bf16 v[12:15], a[96:99], a[200:203], v[12:15]
  ds_read_b64_tr_b16 a[110:111], v144 offset:4608
  buffer_load_dwordx4 v81, s[32:35], s63 offen offset:1024 lds
  v_cvt_pk_bf16_f32 v214, v214, v214
  v_mfma_f32_16x16x32_bf16 v[32:35], a[100:103], a[200:203], v[32:35]
  s_add_u32 m0, s67, 114688
  ds_read_b128 a[216:219], v135 offset:24576
  v_mfma_f32_16x16x32_bf16 v[52:55], a[200:203], a[104:107], v[52:55]
  ds_read_b64_tr_b16 a[112:113], v144 offset:12288
  v_and_b32 v214, 0xffff0000, v214
  v_mfma_f32_16x16x32_bf16 v[16:19], a[96:99], a[204:207], v[16:19]
  buffer_load_dwordx4 v82, s[32:35], s63 offen offset:0 lds
  v_mfma_f32_16x16x32_bf16 v[36:39], a[100:103], a[204:207], v[36:39]
  ds_read_b64_tr_b16 a[114:115], v144 offset:12800
  v_rcp_f32 v214, v214
  v_mfma_f32_16x16x32_bf16 v[56:59], a[204:207], a[104:107], v[56:59]
  ds_read_b64_tr_b16 a[116:117], v144 offset:20480
  v_mul_f32 v215, -v215, v214
  v_mfma_f32_16x16x32_bf16 v[20:23], a[96:99], a[208:211], v[20:23]
  ds_read_b64_tr_b16 a[118:119], v144 offset:20992
  buffer_load_dwordx4 v83, s[32:35], s63 offen offset:1024 lds
  v_mfma_f32_16x16x32_bf16 v[40:43], a[100:103], a[208:211], v[40:43]
  s_lshl_b32 s4, s56, 1
  s_sub_u32 s4, s4, s57
  s_add_u32 m0, s68, 6144
  s_add_u32 s64, s60, s61
  v_mfma_f32_16x16x32_bf16 v[60:63], a[208:211], a[104:107], v[60:63]
  ds_read_b128 a[220:223], v135 offset:26624
  s_waitcnt lgkmcnt(9)
  v_mfma_f32_16x16x32_bf16 v[64:67], v[76:79], a[236:239], v[64:67]
  ds_read_b128 a[224:227], v135 offset:28672
  buffer_load_dword v131, s[28:31], s64 offen lds
  v_mfma_f32_16x16x32_bf16 v[68:71], a[236:239], a[236:239], v[68:71]
  s_waitcnt lgkmcnt(1)
  buffer_store_dwordx2 v[214:215], v169, s[16:19], s4 offen sc1
  ds_read_b128 a[228:231], v135 offset:30720
  v_mfma_f32_16x16x32_bf16 v[72:75], a[232:235], a[232:235], v[72:75]
  buffer_store_dword v214, v169, s[16:19], s56 offen offset:512 sc1
  v_mfma_f32_16x16x32_bf16 v[4:7], a[108:111], a[216:219], v[4:7]
  buffer_store_dword v215, v169, s[16:19], s56 offen offset:768 sc1
  v_mfma_f32_16x16x32_bf16 v[24:27], a[112:115], a[216:219], v[24:27]
  s_waitcnt vmcnt(22) lgkmcnt(0)
  s_barrier
  s_add_u32 m0, s62, 0
  v_mfma_f32_16x16x32_bf16 v[44:47], a[216:219], a[116:119], v[44:47]
  s_add_u32 s60, s60, 128
  ds_read_b128 a[212:215], v140 offset:57344
  v_mfma_f32_16x16x32_bf16 v[8:11], a[108:111], a[220:223], v[8:11]
  s_bitset0_b32 s60, 10
  buffer_load_dwordx4 v130, s[28:31], s60 offen lds
  v_mfma_f32_16x16x32_bf16 v[28:31], a[112:115], a[220:223], v[28:31]
  s_add_u32 m0, s62, 4096
  ds_read_b128 a[208:211], v138 offset:2048
  v_mfma_f32_16x16x32_bf16 v[48:51], a[220:223], a[116:119], v[48:51]
  s_add_u32 s60, s60, 128
  s_bitset0_b32 s60, 10
  v_mfma_f32_16x16x32_bf16 v[12:15], a[108:111], a[224:227], v[12:15]
  ds_read_b64_tr_b16 a[120:121], v144 offset:32768
  v_mfma_f32_16x16x32_bf16 v[32:35], a[112:115], a[224:227], v[32:35]
  ds_read_b64_tr_b16 a[122:123], v144 offset:33280
  buffer_load_dwordx4 v130, s[28:31], s60 offen lds
  v_mfma_f32_16x16x32_bf16 v[52:55], a[224:227], a[116:119], v[52:55]
  s_add_u32 m0, s62, 8192
  ds_read_b128 a[192:195], v134 offset:57344
  s_add_u32 s60, s60, 128
  s_bitset0_b32 s60, 10
  v_mfma_f32_16x16x32_bf16 v[16:19], a[108:111], a[228:231], v[16:19]
  ds_read_b64_tr_b16 a[124:125], v144 offset:40960
  v_mfma_f32_16x16x32_bf16 v[36:39], a[112:115], a[228:231], v[36:39]
  ds_read_b64_tr_b16 a[126:127], v144 offset:41472
  buffer_load_dwordx4 v130, s[28:31], s60 offen lds
  v_mfma_f32_16x16x32_bf16 v[56:59], a[228:231], a[116:119], v[56:59]
  s_add_u32 m0, s62, 12288
  s_add_u32 s60, s60, 128
  s_bitset0_b32 s60, 10
  v_mfma_f32_16x16x32_bf16 v[20:23], a[108:111], a[232:235], v[20:23]
  ds_read_b64_tr_b16 a[128:129], v144 offset:49152
  v_mfma_f32_16x16x32_bf16 v[40:43], a[112:115], a[232:235], v[40:43]
  ds_read_b64_tr_b16 a[130:131], v144 offset:49664
  buffer_load_dwordx4 v130, s[28:31], s60 offen lds
  v_mfma_f32_16x16x32_bf16 v[60:63], a[232:235], a[116:119], v[60:63]
  s_add_u32 m0, s62, 16384
  ds_read_b128 a[196:199], v134 offset:59392
  s_add_u32 s60, s60, 128
  s_bitset0_b32 s60, 10
  s_waitcnt lgkmcnt(9)
  v_mfma_f32_16x16x32_bf16 v[64:67], v[76:79], a[212:215], v[64:67]
  ds_read_b128 a[200:203], v134 offset:61440
  v_mfma_f32_16x16x32_bf16 v[68:71], a[212:215], a[212:215], v[68:71]
  s_waitcnt lgkmcnt(1)
  ds_read_b128 a[204:207], v134 offset:63488
  buffer_load_dwordx4 v130, s[28:31], s60 offen lds
  v_mfma_f32_16x16x32_bf16 v[72:75], a[208:211], a[208:211], v[72:75]
  s_add_u32 m0, s62, 20480
  s_add_u32 s60, s60, 128
  s_bitset0_b32 s60, 10
  v_mfma_f32_16x16x32_bf16 v[4:7], a[120:123], a[192:195], v[4:7]
  buffer_load_dwordx4 v130, s[28:31], s60 offen lds
  v_mfma_f32_16x16x32_bf16 v[24:27], a[124:127], a[192:195], v[24:27]
  s_add_u32 m0, s62, 24576
  ds_read_b128 a[236:239], v141 offset:57344
  v_mfma_f32_16x16x32_bf16 v[44:47], a[192:195], a[128:131], v[44:47]
  s_add_u32 s60, s60, 128
  s_bitset0_b32 s60, 10
  v_mfma_f32_16x16x32_bf16 v[8:11], a[120:123], a[196:199], v[8:11]
  s_waitcnt lgkmcnt(1)
  ds_read_b128 a[232:235], v139 offset:2048
  v_mfma_f32_16x16x32_bf16 v[28:31], a[124:127], a[196:199], v[28:31]
  buffer_load_dwordx4 v130, s[28:31], s60 offen lds
  v_mfma_f32_16x16x32_bf16 v[48:51], a[196:199], a[128:131], v[48:51]
  s_add_u32 m0, s62, 28672
  buffer_load_dword v167, v166, s[84:87], 0 offen offset:0 sc1
  ds_read_b64_tr_b16 a[132:133], v144 offset:36864
  s_add_u32 s60, s60, 128
  s_bitset0_b32 s60, 10
  v_mfma_f32_16x16x32_bf16 v[12:15], a[120:123], a[200:203], v[12:15]
  ds_read_b64_tr_b16 a[134:135], v144 offset:37376
  v_mfma_f32_16x16x32_bf16 v[32:35], a[124:127], a[200:203], v[32:35]
  ds_read_b128 a[216:219], v135 offset:57344
  buffer_load_dwordx4 v130, s[28:31], s60 offen lds
  v_mfma_f32_16x16x32_bf16 v[52:55], a[200:203], a[128:131], v[52:55]
  ds_read_b64_tr_b16 a[136:137], v144 offset:45056
  v_mfma_f32_16x16x32_bf16 v[16:19], a[120:123], a[204:207], v[16:19]
  ds_read_b64_tr_b16 a[138:139], v144 offset:45568
  v_mfma_f32_16x16x32_bf16 v[36:39], a[124:127], a[204:207], v[36:39]
  ds_read_b64_tr_b16 a[140:141], v144 offset:53248
  v_mfma_f32_16x16x32_bf16 v[56:59], a[204:207], a[128:131], v[56:59]
  ds_read_b64_tr_b16 a[142:143], v144 offset:53760
  v_mfma_f32_16x16x32_bf16 v[20:23], a[120:123], a[208:211], v[20:23]
  ds_read_b128 a[220:223], v135 offset:59392
  v_mfma_f32_16x16x32_bf16 v[40:43], a[124:127], a[208:211], v[40:43]
  ds_read_b128 a[224:227], v135 offset:61440
  v_mfma_f32_16x16x32_bf16 v[60:63], a[208:211], a[128:131], v[60:63]
  ds_read_b128 a[228:231], v135 offset:63488
  s_waitcnt lgkmcnt(11)
  v_mfma_f32_16x16x32_bf16 v[64:67], v[76:79], a[236:239], v[64:67]
  v_mfma_f32_16x16x32_bf16 v[68:71], a[236:239], a[236:239], v[68:71]
  s_waitcnt lgkmcnt(2)
  v_mfma_f32_16x16x32_bf16 v[72:75], a[232:235], a[232:235], v[72:75]
  v_mfma_f32_16x16x32_bf16 v[4:7], a[132:135], a[216:219], v[4:7]
  v_mfma_f32_16x16x32_bf16 v[24:27], a[136:139], a[216:219], v[24:27]
  s_waitcnt vmcnt(21) lgkmcnt(0)
  s_barrier
  v_add_u32 v128, 65536, v130
  v_mfma_f32_16x16x32_bf16 v[44:47], a[216:219], a[140:143], v[44:47]
  s_add_u32 m0, s62, 32768
  ds_read_b128 a[212:215], v142 offset:24576
  v_mfma_f32_16x16x32_bf16 v[8:11], a[132:135], a[220:223], v[8:11]
  s_add_u32 s60, s60, 128
  ds_read_b128 a[208:211], v138 offset:4096
  v_mfma_f32_16x16x32_bf16 v[28:31], a[136:139], a[220:223], v[28:31]
  s_bitset0_b32 s60, 10
  ds_read_b64_tr_b16 a[144:145], v145 offset:0
  v_mfma_f32_16x16x32_bf16 v[48:51], a[220:223], a[140:143], v[48:51]
  ds_read_b64_tr_b16 a[146:147], v145 offset:512
  v_mfma_f32_16x16x32_bf16 v[12:15], a[132:135], a[224:227], v[12:15]
  buffer_load_dwordx4 v128, s[28:31], s60 offen lds
  v_mfma_f32_16x16x32_bf16 v[32:35], a[136:139], a[224:227], v[32:35]
  s_add_u32 m0, s62, 36864
  ds_read_b128 a[192:195], v136 offset:24576
  v_mfma_f32_16x16x32_bf16 v[52:55], a[224:227], a[140:143], v[52:55]
  s_add_u32 s60, s60, 128
  s_bitset0_b32 s60, 10
  v_mfma_f32_16x16x32_bf16 v[16:19], a[132:135], a[228:231], v[16:19]
  ds_read_b64_tr_b16 a[148:149], v145 offset:8192
  v_mfma_f32_16x16x32_bf16 v[36:39], a[136:139], a[228:231], v[36:39]
  ds_read_b64_tr_b16 a[150:151], v145 offset:8704
  buffer_load_dwordx4 v128, s[28:31], s60 offen lds
  v_mfma_f32_16x16x32_bf16 v[56:59], a[228:231], a[140:143], v[56:59]
  s_add_u32 m0, s62, 40960
  s_add_u32 s60, s60, 128
  s_bitset0_b32 s60, 10
  v_mfma_f32_16x16x32_bf16 v[20:23], a[132:135], a[232:235], v[20:23]
  ds_read_b64_tr_b16 a[152:153], v145 offset:16384
  v_mfma_f32_16x16x32_bf16 v[40:43], a[136:139], a[232:235], v[40:43]
  ds_read_b64_tr_b16 a[154:155], v145 offset:16896
  buffer_load_dwordx4 v128, s[28:31], s60 offen lds
  v_mfma_f32_16x16x32_bf16 v[60:63], a[232:235], a[140:143], v[60:63]
  s_add_u32 m0, s62, 45056
  ds_read_b128 a[196:199], v136 offset:26624
  s_add_u32 s60, s60, 128
  s_bitset0_b32 s60, 10
  s_waitcnt lgkmcnt(9)
  v_mfma_f32_16x16x32_bf16 v[64:67], v[76:79], a[212:215], v[64:67]
  ds_read_b128 a[200:203], v136 offset:28672
  v_mfma_f32_16x16x32_bf16 v[68:71], a[212:215], a[212:215], v[68:71]
  s_waitcnt lgkmcnt(1)
  ds_read_b128 a[204:207], v136 offset:30720
  buffer_load_dwordx4 v128, s[28:31], s60 offen lds
  v_mfma_f32_16x16x32_bf16 v[72:75], a[208:211], a[208:211], v[72:75]
  s_add_u32 s11, s23, 32768
  s_sub_u32 s5, s11, 458752
  s_min_u32 s11, s11, s5
  s_add_u32 m0, s10, 147456
  v_mfma_f32_16x16x32_bf16 v[4:7], a[144:147], a[192:195], v[4:7]
  buffer_load_dwordx4 v158, s[48:51], s11 offen offset:0 lds
  v_mfma_f32_16x16x32_bf16 v[24:27], a[148:151], a[192:195], v[24:27]
  ds_read_b128 a[236:239], v143 offset:24576
  v_mfma_f32_16x16x32_bf16 v[44:47], a[192:195], a[152:155], v[44:47]
  ds_read_b128 a[232:235], v139 offset:4096
  v_mfma_f32_16x16x32_bf16 v[8:11], a[144:147], a[196:199], v[8:11]
  s_waitcnt lgkmcnt(2)
  buffer_load_dwordx4 v159, s[48:51], s11 offen offset:1024 lds
  v_mfma_f32_16x16x32_bf16 v[28:31], a[148:151], a[196:199], v[28:31]
  ds_read_b64_tr_b16 a[156:157], v145 offset:4096
  v_mfma_f32_16x16x32_bf16 v[48:51], a[196:199], a[152:155], v[48:51]
  ds_read_b64_tr_b16 a[158:159], v145 offset:4608
  v_mfma_f32_16x16x32_bf16 v[12:15], a[144:147], a[200:203], v[12:15]
  ds_read_b128 a[216:219], v137 offset:24576
  s_waitcnt vmcnt(15)
  s_mov_b64 exec, 1
  ds_add_rtn_u32 v3, v170, v170 offset:4
  s_mov_b64 exec, -1
  v_mfma_f32_16x16x32_bf16 v[32:35], a[148:151], a[200:203], v[32:35]
  buffer_load_dwordx4 v160, s[48:51], s11 offen offset:2048 lds
  v_mfma_f32_16x16x32_bf16 v[52:55], a[200:203], a[152:155], v[52:55]
  ds_read_b64_tr_b16 a[160:161], v145 offset:12288
  v_mfma_f32_16x16x32_bf16 v[16:19], a[144:147], a[204:207], v[16:19]
  ds_read_b64_tr_b16 a[162:163], v145 offset:12800
  v_mfma_f32_16x16x32_bf16 v[36:39], a[148:151], a[204:207], v[36:39]
  buffer_load_dwordx4 v161, s[48:51], s11 offen offset:3072 lds
  v_mfma_f32_16x16x32_bf16 v[56:59], a[204:207], a[152:155], v[56:59]
  ds_read_b64_tr_b16 a[164:165], v145 offset:20480
  v_mfma_f32_16x16x32_bf16 v[20:23], a[144:147], a[208:211], v[20:23]
  ds_read_b64_tr_b16 a[166:167], v145 offset:20992
  s_lshr_b32 s5, s6, 1
  s_waitcnt vmcnt(9)
  v_readlane_b32 s24, v167, s27
  v_readlane_b32 s25, v167, s5
  s_nop 0
  s_min_u32 s4, s24, s25
  s_cmp_eq_u32 s4, 0
  s_cbranch_scc1 L_epa
L_epaok:
  v_mfma_f32_16x16x32_bf16 v[40:43], a[148:151], a[208:211], v[40:43]
  ds_read_b128 a[220:223], v137 offset:26624
  v_mfma_f32_16x16x32_bf16 v[60:63], a[208:211], a[152:155], v[60:63]
  ds_read_b128 a[224:227], v137 offset:28672
  s_waitcnt lgkmcnt(11)
  v_mfma_f32_16x16x32_bf16 v[64:67], v[76:79], a[236:239], v[64:67]
  ds_read_b128 a[228:231], v137 offset:30720
  v_mfma_f32_16x16x32_bf16 v[68:71], a[236:239], a[236:239], v[68:71]
  s_waitcnt lgkmcnt(2)
  v_mfma_f32_16x16x32_bf16 v[72:75], a[232:235], a[232:235], v[72:75]
  v_mfma_f32_16x16x32_bf16 v[4:7], a[156:159], a[216:219], v[4:7]
  global_load_dword v220, v221, s[82:83]
  v_mfma_f32_16x16x32_bf16 v[24:27], a[160:163], a[216:219], v[24:27]
  s_waitcnt lgkmcnt(0)
  s_barrier
  v_mfma_f32_16x16x32_bf16 v[44:47], a[216:219], a[164:167], v[44:47]
  ds_read_b128 a[212:215], v142 offset:57344
  v_mfma_f32_16x16x32_bf16 v[8:11], a[156:159], a[220:223], v[8:11]
  s_add_u32 s11, s23, 0
  s_sub_u32 s5, s11, 458752
  s_min_u32 s11, s11, s5
  v_mfma_f32_16x16x32_bf16 v[28:31], a[160:163], a[220:223], v[28:31]
  s_add_u32 m0, s10, 81920
  ds_read_b128 a[208:211], v138 offset:6144
  buffer_load_dwordx4 v158, s[48:51], s11 offen offset:0 lds
  v_mfma_f32_16x16x32_bf16 v[48:51], a[220:223], a[164:167], v[48:51]
  ds_read_b64_tr_b16 a[168:169], v145 offset:32768
  v_mfma_f32_16x16x32_bf16 v[12:15], a[156:159], a[224:227], v[12:15]
  ds_read_b64_tr_b16 a[170:171], v145 offset:33280
  s_add_u32 s5, s24, 1
  v_readfirstlane_b32 s4, v3
  v_mov_b32 v3, s5
  s_cmp_eq_u32 s4, 422400
  s_cselect_b32 s4, s20, 1073741824
  s_nop 1
  buffer_store_dword v3, v169, s[16:19], s4 offen sc1
  v_mfma_f32_16x16x32_bf16 v[32:35], a[160:163], a[224:227], v[32:35]
  buffer_load_dwordx4 v159, s[48:51], s11 offen offset:1024 lds
  v_mfma_f32_16x16x32_bf16 v[52:55], a[224:227], a[164:167], v[52:55]
  ds_read_b128 a[192:195], v136 offset:57344
  v_mfma_f32_16x16x32_bf16 v[16:19], a[156:159], a[228:231], v[16:19]
  ds_read_b64_tr_b16 a[172:173], v145 offset:40960
  v_mfma_f32_16x16x32_bf16 v[36:39], a[160:163], a[228:231], v[36:39]
  ds_read_b64_tr_b16 a[174:175], v145 offset:41472
  buffer_load_dwordx4 v160, s[48:51], s11 offen offset:2048 lds
  v_mfma_f32_16x16x32_bf16 v[56:59], a[228:231], a[164:167], v[56:59]
  ds_read_b64_tr_b16 a[176:177], v145 offset:49152
  v_mfma_f32_16x16x32_bf16 v[20:23], a[156:159], a[232:235], v[20:23]
  ds_read_b64_tr_b16 a[178:179], v145 offset:49664
  v_mfma_f32_16x16x32_bf16 v[40:43], a[160:163], a[232:235], v[40:43]
  buffer_load_dwordx4 v161, s[48:51], s11 offen offset:3072 lds
  v_mfma_f32_16x16x32_bf16 v[60:63], a[232:235], a[164:167], v[60:63]
  s_add_u32 m0, s10, 65536
  ds_read_b128 a[196:199], v136 offset:59392
  s_waitcnt lgkmcnt(9)
  v_mfma_f32_16x16x32_bf16 v[64:67], v[76:79], a[212:215], v[64:67]
  ds_read_b128 a[200:203], v136 offset:61440
  v_mfma_f32_16x16x32_bf16 v[68:71], a[212:215], a[212:215], v[68:71]
  s_waitcnt lgkmcnt(1)
  ds_read_b128 a[204:207], v136 offset:63488
  buffer_load_dwordx4 v158, s[44:47], 0 offen offset:0 lds
  v_mfma_f32_16x16x32_bf16 v[72:75], a[208:211], a[208:211], v[72:75]
  buffer_load_dwordx4 v159, s[44:47], 0 offen offset:1024 lds
  v_mfma_f32_16x16x32_bf16 v[4:7], a[168:171], a[192:195], v[4:7]
  ds_read_b128 a[236:239], v143 offset:57344
  v_mfma_f32_16x16x32_bf16 v[24:27], a[172:175], a[192:195], v[24:27]
  ds_read_b128 a[232:235], v139 offset:6144
  v_mfma_f32_16x16x32_bf16 v[44:47], a[192:195], a[176:179], v[44:47]
  buffer_load_dwordx4 v160, s[44:47], 0 offen offset:2048 lds
  v_mfma_f32_16x16x32_bf16 v[8:11], a[168:171], a[196:199], v[8:11]
  s_waitcnt lgkmcnt(2)
  ds_read_b64_tr_b16 a[180:181], v145 offset:36864
  v_mfma_f32_16x16x32_bf16 v[28:31], a[172:175], a[196:199], v[28:31]
  ds_read_b64_tr_b16 a[182:183], v145 offset:37376
  v_mfma_f32_16x16x32_bf16 v[48:51], a[196:199], a[176:179], v[48:51]
  ds_read_b128 a[216:219], v137 offset:57344
  v_mfma_f32_16x16x32_bf16 v[12:15], a[168:171], a[200:203], v[12:15]
  buffer_load_dwordx4 v161, s[44:47], 0 offen offset:3072 lds
  v_mfma_f32_16x16x32_bf16 v[32:35], a[172:175], a[200:203], v[32:35]
  ds_read_b64_tr_b16 a[184:185], v145 offset:45056
  s_waitcnt lgkmcnt(5)
  v_mfma_f32_16x16x32_bf16 v[64:67], v[76:79], a[236:239], v[64:67]
  ds_read_b64_tr_b16 a[186:187], v145 offset:45568
  v_mfma_f32_16x16x32_bf16 v[68:71], a[236:239], a[236:239], v[68:71]
  ds_read_b64_tr_b16 a[188:189], v145 offset:53248
  s_waitcnt lgkmcnt(6)
  v_mfma_f32_16x16x32_bf16 v[72:75], a[232:235], a[232:235], v[72:75]
  ds_read_b64_tr_b16 a[190:191], v145 offset:53760
  v_mfma_f32_16x16x32_bf16 v[52:55], a[200:203], a[176:179], v[52:55]
  ds_read_b128 a[220:223], v137 offset:59392
  v_mfma_f32_16x16x32_bf16 v[16:19], a[168:171], a[204:207], v[16:19]
  ds_read_b128 a[224:227], v137 offset:61440
  v_mfma_f32_16x16x32_bf16 v[36:39], a[172:175], a[204:207], v[36:39]
  v_cndmask_b32 v210, v68, v69, s[70:71]
  v_cndmask_b32 v210, v210, v70, s[72:73]
  v_mfma_f32_16x16x32_bf16 v[56:59], a[204:207], a[176:179], v[56:59]
  v_cndmask_b32 v210, v210, v71, s[74:75]
  v_cndmask_b32 v212, v72, v73, s[70:71]
  v_mfma_f32_16x16x32_bf16 v[20:23], a[168:171], a[208:211], v[20:23]
  v_cndmask_b32 v212, v212, v74, s[72:73]
  v_cndmask_b32 v212, v212, v75, s[74:75]
  v_mfma_f32_16x16x32_bf16 v[40:43], a[172:175], a[208:211], v[40:43]
  s_waitcnt lgkmcnt(1)
  ds_read_b128 a[228:231], v137 offset:63488
  v_permlane32_swap_b32 v72, v73
  v_mfma_f32_16x16x32_bf16 v[60:63], a[208:211], a[176:179], v[60:63]
  v_mul_f32 v211, 0x3b000000, v64
  v_mul_f32 v213, 0x3b000000, v72
  v_mul_f32 v210, 0x3b000000, v210
  v_mfma_f32_16x16x32_bf16 v[20:23], a[180:183], a[232:235], v[20:23]
  v_mul_f32 v212, 0x3b000000, v212
  v_fma_f32 v210, -v211, v211, v210
  v_fma_f32 v212, -v213, v213, v212
  v_max_f32 v210, 0, v210
  v_mfma_f32_16x16x32_bf16 v[40:43], a[184:187], a[232:235], v[40:43]
  v_max_f32 v212, 0, v212
  v_cvt_pk_bf16_f32 v210, v211, v210
  v_cvt_pk_bf16_f32 v212, v213, v212
  v_mfma_f32_16x16x32_bf16 v[60:63], a[232:235], a[188:191], v[60:63]
  v_lshlrev_b32 v211, 16, v210
  v_lshlrev_b32 v213, 16, v212
  v_and_b32 v210, 0xffff0000, v210
  v_and_b32 v212, 0xffff0000, v212
  v_mfma_f32_16x16x32_bf16 v[4:7], a[180:183], a[216:219], v[4:7]
  v_add_f32 v210, 0x3727c5ac, v210
  v_add_f32 v212, 0x3727c5ac, v212
  v_cvt_pk_bf16_f32 v210, v210, v210
  v_cvt_pk_bf16_f32 v212, v212, v212
  v_mfma_f32_16x16x32_bf16 v[24:27], a[184:187], a[216:219], v[24:27]
  v_and_b32 v210, 0xffff0000, v210
  v_and_b32 v212, 0xffff0000, v212
  v_sqrt_f32 v210, v210
  v_mfma_f32_16x16x32_bf16 v[44:47], a[216:219], a[188:191], v[44:47]
  v_sqrt_f32 v212, v212
  v_cvt_pk_bf16_f32 v210, v210, v210
  v_mfma_f32_16x16x32_bf16 v[8:11], a[180:183], a[220:223], v[8:11]
  v_cvt_pk_bf16_f32 v212, v212, v212
  v_and_b32 v210, 0xffff0000, v210
  v_and_b32 v212, 0xffff0000, v212
  v_mfma_f32_16x16x32_bf16 v[28:31], a[184:187], a[220:223], v[28:31]
  v_rcp_f32 v210, v210
  v_rcp_f32 v212, v212
  v_mfma_f32_16x16x32_bf16 v[48:51], a[220:223], a[188:191], v[48:51]
  v_mul_f32 v211, -v211, v210
  v_mul_f32 v213, -v213, v212
  ds_write_b64 v171, v[210:211]
  s_waitcnt lgkmcnt(2)
  v_mfma_f32_16x16x32_bf16 v[12:15], a[180:183], a[224:227], v[12:15]
  ds_write_b64 v173, v[212:213]
  ds_write2_b32 v172, v210, v211 offset0:0 offset1:80
  v_mfma_f32_16x16x32_bf16 v[32:35], a[184:187], a[224:227], v[32:35]
  ds_write2_b32 v174, v212, v213 offset0:0 offset1:80
  v_mfma_f32_16x16x32_bf16 v[52:55], a[224:227], a[188:191], v[52:55]
  s_waitcnt vmcnt(18) lgkmcnt(0)
  s_barrier
  v_mfma_f32_16x16x32_bf16 v[16:19], a[180:183], a[228:231], v[16:19]
  ds_read_b64 v[184:185], v175 offset:512
  v_mfma_f32_16x16x32_bf16 v[36:39], a[184:187], a[228:231], v[36:39]
  ds_read_b64 v[176:177], v175 offset:0
  ds_read_b64 v[178:179], v175 offset:128
  v_mfma_f32_16x16x32_bf16 v[56:59], a[228:231], a[188:191], v[56:59]
  ds_read_b64 v[180:181], v175 offset:256
  ds_read_b64 v[182:183], v175 offset:384
  v_lshlrev_b32 v171, 4, v164
  v_add_u32 v171, 139904, v171
  ds_read_b128 v[210:213], v171 offset:256
  ds_read_b128 v[214:217], v171 offset:576
  s_waitcnt vmcnt(9)
  ds_read_b128 v[218:221], v171 offset:0
  ds_read_b128 v[222:225], v171 offset:320
  s_mov_b32 s82, 0x3eb8aa3b
  s_mov_b32 s83, 0x3eb8aa3b
  v_mov_b32_dpp v226, v20 row_newbcast:0 row_mask:0xf bank_mask:0xf
  v_mov_b32_dpp v230, v40 row_newbcast:0 row_mask:0xf bank_mask:0xf
  v_mov_b32_dpp v227, v21 row_newbcast:0 row_mask:0xf bank_mask:0xf
  v_mov_b32_dpp v231, v41 row_newbcast:0 row_mask:0xf bank_mask:0xf
  s_add_u32 m0, s62, 49152
  s_add_u32 s60, s60, 128
  s_bitset0_b32 s60, 10
  buffer_load_dwordx4 v128, s[28:31], s60 offen lds
  v_mov_b32_dpp v228, v22 row_newbcast:0 row_mask:0xf bank_mask:0xf
  v_mov_b32_dpp v232, v42 row_newbcast:0 row_mask:0xf bank_mask:0xf
  v_mov_b32_dpp v229, v23 row_newbcast:0 row_mask:0xf bank_mask:0xf
  v_mov_b32_dpp v233, v43 row_newbcast:0 row_mask:0xf bank_mask:0xf
  v_mov_b32 v234, v60
  s_add_u32 m0, s62, 53248
  s_add_u32 s60, s60, 128
  s_bitset0_b32 s60, 10
  buffer_load_dwordx4 v128, s[28:31], s60 offen lds
  v_mov_b32 v235, v60
  s_waitcnt lgkmcnt(8)
  v_pk_mul_f32 v[194:195], v[184:185], v[230:231] op_sel:[1,0] op_sel_hi:[1,1]
  v_pk_mul_f32 v[196:197], v[184:185], v[232:233] op_sel:[1,0] op_sel_hi:[1,1]
  v_pk_fma_f32 v[194:195], v[184:185], v[40:41], v[194:195] op_sel:[0,0,0] op_sel_hi:[0,1,1]
  v_pk_fma_f32 v[196:197], v[184:185], v[42:43], v[196:197] op_sel:[0,0,0] op_sel_hi:[0,1,1]
  s_add_u32 m0, s62, 57344
  s_add_u32 s60, s60, 128
  s_bitset0_b32 s60, 10
  buffer_load_dwordx4 v128, s[28:31], s60 offen lds
  v_cvt_pk_bf16_f32 v236, v194, v195
  v_cvt_pk_bf16_f32 v237, v196, v197
  v_permlane32_swap_b32 v234, v235
  s_waitcnt lgkmcnt(7)
  v_pk_mul_f32 v[194:195], v[176:177], v[230:231] op_sel:[1,0] op_sel_hi:[1,1]
  s_waitcnt lgkmcnt(2)
  v_pk_mul_f32 v[198:199], v[214:215], v[234:235] op_sel_hi:[1,0]
  s_add_u32 m0, s62, 61440
  s_add_u32 s60, s60, 128
  s_bitset0_b32 s60, 10
  buffer_load_dwordx4 v128, s[28:31], s60 offen lds
  v_pk_mul_f32 v[196:197], v[176:177], v[232:233] op_sel:[1,0] op_sel_hi:[1,1]
  v_pk_mul_f32 v[200:201], v[216:217], v[234:235] op_sel_hi:[1,0]
  v_pk_fma_f32 v[194:195], v[176:177], v[24:25], v[194:195] op_sel:[0,0,0] op_sel_hi:[0,1,1]
  v_pk_fma_f32 v[198:199], v[210:211], v[60:61], v[198:199]
  v_pk_fma_f32 v[196:197], v[176:177], v[26:27], v[196:197] op_sel:[0,0,0] op_sel_hi:[0,1,1]
  s_add_u32 s11, s23, 65536
  s_sub_u32 s5, s11, 458752
  s_min_u32 s11, s11, s5
  s_add_u32 m0, s10, 98304
  s_nop 0
  buffer_load_dwordx4 v158, s[48:51], s11 offen offset:0 lds
  v_pk_fma_f32 v[200:201], v[212:213], v[62:63], v[200:201]
  v_cvt_pk_bf16_f32 v24, v194, v195
  v_cvt_pk_bf16_f32 v240, v198, v199
  v_cvt_pk_bf16_f32 v25, v196, v197
  v_cvt_pk_bf16_f32 v241, v200, v201
  buffer_load_dwordx4 v159, s[48:51], s11 offen offset:1024 lds
  ds_read_b128 v[210:213], v171 offset:64
  ds_read_b128 v[214:217], v171 offset:384
  v_pk_mul_f32 v[194:195], v[176:177], v[226:227] op_sel:[1,0] op_sel_hi:[1,1]
  s_waitcnt lgkmcnt(2)
  v_pk_mul_f32 v[198:199], v[222:223], v[234:235] op_sel_hi:[1,0]
  v_pk_mul_f32 v[196:197], v[176:177], v[228:229] op_sel:[1,0] op_sel_hi:[1,1]
  buffer_load_dwordx4 v160, s[48:51], s11 offen offset:2048 lds
  v_pk_mul_f32 v[200:201], v[224:225], v[234:235] op_sel_hi:[1,0]
  v_pk_fma_f32 v[194:195], v[176:177], v[4:5], v[194:195] op_sel:[0,0,0] op_sel_hi:[0,1,1]
  v_pk_fma_f32 v[198:199], v[218:219], v[44:45], v[198:199]
  v_pk_fma_f32 v[196:197], v[176:177], v[6:7], v[196:197] op_sel:[0,0,0] op_sel_hi:[0,1,1]
  v_pk_fma_f32 v[200:201], v[220:221], v[46:47], v[200:201]
  buffer_load_dwordx4 v161, s[48:51], s11 offen offset:3072 lds
  v_cvt_pk_bf16_f32 v4, v194, v195
  v_cvt_pk_bf16_f32 v242, v198, v199
  v_cvt_pk_bf16_f32 v5, v196, v197
  v_cvt_pk_bf16_f32 v243, v200, v201
  ds_read_b128 v[218:221], v171 offset:128
  ds_read_b64_tr_b16 v[112:113], v154 offset:16384
  ds_read_b128 v[222:225], v171 offset:448
  v_pk_mul_f32 v[194:195], v[178:179], v[230:231] op_sel:[1,0] op_sel_hi:[1,1]
  s_waitcnt lgkmcnt(3)
  v_pk_mul_f32 v[198:199], v[214:215], v[234:235] op_sel_hi:[1,0]
  v_pk_mul_f32 v[196:197], v[178:179], v[232:233] op_sel:[1,0] op_sel_hi:[1,1]
  v_pk_mul_f32 v[200:201], v[216:217], v[234:235] op_sel_hi:[1,0]
  ds_read_b64_tr_b16 v[114:115], v154 offset:16896
  v_pk_fma_f32 v[194:195], v[178:179], v[28:29], v[194:195] op_sel:[0,0,0] op_sel_hi:[0,1,1]
  v_pk_fma_f32 v[198:199], v[210:211], v[48:49], v[198:199]
  v_pk_fma_f32 v[196:197], v[178:179], v[30:31], v[196:197] op_sel:[0,0,0] op_sel_hi:[0,1,1]
  v_pk_fma_f32 v[200:201], v[212:213], v[50:51], v[200:201]
  v_cvt_pk_bf16_f32 v238, v194, v195
  ds_read_b64_tr_b16 v[116:117], v155 offset:16384
  v_cvt_pk_bf16_f32 v244, v198, v199
  v_cvt_pk_bf16_f32 v239, v196, v197
  v_cvt_pk_bf16_f32 v245, v200, v201
  ds_read_b128 v[210:213], v171 offset:192
  ds_read_b128 v[214:217], v171 offset:512
  ds_read_b64_tr_b16 v[118:119], v155 offset:16896
  v_pk_mul_f32 v[194:195], v[178:179], v[226:227] op_sel:[1,0] op_sel_hi:[1,1]
  v_pk_mul_f32 v[196:197], v[178:179], v[228:229] op_sel:[1,0] op_sel_hi:[1,1]
  v_pk_fma_f32 v[194:195], v[178:179], v[8:9], v[194:195] op_sel:[0,0,0] op_sel_hi:[0,1,1]
  v_pk_fma_f32 v[196:197], v[178:179], v[10:11], v[196:197] op_sel:[0,0,0] op_sel_hi:[0,1,1]
  v_cvt_pk_bf16_f32 v8, v194, v195
  ds_read_b64_tr_b16 v[120:121], v156 offset:16384
  v_cvt_pk_bf16_f32 v9, v196, v197
  v_mfma_f32_16x16x16_bf16 v[44:47], v[236:237], v[4:5], v[186:189]
  v_mfma_f32_16x16x16_bf16 v[202:205], v[24:25], v[4:5], v[246:249]
  v_mfma_f32_16x16x16_bf16 v[48:51], v[24:25], v[8:9], v[250:253]
  v_mfma_f32_16x16x16_bf16 v[206:209], v[238:239], v[8:9], v[246:249]
  ds_read_b64_tr_b16 v[122:123], v156 offset:16896
  s_nop 4
  v_max_f32 v44, v44, v202
  v_max_f32 v45, v45, v203
  v_max_f32 v46, v46, v204
  v_max_f32 v47, v47, v205
  v_max_f32 v48, v48, v206
  ds_read_b64_tr_b16 v[124:125], v157 offset:16384
  v_max_f32 v49, v49, v207
  v_max_f32 v50, v50, v208
  v_max_f32 v51, v51, v209
  v_max3_f32 v6, v44, v45, v46
  v_max3_f32 v10, v48, v49, v50
  ds_read_b64_tr_b16 v[126:127], v157 offset:16896
  v_max_f32 v6, v6, v47
  v_max_f32 v10, v10, v51
  v_mov_b32 v7, v6
  v_mov_b32 v11, v10
  s_nop 0
  v_permlane32_swap_b32 v6, v7
  s_waitcnt lgkmcnt(0)
  s_add_u32 s11, s23, 196608
  s_sub_u32 s5, s11, 458752
  s_min_u32 s11, s11, s5
  s_add_u32 m0, s10, 147456
  s_nop 0
  buffer_load_dwordx4 v158, s[48:51], s11 offen offset:0 lds
  v_permlane32_swap_b32 v10, v11
  v_max_f32 v6, v6, v7
  v_max_f32 v10, v10, v11
  v_mov_b32 v7, v6
  v_mov_b32 v11, v10
  buffer_load_dwordx4 v159, s[48:51], s11 offen offset:1024 lds
  v_permlane16_swap_b32 v6, v7
  v_permlane16_swap_b32 v10, v11
  v_max_f32 v6, v6, v7
  v_max_f32 v10, v10, v11
  v_mul_f32 v6, s82, v6
  buffer_load_dwordx4 v160, s[48:51], s11 offen offset:2048 lds
  v_mul_f32 v10, s82, v10
  v_pk_fma_f32 v[44:45], v[44:45], s[82:83], v[6:7] op_sel_hi:[1,1,0] neg_lo:[0,0,1] neg_hi:[0,0,1]
  v_pk_fma_f32 v[46:47], v[46:47], s[82:83], v[6:7] op_sel_hi:[1,1,0] neg_lo:[0,0,1] neg_hi:[0,0,1]
  v_pk_fma_f32 v[48:49], v[48:49], s[82:83], v[10:11] op_sel_hi:[1,1,0] neg_lo:[0,0,1] neg_hi:[0,0,1]
  v_pk_fma_f32 v[50:51], v[50:51], s[82:83], v[10:11] op_sel_hi:[1,1,0] neg_lo:[0,0,1] neg_hi:[0,0,1]
  buffer_load_dwordx4 v161, s[48:51], s11 offen offset:3072 lds
  v_exp_f32 v44, v44
  v_exp_f32 v45, v45
  v_exp_f32 v46, v46
  v_exp_f32 v47, v47
  v_exp_f32 v48, v48
  ds_read_b128 a[192:195], v134 offset:0
  v_exp_f32 v49, v49
  v_exp_f32 v50, v50
  v_exp_f32 v51, v51
  v_cvt_pk_bf16_f32 v26, v44, v45
  v_cvt_pk_bf16_f32 v27, v46, v47
  ds_read_b128 a[196:199], v134 offset:2048
  v_cvt_pk_bf16_f32 v30, v48, v49
  v_cvt_pk_bf16_f32 v31, v50, v51
  v_and_b32 v24, v254, v26
  v_and_b32 v25, v255, v27
  v_and_b32 v28, v254, v30
  ds_read_b128 a[200:203], v135 offset:0
  v_and_b32 v29, v255, v31
  v_xor_b32 v26, v26, v24
  v_xor_b32 v27, v27, v25
  v_xor_b32 v30, v30, v28
  v_xor_b32 v31, v31, v29
  ds_read_b128 a[204:207], v135 offset:2048
  v_mfma_f32_16x16x32_bf16 v[202:205], v[76:79], v[24:27], 0
  v_mfma_f32_16x16x32_bf16 v[44:47], v[240:243], v[24:27], 0
  v_mfma_f32_16x16x32_bf16 v[206:209], v[76:79], v[28:31], 0
  v_mfma_f32_16x16x32_bf16 v[48:51], v[242:245], v[28:31], 0
  s_nop 4
  v_rcp_f32 v202, v202
  ds_read_b128 a[208:211], v134 offset:4096
  v_rcp_f32 v206, v206
  v_pk_mul_f32 v[44:45], v[44:45], v[202:203] op_sel_hi:[1,0]
  v_pk_mul_f32 v[46:47], v[46:47], v[202:203] op_sel_hi:[1,0]
  v_pk_mul_f32 v[48:49], v[48:49], v[206:207] op_sel_hi:[1,0]
  ds_read_b128 a[212:215], v134 offset:6144
  v_pk_mul_f32 v[50:51], v[50:51], v[206:207] op_sel_hi:[1,0]
  v_cvt_pk_bf16_f32 v194, v44, v45
  v_cvt_pk_bf16_f32 v196, v48, v49
  v_cvt_pk_bf16_f32 v195, v46, v47
  v_cvt_pk_bf16_f32 v197, v50, v51
  v_permlane16_swap_b32 v194, v196
  s_nop 0
  v_permlane16_swap_b32 v195, v197
  s_add_u32 s69, s78, 0
  buffer_store_dwordx4 v[194:197], v163, s[36:39], s69 offen sc1
  s_waitcnt lgkmcnt(5)
  v_mfma_f32_16x16x32_bf16 v[4:7], a[0:3], a[192:195], 0
  ds_read_b128 a[216:219], v135 offset:4096
  v_mov_b32 v240, v244
  v_mfma_f32_16x16x32_bf16 v[24:27], a[4:7], a[192:195], 0
  ds_read_b128 a[220:223], v135 offset:6144
  v_mov_b32 v241, v245
  v_mfma_f32_16x16x32_bf16 v[44:47], a[192:195], a[8:11], 0
  v_mov_b32 v64, -1
  v_pk_mul_f32 v[194:195], v[180:181], v[230:231] op_sel:[1,0] op_sel_hi:[1,1]
  v_pk_mul_f32 v[198:199], v[222:223], v[234:235] op_sel_hi:[1,0]
  v_pk_mul_f32 v[196:197], v[180:181], v[232:233] op_sel:[1,0] op_sel_hi:[1,1]
  v_pk_mul_f32 v[200:201], v[224:225], v[234:235] op_sel_hi:[1,0]
  v_pk_fma_f32 v[194:195], v[180:181], v[32:33], v[194:195] op_sel:[0,0,0] op_sel_hi:[0,1,1]
  v_pk_fma_f32 v[198:199], v[218:219], v[52:53], v[198:199]
  v_pk_fma_f32 v[196:197], v[180:181], v[34:35], v[196:197] op_sel:[0,0,0] op_sel_hi:[0,1,1]
  v_pk_fma_f32 v[200:201], v[220:221], v[54:55], v[200:201]
  s_waitcnt lgkmcnt(6)
  v_mfma_f32_16x16x32_bf16 v[8:11], a[0:3], a[196:199], 0
  s_waitcnt lgkmcnt(4)
  v_cvt_pk_bf16_f32 v32, v194, v195
  v_cvt_pk_bf16_f32 v242, v198, v199
  v_mfma_f32_16x16x32_bf16 v[28:31], a[4:7], a[196:199], 0
  s_lshr_b32 s77, s23, 5
  v_cvt_pk_bf16_f32 v33, v196, v197
  v_cvt_pk_bf16_f32 v243, v200, v201
  v_mfma_f32_16x16x32_bf16 v[48:51], a[196:199], a[8:11], 0
  s_add_u32 s11, s23, 98304
  s_sub_u32 s5, s11, 458752
  s_min_u32 s11, s11, s5
  v_pk_mul_f32 v[194:195], v[180:181], v[226:227] op_sel:[1,0] op_sel_hi:[1,1]
  v_pk_mul_f32 v[196:197], v[180:181], v[228:229] op_sel:[1,0] op_sel_hi:[1,1]
  v_pk_fma_f32 v[194:195], v[180:181], v[12:13], v[194:195] op_sel:[0,0,0] op_sel_hi:[0,1,1]
  v_pk_fma_f32 v[196:197], v[180:181], v[14:15], v[196:197] op_sel:[0,0,0] op_sel_hi:[0,1,1]
  v_mfma_f32_16x16x32_bf16 v[4:7], a[12:15], a[200:203], v[4:7]
  s_add_u32 m0, s10, 114688
  buffer_load_dword v168, v166, s[16:19], s22 offen sc1
  v_mfma_f32_16x16x32_bf16 v[24:27], a[16:19], a[200:203], v[24:27]
  s_add_u32 s59, s77, 0
  v_cvt_pk_bf16_f32 v12, v194, v195
  v_cvt_pk_bf16_f32 v13, v196, v197
  v_pk_mul_f32 v[194:195], v[182:183], v[230:231] op_sel:[1,0] op_sel_hi:[1,1]
  v_pk_mul_f32 v[198:199], v[214:215], v[234:235] op_sel_hi:[1,0]
  v_pk_mul_f32 v[196:197], v[182:183], v[232:233] op_sel:[1,0] op_sel_hi:[1,1]
  v_pk_mul_f32 v[200:201], v[216:217], v[234:235] op_sel_hi:[1,0]
  v_pk_fma_f32 v[194:195], v[182:183], v[36:37], v[194:195] op_sel:[0,0,0] op_sel_hi:[0,1,1]
  v_pk_fma_f32 v[198:199], v[210:211], v[56:57], v[198:199]
  v_pk_fma_f32 v[196:197], v[182:183], v[38:39], v[196:197] op_sel:[0,0,0] op_sel_hi:[0,1,1]
  v_pk_fma_f32 v[200:201], v[212:213], v[58:59], v[200:201]
  v_mfma_f32_16x16x32_bf16 v[44:47], a[200:203], a[20:23], v[44:47]
  ds_read_b128 a[192:195], v134 offset:8192
  v_cvt_pk_bf16_f32 v236, v194, v195
  v_mfma_f32_16x16x32_bf16 v[8:11], a[12:15], a[204:207], v[8:11]
  s_waitcnt lgkmcnt(3)
  buffer_load_dwordx4 v158, s[48:51], s11 offen offset:0 lds
  v_mfma_f32_16x16x32_bf16 v[28:31], a[16:19], a[204:207], v[28:31]
  s_sub_u32 s60, s59, 14336
  buffer_load_dwordx4 v159, s[48:51], s11 offen offset:1024 lds
  v_mfma_f32_16x16x32_bf16 v[48:51], a[204:207], a[20:23], v[48:51]
  s_min_u32 s59, s59, s60
  v_mov_b32 v65, -1
  v_cvt_pk_bf16_f32 v244, v198, v199
  v_mfma_f32_16x16x32_bf16 v[4:7], a[24:27], a[208:211], v[4:7]
  s_add_u32 s60, s77, 1024
  buffer_load_dwordx4 v160, s[48:51], s11 offen offset:2048 lds
  v_mfma_f32_16x16x32_bf16 v[24:27], a[28:31], a[208:211], v[24:27]
  ds_read_b128 a[196:199], v134 offset:10240
  v_cvt_pk_bf16_f32 v237, v196, v197
  v_mfma_f32_16x16x32_bf16 v[44:47], a[208:211], a[32:35], v[44:47]
  s_sub_u32 s61, s60, 14336
  buffer_load_dwordx4 v161, s[48:51], s11 offen offset:3072 lds
  v_mfma_f32_16x16x32_bf16 v[8:11], a[24:27], a[212:215], v[8:11]
  s_waitcnt lgkmcnt(2)
  v_cvt_pk_bf16_f32 v245, v200, v201
  v_mov_b32 v66, -1
  v_pk_mul_f32 v[194:195], v[182:183], v[226:227] op_sel:[1,0] op_sel_hi:[1,1]
  v_pk_mul_f32 v[196:197], v[182:183], v[228:229] op_sel:[1,0] op_sel_hi:[1,1]
  v_pk_fma_f32 v[194:195], v[182:183], v[16:17], v[194:195] op_sel:[0,0,0] op_sel_hi:[0,1,1]
  v_pk_fma_f32 v[196:197], v[182:183], v[18:19], v[196:197] op_sel:[0,0,0] op_sel_hi:[0,1,1]
  v_mfma_f32_16x16x32_bf16 v[28:31], a[28:31], a[212:215], v[28:31]
  s_waitcnt vmcnt(18)
  ds_read_b64_tr_b16 v[80:81], v150 offset:0
  v_mfma_f32_16x16x32_bf16 v[48:51], a[212:215], a[32:35], v[48:51]
  s_min_u32 s60, s60, s61
  v_cvt_pk_bf16_f32 v16, v194, v195
  v_cvt_pk_bf16_f32 v17, v196, v197
  v_mfma_f32_16x16x32_bf16 v[4:7], a[36:39], a[216:219], v[4:7]
  s_add_u32 s61, s77, 2048
  ds_read_b64_tr_b16 v[82:83], v150 offset:512
  v_mfma_f32_16x16x16_bf16 v[52:55], v[238:239], v[12:13], v[250:253]
  s_sub_u32 s62, s61, 14336
  ds_read_b128 a[200:203], v135 offset:8192
  v_mfma_f32_16x16x16_bf16 v[202:205], v[32:33], v[12:13], v[246:249]
  ds_read_b64_tr_b16 v[84:85], v151 offset:0
  v_mov_b32 v67, -1
  v_mfma_f32_16x16x16_bf16 v[56:59], v[32:33], v[16:17], v[250:253]
  s_min_u32 s61, s61, s62
  ds_read_b64_tr_b16 v[86:87], v151 offset:512
  v_mfma_f32_16x16x32_bf16 v[24:27], a[40:43], a[216:219], v[24:27]
  s_add_u32 s62, s77, 3072
  ds_read_b64_tr_b16 v[88:89], v152 offset:0
  v_mfma_f32_16x16x32_bf16 v[44:47], a[216:219], a[44:47], v[44:47]
  s_sub_u32 s63, s62, 14336
  ds_read_b128 a[204:207], v135 offset:10240
  v_mfma_f32_16x16x32_bf16 v[8:11], a[36:39], a[220:223], v[8:11]
  s_waitcnt lgkmcnt(7)
  ds_read_b64_tr_b16 v[90:91], v152 offset:512
  v_mfma_f32_16x16x16_bf16 v[206:209], v[236:237], v[16:17], v[246:249]
  s_min_u32 s62, s62, s63
  ds_read_b64_tr_b16 v[92:93], v153 offset:0
  v_mfma_f32_16x16x32_bf16 v[28:31], a[40:43], a[220:223], v[28:31]
  ds_read_b64_tr_b16 v[94:95], v153 offset:512
  s_waitcnt lgkmcnt(0)
  v_mfma_f32_16x16x32_bf16 v[48:51], a[220:223], a[44:47], v[48:51]
  ds_read_b128 a[208:211], v134 offset:12288
  s_add_u32 s63, s77, 4096
  v_mfma_f32_16x16x32_bf16 v[4:7], a[48:51], a[192:195], v[4:7]
  s_add_u32 s11, s23, 131072
  s_sub_u32 s5, s11, 458752
  s_min_u32 s11, s11, s5
  v_mfma_f32_16x16x32_bf16 v[24:27], a[52:55], a[192:195], v[24:27]
  s_add_u32 m0, s10, 65536
  ds_read_b128 a[212:215], v134 offset:14336
  v_mfma_f32_16x16x32_bf16 v[44:47], a[192:195], a[56:59], v[44:47]
  s_sub_u32 s64, s63, 14336
  buffer_load_dwordx4 v158, s[48:51], s11 offen offset:0 lds
  v_mfma_f32_16x16x32_bf16 v[8:11], a[48:51], a[196:199], v[8:11]
  buffer_load_dwordx4 v159, s[48:51], s11 offen offset:1024 lds
  v_mfma_f32_16x16x32_bf16 v[28:31], a[52:55], a[196:199], v[28:31]
  s_min_u32 s63, s63, s64
  buffer_load_dwordx4 v160, s[48:51], s11 offen offset:2048 lds
  v_mfma_f32_16x16x32_bf16 v[48:51], a[196:199], a[56:59], v[48:51]
  ds_read_b128 a[216:219], v135 offset:12288
  v_max_f32 v52, v52, v202
  v_mfma_f32_16x16x32_bf16 v[4:7], a[60:63], a[200:203], v[4:7]
  s_add_u32 s64, s77, 5120
  buffer_load_dwordx4 v161, s[48:51], s11 offen offset:3072 lds
  s_add_u32 s69, s78, 245760
  buffer_store_dwordx4 v[64:67], v163, s[36:39], s69 offen sc1
  v_mfma_f32_16x16x32_bf16 v[24:27], a[64:67], a[200:203], v[24:27]
  s_sub_u32 s65, s64, 14336
  ds_read_b64_tr_b16 v[96:97], v150 offset:16384
  v_max_f32 v53, v53, v203
  v_max_f32 v54, v54, v204
  v_mfma_f32_16x16x32_bf16 v[44:47], a[200:203], a[68:71], v[44:47]
  ds_read_b64_tr_b16 v[98:99], v150 offset:16896
  ds_read_b128 a[220:223], v135 offset:14336
  v_max_f32 v55, v55, v205
  v_mfma_f32_16x16x32_bf16 v[8:11], a[60:63], a[204:207], v[8:11]
  ds_read_b64_tr_b16 v[100:101], v151 offset:16384
  v_max_f32 v56, v56, v206
  v_mfma_f32_16x16x32_bf16 v[28:31], a[64:67], a[204:207], v[28:31]
  s_waitcnt lgkmcnt(5)
  v_max_f32 v57, v57, v207
  v_max_f32 v58, v58, v208
  v_mfma_f32_16x16x32_bf16 v[48:51], a[204:207], a[68:71], v[48:51]
  ds_read_b64_tr_b16 v[102:103], v151 offset:16896
  v_max_f32 v59, v59, v209
  v_mfma_f32_16x16x32_bf16 v[4:7], a[72:75], a[208:211], v[4:7]
  ds_read_b64_tr_b16 v[104:105], v152 offset:16384
  v_max3_f32 v14, v52, v53, v54
  v_mfma_f32_16x16x32_bf16 v[24:27], a[76:79], a[208:211], v[24:27]
  ds_read_b128 a[192:195], v134 offset:16384
  ds_read_b64_tr_b16 v[106:107], v152 offset:16896
  v_max3_f32 v18, v56, v57, v58
  s_add_u32 s4, s24, 1
  s_waitcnt vmcnt(9)
  v_subrev_u32 v1, s4, v168
  v_cmp_lt_u32 vcc, 4, v1
  s_nop 0
  s_and_b32 s4, vcc_lo, 0xffff
  s_cbranch_scc1 L_sta
L_staok:
  v_mfma_f32_16x16x32_bf16 v[44:47], a[208:211], a[80:83], v[44:47]
  ds_read_b64_tr_b16 v[108:109], v153 offset:16384
  ds_read_b128 a[196:199], v134 offset:18432
  v_max_f32 v14, v14, v55
  v_lshlrev_b32 v172, 1, v166
  v_lshlrev_b32 v173, 4, v164
  v_mfma_f32_16x16x32_bf16 v[8:11], a[72:75], a[212:215], v[8:11]
  ds_read_b64_tr_b16 v[110:111], v153 offset:16896
  v_max_f32 v18, v18, v59
  v_mfma_f32_16x16x32_bf16 v[28:31], a[76:79], a[212:215], v[28:31]
  s_waitcnt lgkmcnt(0)
  v_mov_b32 v15, v14
  v_mov_b32 v19, v18
  s_add_u32 s11, s23, 163840
  s_sub_u32 s5, s11, 458752
  s_min_u32 s11, s11, s5
  v_mfma_f32_16x16x32_bf16 v[48:51], a[212:215], a[80:83], v[48:51]
  v_permlane32_swap_b32 v14, v15
  v_mfma_f32_16x16x32_bf16 v[4:7], a[84:87], a[216:219], v[4:7]
  s_add_u32 m0, s10, 81920
  ds_read_b128 a[200:203], v135 offset:16384
  buffer_load_dwordx4 v158, s[48:51], s11 offen offset:0 lds
  buffer_load_dwordx2 v[186:187], v172, s[16:19], s57 offen offset:0 sc1
  v_mfma_f32_16x16x32_bf16 v[24:27], a[88:91], a[216:219], v[24:27]
  s_min_u32 s64, s64, s65
  buffer_load_dwordx4 v159, s[48:51], s11 offen offset:1024 lds
  buffer_load_dwordx2 v[188:189], v172, s[16:19], s57 offen offset:128 sc1
  v_permlane32_swap_b32 v18, v19
  v_mfma_f32_16x16x32_bf16 v[44:47], a[216:219], a[92:95], v[44:47]
  s_add_u32 s65, s77, 6144
  buffer_load_dwordx4 v160, s[48:51], s11 offen offset:2048 lds
  ds_read_b128 a[204:207], v135 offset:18432
  buffer_load_dwordx2 v[190:191], v172, s[16:19], s57 offen offset:256 sc1
  v_max_f32 v14, v14, v15
  v_max_f32 v18, v18, v19
  v_mfma_f32_16x16x32_bf16 v[8:11], a[84:87], a[220:223], v[8:11]
  s_sub_u32 s66, s65, 14336
  buffer_load_dwordx4 v161, s[48:51], s11 offen offset:3072 lds
  buffer_load_dwordx2 v[192:193], v172, s[16:19], s57 offen offset:384 sc1
  v_mfma_f32_16x16x32_bf16 v[28:31], a[88:91], a[220:223], v[28:31]
  ds_read_b64_tr_b16 a[240:241], v150 offset:32768
  buffer_load_dwordx4 v[210:213], v173, s[16:19], s57 offen offset:512 sc1
  v_mov_b32 v15, v14
  v_mov_b32 v19, v18
  v_mfma_f32_16x16x32_bf16 v[48:51], a[220:223], a[92:95], v[48:51]
  s_min_u32 s65, s65, s66
  s_add_u32 s69, s78, 368640
  buffer_store_dwordx4 v[64:67], v163, s[36:39], s69 offen sc1
  buffer_load_dwordx4 v[214:217], v173, s[16:19], s57 offen offset:768 sc1
  v_permlane16_swap_b32 v14, v15
  v_mfma_f32_16x16x32_bf16 v[4:7], a[96:99], a[192:195], v[4:7]
  s_add_u32 s66, s77, 7168
  ds_read_b64_tr_b16 a[242:243], v150 offset:33280
  buffer_load_dwordx4 v[218:221], v173, s[16:19], s57 offen offset:576 sc1
  v_mfma_f32_16x16x32_bf16 v[24:27], a[100:103], a[192:195], v[24:27]
  s_sub_u32 s67, s66, 14336
  ds_read_b128 a[208:211], v134 offset:20480
  ds_read_b64_tr_b16 a[244:245], v151 offset:32768
  buffer_load_dwordx4 v[222:225], v173, s[16:19], s57 offen offset:832 sc1
  v_permlane16_swap_b32 v18, v19
  v_mfma_f32_16x16x32_bf16 v[44:47], a[192:195], a[104:107], v[44:47]
  ds_read_b64_tr_b16 a[246:247], v151 offset:33280
  ds_read_b128 a[212:215], v134 offset:22528
  v_max_f32 v14, v14, v15
  v_mfma_f32_16x16x32_bf16 v[8:11], a[96:99], a[196:199], v[8:11]
  ds_read_b64_tr_b16 a[248:249], v152 offset:32768
  s_mov_b64 exec, 1
  ds_add_rtn_u32 v3, v170, v170 offset:8
  s_mov_b64 exec, -1
  v_max_f32 v18, v18, v19
  v_mfma_f32_16x16x32_bf16 v[28:31], a[100:103], a[196:199], v[28:31]
  ds_read_b64_tr_b16 a[250:251], v152 offset:33280
  v_mul_f32 v14, s82, v14
  v_mul_f32 v18, s82, v18
  v_pk_fma_f32 v[52:53], v[52:53], s[82:83], v[14:15] op_sel_hi:[1,1,0] neg_lo:[0,0,1] neg_hi:[0,0,1]
  v_pk_fma_f32 v[54:55], v[54:55], s[82:83], v[14:15] op_sel_hi:[1,1,0] neg_lo:[0,0,1] neg_hi:[0,0,1]
  v_pk_fma_f32 v[56:57], v[56:57], s[82:83], v[18:19] op_sel_hi:[1,1,0] neg_lo:[0,0,1] neg_hi:[0,0,1]
  v_pk_fma_f32 v[58:59], v[58:59], s[82:83], v[18:19] op_sel_hi:[1,1,0] neg_lo:[0,0,1] neg_hi:[0,0,1]
  v_mfma_f32_16x16x32_bf16 v[48:51], a[196:199], a[104:107], v[48:51]
  s_waitcnt lgkmcnt(9)
  ds_read_b64_tr_b16 a[252:253], v153 offset:32768
  v_mfma_f32_16x16x32_bf16 v[4:7], a[108:111], a[200:203], v[4:7]
  s_min_u32 s66, s66, s67
  ds_read_b64_tr_b16 a[254:255], v153 offset:33280
  v_exp_f32 v52, v52
  v_mfma_f32_16x16x32_bf16 v[24:27], a[112:115], a[200:203], v[24:27]
  s_waitcnt lgkmcnt(0)
  ds_read_b128 a[216:219], v135 offset:20480
  v_exp_f32 v53, v53
  s_add_u32 s5, s24, 2
  v_readfirstlane_b32 s4, v3
  v_mov_b32 v3, s5
  s_cmp_eq_u32 s4, 422400
  s_cselect_b32 s4, s20, 1073741824
  s_nop 1
  buffer_store_dword v3, v169, s[16:19], s4 offen sc1
  s_add_u32 s11, s23, 229376
  s_sub_u32 s5, s11, 458752
  s_min_u32 s11, s11, s5
  v_mfma_f32_16x16x32_bf16 v[44:47], a[200:203], a[116:119], v[44:47]
  s_add_u32 s67, s77, 8192
  ds_read_b128 a[220:223], v135 offset:22528
  v_exp_f32 v54, v54
  v_mfma_f32_16x16x32_bf16 v[8:11], a[108:111], a[204:207], v[8:11]
  s_add_u32 m0, s10, 98304
  s_nop 0
  buffer_load_dwordx4 v158, s[48:51], s11 offen offset:0 lds
  s_sub_u32 s68, s67, 14336
  v_mfma_f32_16x16x32_bf16 v[28:31], a[112:115], a[204:207], v[28:31]
  s_min_u32 s67, s67, s68
  buffer_load_dwordx4 v159, s[48:51], s11 offen offset:1024 lds
  v_exp_f32 v55, v55
  v_mfma_f32_16x16x32_bf16 v[48:51], a[204:207], a[116:119], v[48:51]
  s_add_u32 s68, s77, 9216
  buffer_load_dwordx4 v160, s[48:51], s11 offen offset:2048 lds
  v_mfma_f32_16x16x32_bf16 v[4:7], a[120:123], a[208:211], v[4:7]
  s_sub_u32 s70, s68, 14336
  buffer_load_dwordx4 v161, s[48:51], s11 offen offset:3072 lds
  v_exp_f32 v56, v56
  v_mfma_f32_16x16x32_bf16 v[24:27], a[124:127], a[208:211], v[24:27]
  s_min_u32 s68, s68, s70
  ds_read_b128 a[192:195], v134 offset:24576
  s_waitcnt vmcnt(23)
  ds_read_b64_tr_b16 a[224:225], v150 offset:49152
  v_exp_f32 v57, v57
  v_mfma_f32_16x16x32_bf16 v[44:47], a[208:211], a[128:131], v[44:47]
  s_add_u32 s70, s77, 10240
  ds_read_b128 a[196:199], v134 offset:26624
  v_exp_f32 v58, v58
  v_mfma_f32_16x16x32_bf16 v[8:11], a[120:123], a[212:215], v[8:11]
  s_waitcnt lgkmcnt(3)
  ds_read_b64_tr_b16 a[226:227], v150 offset:49664
  v_mfma_f32_16x16x32_bf16 v[28:31], a[124:127], a[212:215], v[28:31]
  s_sub_u32 s71, s70, 14336
  ds_read_b64_tr_b16 a[228:229], v151 offset:49152
  v_exp_f32 v59, v59
  v_mfma_f32_16x16x32_bf16 v[48:51], a[212:215], a[128:131], v[48:51]
  ds_read_b64_tr_b16 a[230:231], v151 offset:49664
  v_cvt_pk_bf16_f32 v34, v52, v53
  v_mfma_f32_16x16x32_bf16 v[4:7], a[132:135], a[216:219], v[4:7]
  ds_read_b64_tr_b16 a[232:233], v152 offset:49152
  v_cvt_pk_bf16_f32 v35, v54, v55
  v_mfma_f32_16x16x32_bf16 v[24:27], a[136:139], a[216:219], v[24:27]
  ds_read_b128 a[200:203], v135 offset:24576
  ds_read_b64_tr_b16 a[234:235], v152 offset:49664
  v_cvt_pk_bf16_f32 v38, v56, v57
  v_mfma_f32_16x16x32_bf16 v[44:47], a[216:219], a[140:143], v[44:47]
  ds_read_b64_tr_b16 a[236:237], v153 offset:49152
  ds_read_b128 a[204:207], v135 offset:26624
  v_cvt_pk_bf16_f32 v39, v58, v59
  v_mfma_f32_16x16x32_bf16 v[8:11], a[132:135], a[220:223], v[8:11]
  ds_read_b64_tr_b16 a[238:239], v153 offset:49664
  v_and_b32 v32, v254, v34
  v_and_b32 v33, v255, v35
  v_mfma_f32_16x16x32_bf16 v[28:31], a[136:139], a[220:223], v[28:31]
  s_min_u32 s70, s70, s71
  v_and_b32 v36, v254, v38
  s_waitcnt lgkmcnt(0)
  s_add_u32 s11, s23, 262144
  s_sub_u32 s5, s11, 458752
  s_min_u32 s11, s11, s5
  v_mfma_f32_16x16x32_bf16 v[48:51], a[220:223], a[140:143], v[48:51]
  v_and_b32 v37, v255, v39
  s_add_u32 s71, s77, 11264
  v_mfma_f32_16x16x32_bf16 v[4:7], a[144:147], a[192:195], v[4:7]
  s_add_u32 m0, s10, 114688
  s_nop 0
  buffer_load_dwordx4 v158, s[48:51], s11 offen offset:0 lds
  v_xor_b32 v34, v34, v32
  v_xor_b32 v35, v35, v33
  v_mfma_f32_16x16x32_bf16 v[24:27], a[148:151], a[192:195], v[24:27]
  s_sub_u32 s72, s71, 14336
  ds_read_b128 a[208:211], v134 offset:28672
  buffer_load_dwordx4 v159, s[48:51], s11 offen offset:1024 lds
  v_xor_b32 v38, v38, v36
  v_mfma_f32_16x16x32_bf16 v[44:47], a[192:195], a[152:155], v[44:47]
  s_min_u32 s71, s71, s72
  buffer_load_dwordx4 v160, s[48:51], s11 offen offset:2048 lds
  ds_read_b128 a[212:215], v134 offset:30720
  v_xor_b32 v39, v39, v37
  s_add_u32 s72, s77, 12288
  v_mfma_f32_16x16x32_bf16 v[8:11], a[144:147], a[196:199], v[8:11]
  buffer_load_dwordx4 v161, s[48:51], s11 offen offset:3072 lds
  ds_read_b128 a[216:219], v135 offset:28672
  ds_read_b128 a[220:223], v135 offset:30720
  v_mfma_f32_16x16x32_bf16 v[202:205], v[76:79], v[32:35], 0
  s_sub_u32 s73, s72, 14336
  s_min_u32 s72, s72, s73
  s_add_u32 s73, s77, 13312
  v_mfma_f32_16x16x32_bf16 v[52:55], v[240:243], v[32:35], 0
  s_sub_u32 s77, s73, 14336
  s_min_u32 s73, s73, s77
  v_mfma_f32_16x16x32_bf16 v[206:209], v[76:79], v[36:39], 0
  v_mfma_f32_16x16x32_bf16 v[28:31], a[148:151], a[196:199], v[28:31]
  v_mfma_f32_16x16x32_bf16 v[48:51], a[196:199], a[152:155], v[48:51]
  s_waitcnt lgkmcnt(0)
  s_barrier
  v_mfma_f32_16x16x32_bf16 v[56:59], v[242:245], v[36:39], 0
  v_mfma_f32_16x16x32_bf16 v[4:7], a[156:159], a[200:203], v[4:7]
  ds_read_b128 a[192:195], v134 offset:32768
  v_mfma_f32_16x16x32_bf16 v[24:27], a[160:163], a[200:203], v[24:27]
  s_add_u32 s11, s23, 294912
  s_sub_u32 s5, s11, 458752
  s_min_u32 s11, s11, s5
  v_mfma_f32_16x16x32_bf16 v[44:47], a[200:203], a[164:167], v[44:47]
  s_add_u32 m0, s10, 0
  v_rcp_f32 v202, v202
  v_mfma_f32_16x16x32_bf16 v[8:11], a[156:159], a[204:207], v[8:11]
  buffer_load_dwordx4 v158, s[48:51], s11 offen offset:0 lds
  v_mfma_f32_16x16x32_bf16 v[28:31], a[160:163], a[204:207], v[28:31]
  ds_read_b128 a[196:199], v134 offset:34816
  v_mfma_f32_16x16x32_bf16 v[48:51], a[204:207], a[164:167], v[48:51]
  buffer_load_dwordx4 v159, s[48:51], s11 offen offset:1024 lds
  v_mfma_f32_16x16x32_bf16 v[4:7], a[168:171], a[208:211], v[4:7]
  v_rcp_f32 v206, v206
  v_pk_mul_f32 v[52:53], v[52:53], v[202:203] op_sel_hi:[1,0]
  v_pk_mul_f32 v[54:55], v[54:55], v[202:203] op_sel_hi:[1,0]
  v_pk_mul_f32 v[56:57], v[56:57], v[206:207] op_sel_hi:[1,0]
  v_pk_mul_f32 v[58:59], v[58:59], v[206:207] op_sel_hi:[1,0]
  v_mfma_f32_16x16x32_bf16 v[24:27], a[172:175], a[208:211], v[24:27]
  buffer_load_dwordx4 v160, s[48:51], s11 offen offset:2048 lds
  v_mfma_f32_16x16x32_bf16 v[44:47], a[208:211], a[176:179], v[44:47]
  buffer_load_dwordx4 v161, s[48:51], s11 offen offset:3072 lds
  v_mfma_f32_16x16x32_bf16 v[8:11], a[168:171], a[212:215], v[8:11]
  v_cvt_pk_bf16_f32 v198, v52, v53
  v_cvt_pk_bf16_f32 v200, v56, v57
  v_mfma_f32_16x16x32_bf16 v[28:31], a[172:175], a[212:215], v[28:31]
  ds_read_b128 a[200:203], v135 offset:32768
  v_cvt_pk_bf16_f32 v199, v54, v55
  v_mfma_f32_16x16x32_bf16 v[48:51], a[212:215], a[176:179], v[48:51]
  s_add_u32 s11, s23, 327680
  s_sub_u32 s5, s11, 458752
  s_min_u32 s11, s11, s5
  v_mfma_f32_16x16x32_bf16 v[4:7], a[180:183], a[216:219], v[4:7]
  s_add_u32 m0, s10, 16384
  v_cvt_pk_bf16_f32 v201, v58, v59
  v_mfma_f32_16x16x32_bf16 v[24:27], a[184:187], a[216:219], v[24:27]
  buffer_load_dwordx4 v158, s[48:51], s11 offen offset:0 lds
  v_mfma_f32_16x16x32_bf16 v[44:47], a[216:219], a[188:191], v[44:47]
  ds_read_b128 a[204:207], v135 offset:34816
  v_permlane16_swap_b32 v198, v200
  v_mfma_f32_16x16x32_bf16 v[8:11], a[180:183], a[220:223], v[8:11]
  s_waitcnt lgkmcnt(2)
  buffer_load_dwordx4 v159, s[48:51], s11 offen offset:1024 lds
  v_mfma_f32_16x16x32_bf16 v[28:31], a[184:187], a[220:223], v[28:31]
  buffer_load_dwordx4 v160, s[48:51], s11 offen offset:2048 lds
  v_mfma_f32_16x16x32_bf16 v[48:51], a[220:223], a[188:191], v[48:51]
  buffer_load_dwordx4 v161, s[48:51], s11 offen offset:3072 lds
  v_permlane16_swap_b32 v199, v201
  v_mfma_f32_16x16x32_bf16 v[12:15], a[0:3], a[192:195], 0
  s_add_u32 s69, s78, 122880
  buffer_store_dwordx4 v[198:201], v163, s[36:39], s69 offen sc1
  v_mfma_f32_16x16x32_bf16 v[32:35], a[4:7], a[192:195], 0
  ds_read_b128 a[208:211], v134 offset:36864
  v_mov_b32 v240, v244
  v_mfma_f32_16x16x32_bf16 v[52:55], a[192:195], a[8:11], 0
  ds_read_b128 a[212:215], v134 offset:38912
  v_mov_b32 v241, v245
  s_waitcnt vmcnt(29)
  v_pk_mul_f32 v[194:195], v[186:187], v[230:231] op_sel:[1,0] op_sel_hi:[1,1]
  s_waitcnt vmcnt(20)
  v_pk_mul_f32 v[198:199], v[214:215], v[234:235] op_sel_hi:[1,0]
  v_pk_mul_f32 v[196:197], v[186:187], v[232:233] op_sel:[1,0] op_sel_hi:[1,1]
  v_pk_mul_f32 v[200:201], v[216:217], v[234:235] op_sel_hi:[1,0]
  v_pk_fma_f32 v[194:195], v[186:187], v[24:25], v[194:195] op_sel:[0,0,0] op_sel_hi:[0,1,1]
  v_pk_fma_f32 v[198:199], v[210:211], v[44:45], v[198:199]
  v_pk_fma_f32 v[196:197], v[186:187], v[26:27], v[196:197] op_sel:[0,0,0] op_sel_hi:[0,1,1]
  v_pk_fma_f32 v[200:201], v[212:213], v[46:47], v[200:201]
  v_mfma_f32_16x16x32_bf16 v[16:19], a[0:3], a[196:199], 0
  s_waitcnt lgkmcnt(2)
  ds_read_b128 a[216:219], v135 offset:36864
  v_mfma_f32_16x16x32_bf16 v[36:39], a[4:7], a[196:199], 0
  v_cvt_pk_bf16_f32 v24, v194, v195
  v_cvt_pk_bf16_f32 v242, v198, v199
  v_mfma_f32_16x16x32_bf16 v[56:59], a[196:199], a[8:11], 0
  ds_read_b128 a[220:223], v135 offset:38912
  v_cvt_pk_bf16_f32 v25, v196, v197
  v_mfma_f32_16x16x32_bf16 v[12:15], a[12:15], a[200:203], v[12:15]
  s_mov_b32 s4, 0x078000ff
  s_mov_b32 s5, 0xf0001c00
  s_lshl_b32 s77, s26, 4
  s_lshr_b64 s[4:5], s[4:5], s77
  s_and_b32 s77, s4, 0xffff
  v_cvt_pk_bf16_f32 v243, v200, v201
  v_lshlrev_b32 v174, 3, v164
  v_pk_mul_f32 v[194:195], v[186:187], v[226:227] op_sel:[1,0] op_sel_hi:[1,1]
  v_pk_mul_f32 v[196:197], v[186:187], v[228:229] op_sel:[1,0] op_sel_hi:[1,1]
  v_pk_fma_f32 v[194:195], v[186:187], v[4:5], v[194:195] op_sel:[0,0,0] op_sel_hi:[0,1,1]
  v_pk_fma_f32 v[196:197], v[186:187], v[6:7], v[196:197] op_sel:[0,0,0] op_sel_hi:[0,1,1]
  v_mfma_f32_16x16x32_bf16 v[32:35], a[16:19], a[200:203], v[32:35]
  v_cvt_pk_bf16_f32 v4, v194, v195
  v_lshl_add_u32 v175, v165, 11, v174
  v_mfma_f32_16x16x32_bf16 v[52:55], a[200:203], a[20:23], v[52:55]
  ds_read_b128 a[192:195], v134 offset:40960
  v_cvt_pk_bf16_f32 v5, v196, v197
  v_pk_mul_f32 v[194:195], v[188:189], v[230:231] op_sel:[1,0] op_sel_hi:[1,1]
  s_waitcnt vmcnt(18)
  v_pk_mul_f32 v[198:199], v[222:223], v[234:235] op_sel_hi:[1,0]
  v_pk_mul_f32 v[196:197], v[188:189], v[232:233] op_sel:[1,0] op_sel_hi:[1,1]
  v_pk_mul_f32 v[200:201], v[224:225], v[234:235] op_sel_hi:[1,0]
  v_pk_fma_f32 v[194:195], v[188:189], v[28:29], v[194:195] op_sel:[0,0,0] op_sel_hi:[0,1,1]
  v_pk_fma_f32 v[198:199], v[218:219], v[48:49], v[198:199]
  v_pk_fma_f32 v[196:197], v[188:189], v[30:31], v[196:197] op_sel:[0,0,0] op_sel_hi:[0,1,1]
  v_pk_fma_f32 v[200:201], v[220:221], v[50:51], v[200:201]
  v_mfma_f32_16x16x32_bf16 v[16:19], a[12:15], a[204:207], v[16:19]
  s_waitcnt lgkmcnt(3)
  v_cvt_pk_bf16_f32 v238, v194, v195
  v_cvt_pk_bf16_f32 v244, v198, v199
  v_mfma_f32_16x16x32_bf16 v[36:39], a[16:19], a[204:207], v[36:39]
  s_add_u32 s4, s8, 0
  buffer_load_dwordx2 v[176:177], v175, s[28:31], s4 offen
  v_mfma_f32_16x16x32_bf16 v[56:59], a[204:207], a[20:23], v[56:59]
  v_cvt_pk_bf16_f32 v239, v196, v197
  v_cvt_pk_bf16_f32 v245, v200, v201
  v_pk_mul_f32 v[194:195], v[188:189], v[226:227] op_sel:[1,0] op_sel_hi:[1,1]
  v_pk_mul_f32 v[196:197], v[188:189], v[228:229] op_sel:[1,0] op_sel_hi:[1,1]
  v_pk_fma_f32 v[194:195], v[188:189], v[8:9], v[194:195] op_sel:[0,0,0] op_sel_hi:[0,1,1]
  v_pk_fma_f32 v[196:197], v[188:189], v[10:11], v[196:197] op_sel:[0,0,0] op_sel_hi:[0,1,1]
  v_mfma_f32_16x16x32_bf16 v[12:15], a[24:27], a[208:211], v[12:15]
  ds_read_b128 a[196:199], v134 offset:43008
  v_cvt_pk_bf16_f32 v8, v194, v195
  v_mfma_f32_16x16x32_bf16 v[32:35], a[28:31], a[208:211], v[32:35]
  ds_read_b128 a[200:203], v135 offset:40960
  v_cvt_pk_bf16_f32 v9, v196, v197
  v_mfma_f32_16x16x32_bf16 v[52:55], a[208:211], a[32:35], v[52:55]
  s_add_u32 s4, s8, 65536
  buffer_load_dwordx2 v[178:179], v175, s[28:31], s4 offen
  v_mfma_f32_16x16x16_bf16 v[44:47], v[236:237], v[4:5], v[250:253]
  ds_read_b64_tr_b16 a[0:1], v150 offset:0
  v_mfma_f32_16x16x16_bf16 v[202:205], v[24:25], v[4:5], v[246:249]
  ds_read_b64_tr_b16 a[2:3], v150 offset:512
  v_mfma_f32_16x16x32_bf16 v[16:19], a[24:27], a[212:215], v[16:19]
  s_waitcnt lgkmcnt(5)
  ds_read_b64_tr_b16 a[4:5], v151 offset:0
  v_mfma_f32_16x16x32_bf16 v[36:39], a[28:31], a[212:215], v[36:39]
  ds_read_b128 a[204:207], v135 offset:43008
  v_mfma_f32_16x16x32_bf16 v[56:59], a[212:215], a[32:35], v[56:59]
  ds_read_b64_tr_b16 a[6:7], v151 offset:512
  v_mfma_f32_16x16x16_bf16 v[48:51], v[24:25], v[8:9], v[250:253]
  ds_read_b64_tr_b16 a[8:9], v152 offset:0
  v_mfma_f32_16x16x32_bf16 v[12:15], a[36:39], a[216:219], v[12:15]
  s_add_u32 s4, s8, 131072
  buffer_load_dwordx2 v[180:181], v175, s[28:31], s4 offen
  v_mfma_f32_16x16x32_bf16 v[32:35], a[40:43], a[216:219], v[32:35]
  ds_read_b64_tr_b16 a[10:11], v152 offset:512
  v_mfma_f32_16x16x32_bf16 v[52:55], a[216:219], a[44:47], v[52:55]
  ds_read_b128 a[208:211], v134 offset:45056
  v_mfma_f32_16x16x16_bf16 v[206:209], v[238:239], v[8:9], v[246:249]
  ds_read_b64_tr_b16 a[12:13], v153 offset:0
  v_mfma_f32_16x16x32_bf16 v[16:19], a[36:39], a[220:223], v[16:19]
  s_waitcnt lgkmcnt(10)
  ds_read_b64_tr_b16 a[14:15], v153 offset:512
  v_mfma_f32_16x16x32_bf16 v[36:39], a[40:43], a[220:223], v[36:39]
  s_waitcnt lgkmcnt(0)
  ds_read_b128 a[212:215], v134 offset:47104
  v_mfma_f32_16x16x32_bf16 v[56:59], a[220:223], a[44:47], v[56:59]
  s_add_u32 s11, s23, 360448
  s_sub_u32 s5, s11, 458752
  s_min_u32 s11, s11, s5
  v_mfma_f32_16x16x32_bf16 v[12:15], a[48:51], a[192:195], v[12:15]
  s_add_u32 s4, s8, 196608
  buffer_load_dwordx2 v[182:183], v175, s[28:31], s4 offen
  v_mfma_f32_16x16x32_bf16 v[32:35], a[52:55], a[192:195], v[32:35]
  s_add_u32 m0, s10, 65536
  buffer_load_dwordx4 v[210:213], v173, s[16:19], s57 offen offset:640 sc1
  s_waitcnt vmcnt(5)
  s_mov_b64 exec, 1
  ds_add_rtn_u32 v3, v170, v170 offset:12
  s_mov_b64 exec, -1
  v_mfma_f32_16x16x32_bf16 v[52:55], a[192:195], a[56:59], v[52:55]
  buffer_load_dwordx4 v158, s[48:51], s11 offen offset:0 lds
  v_mfma_f32_16x16x32_bf16 v[16:19], a[48:51], a[196:199], v[16:19]
  buffer_load_dwordx4 v[214:217], v173, s[16:19], s57 offen offset:896 sc1
  v_mfma_f32_16x16x32_bf16 v[36:39], a[52:55], a[196:199], v[36:39]
  ds_read_b128 a[216:219], v135 offset:45056
  buffer_load_dword v168, v166, s[16:19], s21 offen sc1
  v_mfma_f32_16x16x32_bf16 v[56:59], a[196:199], a[56:59], v[56:59]
  buffer_load_dwordx4 v159, s[48:51], s11 offen offset:1024 lds
  s_add_u32 s5, s24, 3
  s_waitcnt lgkmcnt(1)
  v_readfirstlane_b32 s4, v3
  v_mov_b32 v3, s5
  s_cmp_eq_u32 s4, 422400
  s_cselect_b32 s4, s20, 1073741824
  s_nop 1
  buffer_store_dword v3, v169, s[16:19], s4 offen sc1
  v_mfma_f32_16x16x32_bf16 v[12:15], a[60:63], a[200:203], v[12:15]
  buffer_load_dwordx4 v160, s[48:51], s11 offen offset:2048 lds
  v_mfma_f32_16x16x32_bf16 v[32:35], a[64:67], a[200:203], v[32:35]
  buffer_load_dwordx4 v[218:221], v173, s[16:19], s57 offen offset:704 sc1
  v_mfma_f32_16x16x32_bf16 v[52:55], a[200:203], a[68:71], v[52:55]
  buffer_load_dwordx2 v[184:185], v174, s[12:15], s9 offen
  buffer_load_dwordx4 v161, s[48:51], s11 offen offset:3072 lds
  ds_read_b128 a[220:223], v135 offset:47104
  v_mfma_f32_16x16x32_bf16 v[16:19], a[60:63], a[204:207], v[16:19]
  buffer_load_dwordx4 v[222:225], v173, s[16:19], s57 offen offset:960 sc1
  ds_read_b64_tr_b16 a[16:17], v150 offset:16384
  v_mfma_f32_16x16x32_bf16 v[36:39], a[64:67], a[204:207], v[36:39]
  ds_read_b64_tr_b16 a[18:19], v150 offset:16896
  v_mfma_f32_16x16x32_bf16 v[56:59], a[204:207], a[68:71], v[56:59]
  v_max_f32 v44, v44, v202
  v_max_f32 v45, v45, v203
  v_mfma_f32_16x16x32_bf16 v[12:15], a[72:75], a[208:211], v[12:15]
  ds_read_b64_tr_b16 a[20:21], v151 offset:16384
  v_max_f32 v46, v46, v204
  v_max_f32 v47, v47, v205
  v_mfma_f32_16x16x32_bf16 v[32:35], a[76:79], a[208:211], v[32:35]
  ds_read_b128 a[192:195], v134 offset:49152
  ds_read_b64_tr_b16 a[22:23], v151 offset:16896
  v_max_f32 v48, v48, v206
  v_mfma_f32_16x16x32_bf16 v[52:55], a[208:211], a[80:83], v[52:55]
  ds_read_b64_tr_b16 a[24:25], v152 offset:16384
  ds_read_b128 a[196:199], v134 offset:51200
  v_max_f32 v49, v49, v207
  v_mfma_f32_16x16x32_bf16 v[16:19], a[72:75], a[212:215], v[16:19]
  ds_read_b64_tr_b16 a[26:27], v152 offset:16896
  v_max_f32 v50, v50, v208
  v_max_f32 v51, v51, v209
  v_mfma_f32_16x16x32_bf16 v[36:39], a[76:79], a[212:215], v[36:39]
  ds_read_b64_tr_b16 a[28:29], v153 offset:16384
  v_max3_f32 v6, v44, v45, v46
  v_mfma_f32_16x16x32_bf16 v[56:59], a[212:215], a[80:83], v[56:59]
  s_waitcnt lgkmcnt(9)
  ds_read_b64_tr_b16 a[30:31], v153 offset:16896
  v_max3_f32 v10, v48, v49, v50
  v_max_f32 v6, v6, v47
  v_mfma_f32_16x16x32_bf16 v[12:15], a[84:87], a[216:219], v[12:15]
  s_waitcnt lgkmcnt(0)
  v_max_f32 v10, v10, v51
  v_mov_b32 v7, v6
  s_add_u32 s11, s23, 393216
  s_sub_u32 s5, s11, 458752
  s_min_u32 s11, s11, s5
  v_mfma_f32_16x16x32_bf16 v[32:35], a[88:91], a[216:219], v[32:35]
  ds_read_b128 a[200:203], v135 offset:49152
  v_mov_b32 v11, v10
  v_mfma_f32_16x16x32_bf16 v[52:55], a[216:219], a[92:95], v[52:55]
  s_add_u32 m0, s10, 81920
  s_nop 0
  buffer_load_dwordx4 v158, s[48:51], s11 offen offset:0 lds
  ds_read_b128 a[204:207], v135 offset:51200
  v_permlane32_swap_b32 v6, v7
  v_mfma_f32_16x16x32_bf16 v[16:19], a[84:87], a[220:223], v[16:19]
  buffer_load_dwordx4 v159, s[48:51], s11 offen offset:1024 lds
  v_mfma_f32_16x16x32_bf16 v[36:39], a[88:91], a[220:223], v[36:39]
  buffer_load_dwordx4 v160, s[48:51], s11 offen offset:2048 lds
  v_permlane32_swap_b32 v10, v11
  v_mfma_f32_16x16x32_bf16 v[56:59], a[220:223], a[92:95], v[56:59]
  buffer_load_dwordx4 v161, s[48:51], s11 offen offset:3072 lds
  v_max_f32 v6, v6, v7
  v_max_f32 v10, v10, v11
  v_mfma_f32_16x16x32_bf16 v[12:15], a[96:99], a[192:195], v[12:15]
  ds_read_b128 a[208:211], v134 offset:53248
  ds_read_b64_tr_b16 a[32:33], v154 offset:16384
  v_mov_b32 v7, v6
  v_mfma_f32_16x16x32_bf16 v[32:35], a[100:103], a[192:195], v[32:35]
  ds_read_b64_tr_b16 a[34:35], v154 offset:16896
  v_mov_b32 v11, v10
  v_mfma_f32_16x16x32_bf16 v[52:55], a[192:195], a[104:107], v[52:55]
  ds_read_b128 a[212:215], v134 offset:55296
  v_permlane16_swap_b32 v6, v7
  v_mfma_f32_16x16x32_bf16 v[16:19], a[96:99], a[196:199], v[16:19]
  s_waitcnt lgkmcnt(4)
  ds_read_b64_tr_b16 a[36:37], v155 offset:16384
  v_permlane16_swap_b32 v10, v11
  v_mfma_f32_16x16x32_bf16 v[36:39], a[100:103], a[196:199], v[36:39]
  ds_read_b64_tr_b16 a[38:39], v155 offset:16896
  v_max_f32 v6, v6, v7
  v_mfma_f32_16x16x32_bf16 v[56:59], a[196:199], a[104:107], v[56:59]
  ds_read_b64_tr_b16 a[40:41], v156 offset:16384
  v_max_f32 v10, v10, v11
  v_mfma_f32_16x16x32_bf16 v[12:15], a[108:111], a[200:203], v[12:15]
  ds_read_b64_tr_b16 a[42:43], v156 offset:16896
  v_mul_f32 v6, s82, v6
  v_mfma_f32_16x16x32_bf16 v[32:35], a[112:115], a[200:203], v[32:35]
  ds_read_b128 a[216:219], v135 offset:53248
  ds_read_b64_tr_b16 a[44:45], v157 offset:16384
  v_mul_f32 v10, s82, v10
  v_pk_fma_f32 v[44:45], v[44:45], s[82:83], v[6:7] op_sel_hi:[1,1,0] neg_lo:[0,0,1] neg_hi:[0,0,1]
  v_pk_fma_f32 v[46:47], v[46:47], s[82:83], v[6:7] op_sel_hi:[1,1,0] neg_lo:[0,0,1] neg_hi:[0,0,1]
  v_pk_fma_f32 v[48:49], v[48:49], s[82:83], v[10:11] op_sel_hi:[1,1,0] neg_lo:[0,0,1] neg_hi:[0,0,1]
  v_pk_fma_f32 v[50:51], v[50:51], s[82:83], v[10:11] op_sel_hi:[1,1,0] neg_lo:[0,0,1] neg_hi:[0,0,1]
  v_mfma_f32_16x16x32_bf16 v[52:55], a[200:203], a[116:119], v[52:55]
  ds_read_b64_tr_b16 a[46:47], v157 offset:16896
  ds_read_b128 a[220:223], v135 offset:55296
  v_exp_f32 v44, v44
  v_mfma_f32_16x16x32_bf16 v[16:19], a[108:111], a[204:207], v[16:19]
  s_waitcnt lgkmcnt(1)
  v_exp_f32 v45, v45
  s_add_u32 s11, s23, 425984
  s_sub_u32 s5, s11, 458752
  s_min_u32 s11, s11, s5
  v_mfma_f32_16x16x32_bf16 v[36:39], a[112:115], a[204:207], v[36:39]
  v_exp_f32 v46, v46
  s_add_u32 s4, s25, 2
  s_waitcnt vmcnt(11)
  v_subrev_u32 v1, s4, v168
  v_cmp_lt_u32 vcc, 3, v1
  s_nop 0
  s_and_b32 s4, vcc_lo, s77
  s_cbranch_scc1 L_c2a
L_c2aok:
  v_mfma_f32_16x16x32_bf16 v[56:59], a[204:207], a[116:119], v[56:59]
  s_add_u32 m0, s10, 147456
  s_nop 0
  buffer_load_dwordx4 v158, s[48:51], s11 offen offset:0 lds
  v_exp_f32 v47, v47
  v_mfma_f32_16x16x32_bf16 v[12:15], a[120:123], a[208:211], v[12:15]
  ds_read_b128 a[192:195], v134 offset:57344
  buffer_load_dwordx4 v159, s[48:51], s11 offen offset:1024 lds
  v_mfma_f32_16x16x32_bf16 v[32:35], a[124:127], a[208:211], v[32:35]
  buffer_load_dwordx4 v160, s[48:51], s11 offen offset:2048 lds
  v_exp_f32 v48, v48
  v_mfma_f32_16x16x32_bf16 v[52:55], a[208:211], a[128:131], v[52:55]
  buffer_load_dwordx4 v161, s[48:51], s11 offen offset:3072 lds
  ds_read_b128 a[196:199], v134 offset:59392
  v_mfma_f32_16x16x32_bf16 v[16:19], a[120:123], a[212:215], v[16:19]
  s_waitcnt lgkmcnt(2)
  v_exp_f32 v49, v49
  v_mfma_f32_16x16x32_bf16 v[36:39], a[124:127], a[212:215], v[36:39]
  buffer_load_dwordx4 a[48:51], v162, s[16:19], 0 offen offset:0 sc1
  v_exp_f32 v50, v50
  v_mfma_f32_16x16x32_bf16 v[56:59], a[212:215], a[128:131], v[56:59]
  v_exp_f32 v51, v51
  v_mfma_f32_16x16x32_bf16 v[12:15], a[132:135], a[216:219], v[12:15]
  ds_read_b128 a[200:203], v135 offset:57344
  buffer_load_dwordx4 a[52:55], v162, s[16:19], s59 offen offset:1024 sc1
  v_cvt_pk_bf16_f32 v26, v44, v45
  v_mfma_f32_16x16x32_bf16 v[32:35], a[136:139], a[216:219], v[32:35]
  v_cvt_pk_bf16_f32 v27, v46, v47
  v_cvt_pk_bf16_f32 v30, v48, v49
  v_mfma_f32_16x16x32_bf16 v[52:55], a[216:219], a[140:143], v[52:55]
  ds_read_b128 a[204:207], v135 offset:59392
  buffer_load_dwordx4 a[56:59], v162, s[16:19], s60 offen offset:1024 sc1
  v_cvt_pk_bf16_f32 v31, v50, v51
  v_mfma_f32_16x16x32_bf16 v[16:19], a[132:135], a[220:223], v[16:19]
  s_waitcnt lgkmcnt(2)
  v_and_b32 v24, v254, v26
  v_and_b32 v25, v255, v27
  v_mfma_f32_16x16x32_bf16 v[36:39], a[136:139], a[220:223], v[36:39]
  buffer_load_dwordx4 a[60:63], v162, s[16:19], s61 offen offset:1024 sc1
  v_and_b32 v28, v254, v30
  v_and_b32 v29, v255, v31
  v_mfma_f32_16x16x32_bf16 v[56:59], a[220:223], a[140:143], v[56:59]
  ds_read_b128 a[208:211], v134 offset:61440
  v_xor_b32 v26, v26, v24
  v_mfma_f32_16x16x32_bf16 v[12:15], a[144:147], a[192:195], v[12:15]
  buffer_load_dwordx4 a[64:67], v162, s[16:19], s62 offen offset:1024 sc1
  v_xor_b32 v27, v27, v25
  v_xor_b32 v30, v30, v28
  v_mfma_f32_16x16x32_bf16 v[32:35], a[148:151], a[192:195], v[32:35]
  ds_read_b128 a[212:215], v134 offset:63488
  v_xor_b32 v31, v31, v29
  v_mfma_f32_16x16x32_bf16 v[52:55], a[192:195], a[152:155], v[52:55]
  buffer_load_dwordx4 a[68:71], v162, s[16:19], s63 offen offset:1024 sc1
  v_mfma_f32_16x16x32_bf16 v[202:205], v[76:79], v[24:27], 0
  ds_read_b128 a[216:219], v135 offset:61440
  v_mfma_f32_16x16x32_bf16 v[44:47], v[240:243], v[24:27], 0
  buffer_load_dwordx4 a[72:75], v162, s[16:19], s64 offen offset:1024 sc1
  v_mfma_f32_16x16x32_bf16 v[206:209], v[76:79], v[28:31], 0
  buffer_load_dwordx4 a[76:79], v162, s[16:19], s65 offen offset:1024 sc1
  v_mfma_f32_16x16x32_bf16 v[16:19], a[144:147], a[196:199], v[16:19]
  s_waitcnt lgkmcnt(3)
  ds_read_b128 a[220:223], v135 offset:63488
  v_mfma_f32_16x16x32_bf16 v[36:39], a[148:151], a[196:199], v[36:39]
  buffer_load_dwordx4 a[80:83], v162, s[16:19], s66 offen offset:1024 sc1
  v_mfma_f32_16x16x32_bf16 v[56:59], a[196:199], a[152:155], v[56:59]
  buffer_load_dwordx4 a[84:87], v162, s[16:19], s67 offen offset:1024 sc1
  v_mfma_f32_16x16x32_bf16 v[48:51], v[242:245], v[28:31], 0
  v_mfma_f32_16x16x32_bf16 v[12:15], a[156:159], a[200:203], v[12:15]
  v_mfma_f32_16x16x32_bf16 v[32:35], a[160:163], a[200:203], v[32:35]
  v_rcp_f32 v202, v202
  v_mfma_f32_16x16x32_bf16 v[52:55], a[200:203], a[164:167], v[52:55]
  buffer_load_dword v168, v166, s[16:19], s21 offen sc1
  v_mfma_f32_16x16x32_bf16 v[16:19], a[156:159], a[204:207], v[16:19]
  s_waitcnt lgkmcnt(2)
  buffer_load_dwordx4 a[88:91], v162, s[16:19], s68 offen offset:1024 sc1
  v_mfma_f32_16x16x32_bf16 v[36:39], a[160:163], a[204:207], v[36:39]
  v_rcp_f32 v206, v206
  v_mfma_f32_16x16x32_bf16 v[56:59], a[204:207], a[164:167], v[56:59]
  buffer_load_dwordx4 a[92:95], v162, s[16:19], s70 offen offset:1024 sc1
  v_pk_mul_f32 v[44:45], v[44:45], v[202:203] op_sel_hi:[1,0]
  v_pk_mul_f32 v[46:47], v[46:47], v[202:203] op_sel_hi:[1,0]
  v_pk_mul_f32 v[48:49], v[48:49], v[206:207] op_sel_hi:[1,0]
  v_pk_mul_f32 v[50:51], v[50:51], v[206:207] op_sel_hi:[1,0]
  v_mfma_f32_16x16x32_bf16 v[12:15], a[168:171], a[208:211], v[12:15]
  v_cvt_pk_bf16_f32 v194, v44, v45
  v_cvt_pk_bf16_f32 v196, v48, v49
  v_mfma_f32_16x16x32_bf16 v[32:35], a[172:175], a[208:211], v[32:35]
  buffer_load_dwordx4 a[96:99], v162, s[16:19], s71 offen offset:1024 sc1
  v_mfma_f32_16x16x32_bf16 v[52:55], a[208:211], a[176:179], v[52:55]
  v_min_u32 v194, -2, v194
  v_min_u32 v196, -2, v196
  v_mfma_f32_16x16x32_bf16 v[16:19], a[168:171], a[212:215], v[16:19]
  s_waitcnt lgkmcnt(0)
  v_cvt_pk_bf16_f32 v195, v46, v47
  v_cvt_pk_bf16_f32 v197, v50, v51
  v_mfma_f32_16x16x32_bf16 v[36:39], a[172:175], a[212:215], v[36:39]
  buffer_load_dwordx4 a[100:103], v162, s[16:19], s72 offen offset:1024 sc1
  v_mfma_f32_16x16x32_bf16 v[56:59], a[212:215], a[176:179], v[56:59]
  v_permlane16_swap_b32 v194, v196
  v_mfma_f32_16x16x32_bf16 v[12:15], a[180:183], a[216:219], v[12:15]
  buffer_load_dwordx4 a[104:107], v162, s[16:19], s73 offen offset:1024 sc1
  v_mfma_f32_16x16x32_bf16 v[32:35], a[184:187], a[216:219], v[32:35]
  v_permlane16_swap_b32 v195, v197
  v_mfma_f32_16x16x32_bf16 v[52:55], a[216:219], a[188:191], v[52:55]
  s_add_u32 s69, s78, 245760
  buffer_store_dwordx4 v[194:197], v163, s[36:39], s69 offen sc1
  v_mfma_f32_16x16x32_bf16 v[16:19], a[180:183], a[220:223], v[16:19]
  v_add_u32 v162, 122880, v162
  v_mfma_f32_16x16x32_bf16 v[36:39], a[184:187], a[220:223], v[36:39]
  v_mfma_f32_16x16x32_bf16 v[56:59], a[220:223], a[188:191], v[56:59]
  s_waitcnt vmcnt(16)
  v_mfma_f32_16x16x32_bf16 v[8:11], v[84:87], a[48:51], 0
  v_mov_b32 v240, v244
  v_mov_b32 v241, v245
  v_pk_mul_f32 v[194:195], v[190:191], v[230:231] op_sel:[1,0] op_sel_hi:[1,1]
  v_pk_mul_f32 v[198:199], v[214:215], v[234:235] op_sel_hi:[1,0]
  v_pk_mul_f32 v[196:197], v[190:191], v[232:233] op_sel:[1,0] op_sel_hi:[1,1]
  v_pk_mul_f32 v[200:201], v[216:217], v[234:235] op_sel_hi:[1,0]
  v_pk_fma_f32 v[194:195], v[190:191], v[32:33], v[194:195] op_sel:[0,0,0] op_sel_hi:[0,1,1]
  v_pk_fma_f32 v[198:199], v[210:211], v[52:53], v[198:199]
  v_pk_fma_f32 v[196:197], v[190:191], v[34:35], v[196:197] op_sel:[0,0,0] op_sel_hi:[0,1,1]
  v_pk_fma_f32 v[200:201], v[212:213], v[54:55], v[200:201]
  v_mfma_f32_16x16x32_bf16 v[24:27], v[88:91], a[48:51], 0
  v_cvt_pk_bf16_f32 v32, v194, v195
  v_cvt_pk_bf16_f32 v242, v198, v199
  v_mfma_f32_16x16x32_bf16 v[28:31], v[92:95], a[48:51], 0
  v_lshlrev_b32 v172, 16, v184
  v_cvt_pk_bf16_f32 v33, v196, v197
  s_waitcnt vmcnt(15)
  v_mfma_f32_16x16x32_bf16 v[8:11], v[100:103], a[52:55], v[8:11]
  v_cvt_pk_bf16_f32 v243, v200, v201
  v_and_b32 v173, 0xffff0000, v184
  s_add_u32 s4, s25, 3
  s_waitcnt vmcnt(6)
  v_subrev_u32 v1, s4, v168
  v_cmp_lt_u32 vcc, 2, v1
  s_nop 0
  s_and_b32 s4, vcc_lo, s77
  s_cbranch_scc1 L_c3a
L_c3aok:
  v_pk_mul_f32 v[194:195], v[190:191], v[226:227] op_sel:[1,0] op_sel_hi:[1,1]
  v_pk_mul_f32 v[196:197], v[190:191], v[228:229] op_sel:[1,0] op_sel_hi:[1,1]
  v_pk_fma_f32 v[194:195], v[190:191], v[12:13], v[194:195] op_sel:[0,0,0] op_sel_hi:[0,1,1]
  v_pk_fma_f32 v[196:197], v[190:191], v[14:15], v[196:197] op_sel:[0,0,0] op_sel_hi:[0,1,1]
  v_mfma_f32_16x16x32_bf16 v[24:27], v[104:107], a[52:55], v[24:27]
  v_cvt_pk_bf16_f32 v12, v194, v195
  v_cvt_pk_bf16_f32 v13, v196, v197
  v_pk_mul_f32 v[194:195], v[192:193], v[230:231] op_sel:[1,0] op_sel_hi:[1,1]
  v_pk_mul_f32 v[198:199], v[222:223], v[234:235] op_sel_hi:[1,0]
  v_pk_mul_f32 v[196:197], v[192:193], v[232:233] op_sel:[1,0] op_sel_hi:[1,1]
  v_pk_mul_f32 v[200:201], v[224:225], v[234:235] op_sel_hi:[1,0]
  v_pk_fma_f32 v[194:195], v[192:193], v[36:37], v[194:195] op_sel:[0,0,0] op_sel_hi:[0,1,1]
  v_pk_fma_f32 v[198:199], v[218:219], v[56:57], v[198:199]
  v_pk_fma_f32 v[196:197], v[192:193], v[38:39], v[196:197] op_sel:[0,0,0] op_sel_hi:[0,1,1]
  v_pk_fma_f32 v[200:201], v[220:221], v[58:59], v[200:201]
  v_mfma_f32_16x16x32_bf16 v[28:31], v[108:111], a[52:55], v[28:31]
  v_cvt_pk_bf16_f32 v236, v194, v195
  v_lshlrev_b32 v174, 16, v185
  v_cvt_pk_bf16_f32 v244, v198, v199
  v_cvt_pk_bf16_f32 v237, v196, v197
  v_mfma_f32_16x16x32_bf16 v[8:11], v[116:119], a[56:59], v[8:11]
  v_cvt_pk_bf16_f32 v245, v200, v201
  v_and_b32 v175, 0xffff0000, v185
  v_pk_mul_f32 v[194:195], v[192:193], v[226:227] op_sel:[1,0] op_sel_hi:[1,1]
  v_pk_mul_f32 v[196:197], v[192:193], v[228:229] op_sel:[1,0] op_sel_hi:[1,1]
  v_pk_fma_f32 v[194:195], v[192:193], v[16:17], v[194:195] op_sel:[0,0,0] op_sel_hi:[0,1,1]
  v_pk_fma_f32 v[196:197], v[192:193], v[18:19], v[196:197] op_sel:[0,0,0] op_sel_hi:[0,1,1]
  v_mfma_f32_16x16x32_bf16 v[24:27], v[120:123], a[56:59], v[24:27]
  v_cvt_pk_bf16_f32 v16, v194, v195
  v_cvt_pk_bf16_f32 v17, v196, v197
  v_mfma_f32_16x16x32_bf16 v[28:31], v[124:127], a[56:59], v[28:31]
  v_lshlrev_b32 v4, 16, v176
  v_and_b32 v5, 0xffff0000, v176
  v_mfma_f32_16x16x16_bf16 v[52:55], v[238:239], v[12:13], v[250:253]
  v_lshlrev_b32 v6, 16, v177
  v_and_b32 v7, 0xffff0000, v177
  v_mfma_f32_16x16x16_bf16 v[202:205], v[32:33], v[12:13], v[246:249]
  v_add_f32 v4, v4, v172
  v_add_f32 v5, v5, v173
  v_mfma_f32_16x16x16_bf16 v[56:59], v[32:33], v[16:17], v[250:253]
  v_add_f32 v6, v6, v174
  v_add_f32 v7, v7, v175
  v_mfma_f32_16x16x16_bf16 v[206:209], v[236:237], v[16:17], v[246:249]
  buffer_load_dwordx4 v[64:67], v162, s[16:19], 0 offen offset:0 sc1
  v_mfma_f32_16x16x32_bf16 v[8:11], a[244:247], a[60:63], v[8:11]
  v_max_f32 v52, v52, v202
  v_max_f32 v53, v53, v203
  v_mfma_f32_16x16x32_bf16 v[24:27], a[248:251], a[60:63], v[24:27]
  v_max_f32 v54, v54, v204
  v_max_f32 v55, v55, v205
  v_mfma_f32_16x16x32_bf16 v[28:31], a[252:255], a[60:63], v[28:31]
  v_max_f32 v56, v56, v206
  v_max_f32 v57, v57, v207
  v_mfma_f32_16x16x32_bf16 v[4:7], v[80:83], a[48:51], v[4:7]
  v_max_f32 v58, v58, v208
  v_max_f32 v59, v59, v209
  v_max3_f32 v14, v52, v53, v54
  v_mfma_f32_16x16x32_bf16 v[4:7], v[96:99], a[52:55], v[4:7]
  buffer_load_dwordx4 v[68:71], v162, s[16:19], s59 offen offset:1024 sc1
  v_max3_f32 v18, v56, v57, v58
  v_max_f32 v14, v14, v55
  v_max_f32 v18, v18, v59
  v_mov_b32 v15, v14
  v_mfma_f32_16x16x32_bf16 v[4:7], v[112:115], a[56:59], v[4:7]
  v_mov_b32 v19, v18
  v_permlane32_swap_b32 v14, v15
  s_nop 0
  v_permlane32_swap_b32 v18, v19
  v_mfma_f32_16x16x32_bf16 v[4:7], a[240:243], a[60:63], v[4:7]
  v_max_f32 v14, v14, v15
  v_max_f32 v18, v18, v19
  v_mov_b32 v15, v14
  v_mfma_f32_16x16x32_bf16 v[4:7], a[224:227], a[64:67], v[4:7]
  buffer_load_dwordx4 v[72:75], v162, s[16:19], s60 offen offset:1024 sc1
  v_mov_b32 v19, v18
  v_permlane16_swap_b32 v14, v15
  s_nop 0
  v_permlane16_swap_b32 v18, v19
  v_mfma_f32_16x16x32_bf16 v[8:11], a[228:231], a[64:67], v[8:11]
  v_max_f32 v14, v14, v15
  v_max_f32 v18, v18, v19
  v_mul_f32 v14, s82, v14
  v_mfma_f32_16x16x32_bf16 v[24:27], a[232:235], a[64:67], v[24:27]
  buffer_load_dwordx4 v[128:131], v162, s[16:19], s61 offen offset:1024 sc1
  v_mul_f32 v18, s82, v18
  v_pk_fma_f32 v[52:53], v[52:53], s[82:83], v[14:15] op_sel_hi:[1,1,0] neg_lo:[0,0,1] neg_hi:[0,0,1]
  v_pk_fma_f32 v[54:55], v[54:55], s[82:83], v[14:15] op_sel_hi:[1,1,0] neg_lo:[0,0,1] neg_hi:[0,0,1]
  v_pk_fma_f32 v[56:57], v[56:57], s[82:83], v[18:19] op_sel_hi:[1,1,0] neg_lo:[0,0,1] neg_hi:[0,0,1]
  v_pk_fma_f32 v[58:59], v[58:59], s[82:83], v[18:19] op_sel_hi:[1,1,0] neg_lo:[0,0,1] neg_hi:[0,0,1]
  v_mfma_f32_16x16x32_bf16 v[28:31], a[236:239], a[64:67], v[28:31]
  v_exp_f32 v52, v52
  v_exp_f32 v53, v53
  v_exp_f32 v54, v54
  v_mfma_f32_16x16x32_bf16 v[4:7], a[0:3], a[68:71], v[4:7]
  v_exp_f32 v55, v55
  v_exp_f32 v56, v56
  v_mfma_f32_16x16x32_bf16 v[8:11], a[4:7], a[68:71], v[8:11]
  buffer_load_dwordx4 v[136:139], v162, s[16:19], s62 offen offset:1024 sc1
  v_exp_f32 v57, v57
  v_exp_f32 v58, v58
  v_mfma_f32_16x16x32_bf16 v[24:27], a[8:11], a[68:71], v[24:27]
  v_exp_f32 v59, v59
  v_cvt_pk_bf16_f32 v34, v52, v53
  v_cvt_pk_bf16_f32 v35, v54, v55
  v_mfma_f32_16x16x32_bf16 v[28:31], a[12:15], a[68:71], v[28:31]
  buffer_load_dwordx4 v[20:23], v162, s[16:19], s63 offen offset:1024 sc1
  v_cvt_pk_bf16_f32 v38, v56, v57
  v_cvt_pk_bf16_f32 v39, v58, v59
  v_and_b32 v32, v254, v34
  v_and_b32 v33, v255, v35
  v_mfma_f32_16x16x32_bf16 v[4:7], a[16:19], a[72:75], v[4:7]
  v_and_b32 v36, v254, v38
  v_and_b32 v37, v255, v39
  v_xor_b32 v34, v34, v32
  v_xor_b32 v35, v35, v33
  v_mfma_f32_16x16x32_bf16 v[8:11], a[20:23], a[72:75], v[8:11]
  v_xor_b32 v38, v38, v36
  v_xor_b32 v39, v39, v37
  v_mfma_f32_16x16x32_bf16 v[24:27], a[24:27], a[72:75], v[24:27]
  buffer_load_dwordx4 v[40:43], v162, s[16:19], s64 offen offset:1024 sc1
  v_mfma_f32_16x16x32_bf16 v[202:205], v[76:79], v[32:35], 0
  buffer_load_dwordx4 v[60:63], v162, s[16:19], s65 offen offset:1024 sc1
  v_mfma_f32_16x16x32_bf16 v[52:55], v[240:243], v[32:35], 0
  v_mfma_f32_16x16x32_bf16 v[206:209], v[76:79], v[36:39], 0
  v_mfma_f32_16x16x32_bf16 v[56:59], v[242:245], v[36:39], 0
  v_mfma_f32_16x16x32_bf16 v[28:31], a[28:31], a[72:75], v[28:31]
  s_nop 2
  v_rcp_f32 v202, v202
  v_mfma_f32_16x16x32_bf16 v[4:7], a[32:35], a[76:79], v[4:7]
  s_nop 0
  v_rcp_f32 v206, v206
  v_pk_mul_f32 v[52:53], v[52:53], v[202:203] op_sel_hi:[1,0]
  v_pk_mul_f32 v[54:55], v[54:55], v[202:203] op_sel_hi:[1,0]
  v_pk_mul_f32 v[56:57], v[56:57], v[206:207] op_sel_hi:[1,0]
  v_pk_mul_f32 v[58:59], v[58:59], v[206:207] op_sel_hi:[1,0]
  v_mfma_f32_16x16x32_bf16 v[8:11], a[36:39], a[76:79], v[8:11]
  v_cvt_pk_bf16_f32 v198, v52, v53
  v_cvt_pk_bf16_f32 v200, v56, v57
  v_mfma_f32_16x16x32_bf16 v[24:27], a[40:43], a[76:79], v[24:27]
  v_min_u32 v198, -2, v198
  v_min_u32 v200, -2, v200
  v_mfma_f32_16x16x32_bf16 v[28:31], a[44:47], a[76:79], v[28:31]
  buffer_load_dwordx4 v[132:135], v162, s[16:19], s66 offen offset:1024 sc1
  v_cvt_pk_bf16_f32 v199, v54, v55
  v_cvt_pk_bf16_f32 v201, v58, v59
  v_permlane16_swap_b32 v198, v200
  s_nop 0
  v_permlane16_swap_b32 v199, v201
  s_add_u32 s69, s78, 368640
  buffer_store_dwordx4 v[198:201], v163, s[36:39], s69 offen sc1
  buffer_load_dwordx4 v[44:47], v162, s[16:19], s67 offen offset:1024 sc1
  buffer_load_dwordx4 v[48:51], v162, s[16:19], s68 offen offset:1024 sc1
  ds_read_b64_tr_b16 a[108:109], v150 offset:32768
  ds_read_b64_tr_b16 a[110:111], v150 offset:33280
  ds_read_b64_tr_b16 a[112:113], v151 offset:32768
  ds_read_b64_tr_b16 a[114:115], v151 offset:33280
  ds_read_b64_tr_b16 a[116:117], v152 offset:32768
  ds_read_b64_tr_b16 a[118:119], v152 offset:33280
  ds_read_b64_tr_b16 a[120:121], v153 offset:32768
  ds_read_b64_tr_b16 a[122:123], v153 offset:33280
  s_waitcnt lgkmcnt(6)
  v_mfma_f32_16x16x32_bf16 v[4:7], a[108:111], a[80:83], v[4:7]
  ds_read_b64_tr_b16 a[124:125], v150 offset:49152
  ds_read_b64_tr_b16 a[126:127], v150 offset:49664
  ds_read_b64_tr_b16 a[128:129], v151 offset:49152
  ds_read_b64_tr_b16 a[130:131], v151 offset:49664
  ds_read_b64_tr_b16 a[132:133], v152 offset:49152
  s_waitcnt lgkmcnt(9)
  v_mfma_f32_16x16x32_bf16 v[8:11], a[112:115], a[80:83], v[8:11]
  ds_read_b64_tr_b16 a[134:135], v152 offset:49664
  ds_read_b64_tr_b16 a[136:137], v153 offset:49152
  buffer_load_dwordx4 v[12:15], v162, s[16:19], s70 offen offset:1024 sc1
  s_waitcnt lgkmcnt(9)
  v_mfma_f32_16x16x32_bf16 v[24:27], a[116:119], a[80:83], v[24:27]
  ds_read_b64_tr_b16 a[138:139], v153 offset:49664
  ds_read_b64_tr_b16 a[140:141], v146 offset:0
  s_waitcnt lgkmcnt(9)
  v_mfma_f32_16x16x32_bf16 v[28:31], a[120:123], a[80:83], v[28:31]
  ds_read_b64_tr_b16 a[142:143], v146 offset:512
  ds_read_b64_tr_b16 a[144:145], v147 offset:0
  buffer_load_dwordx4 v[16:19], v162, s[16:19], s71 offen offset:1024 sc1
  s_waitcnt lgkmcnt(9)
  v_mfma_f32_16x16x32_bf16 v[4:7], a[124:127], a[84:87], v[4:7]
  ds_read_b64_tr_b16 a[146:147], v147 offset:512
  ds_read_b64_tr_b16 a[148:149], v148 offset:0
  s_waitcnt lgkmcnt(9)
  v_mfma_f32_16x16x32_bf16 v[8:11], a[128:131], a[84:87], v[8:11]
  ds_read_b64_tr_b16 a[150:151], v148 offset:512
  ds_read_b64_tr_b16 a[152:153], v149 offset:0
  buffer_load_dwordx4 v[32:35], v162, s[16:19], s72 offen offset:1024 sc1
  s_waitcnt lgkmcnt(9)
  v_mfma_f32_16x16x32_bf16 v[24:27], a[132:135], a[84:87], v[24:27]
  ds_read_b64_tr_b16 a[154:155], v149 offset:512
  ds_read_b64_tr_b16 a[156:157], v146 offset:16384
  s_waitcnt lgkmcnt(9)
  v_mfma_f32_16x16x32_bf16 v[28:31], a[136:139], a[84:87], v[28:31]
  ds_read_b64_tr_b16 a[158:159], v146 offset:16896
  ds_read_b64_tr_b16 a[160:161], v147 offset:16384
  buffer_load_dwordx4 v[36:39], v162, s[16:19], s73 offen offset:1024 sc1
  s_waitcnt vmcnt(21) lgkmcnt(9)
  v_mfma_f32_16x16x32_bf16 v[4:7], a[140:143], a[88:91], v[4:7]
  ds_read_b64_tr_b16 a[162:163], v147 offset:16896
  ds_read_b64_tr_b16 a[164:165], v148 offset:16384
  v_add_u32 v162, 122880, v162
  s_waitcnt lgkmcnt(9)
  v_mfma_f32_16x16x32_bf16 v[8:11], a[144:147], a[88:91], v[8:11]
  ds_read_b64_tr_b16 a[166:167], v148 offset:16896
  ds_read_b64_tr_b16 a[168:169], v149 offset:16384
  s_waitcnt lgkmcnt(9)
  v_mfma_f32_16x16x32_bf16 v[24:27], a[148:151], a[88:91], v[24:27]
  ds_read_b64_tr_b16 a[170:171], v149 offset:16896
  ds_read_b64_tr_b16 a[172:173], v150 offset:0
  s_waitcnt lgkmcnt(9)
  v_mfma_f32_16x16x32_bf16 v[28:31], a[152:155], a[88:91], v[28:31]
  ds_read_b64_tr_b16 a[174:175], v150 offset:512
  ds_read_b64_tr_b16 a[176:177], v151 offset:0
  s_waitcnt vmcnt(20) lgkmcnt(9)
  v_mfma_f32_16x16x32_bf16 v[4:7], a[156:159], a[92:95], v[4:7]
  ds_read_b64_tr_b16 a[178:179], v151 offset:512
  ds_read_b64_tr_b16 a[180:181], v152 offset:0
  s_waitcnt lgkmcnt(9)
  v_mfma_f32_16x16x32_bf16 v[8:11], a[160:163], a[92:95], v[8:11]
  ds_read_b64_tr_b16 a[182:183], v152 offset:512
  ds_read_b64_tr_b16 a[184:185], v153 offset:0
  s_waitcnt lgkmcnt(9)
  v_mfma_f32_16x16x32_bf16 v[24:27], a[164:167], a[92:95], v[24:27]
  ds_read_b64_tr_b16 a[186:187], v153 offset:512
  ds_read_b64_tr_b16 a[192:193], v150 offset:16384
  s_waitcnt lgkmcnt(9)
  v_mfma_f32_16x16x32_bf16 v[28:31], a[168:171], a[92:95], v[28:31]
  ds_read_b64_tr_b16 a[194:195], v150 offset:16896
  ds_read_b64_tr_b16 a[196:197], v151 offset:16384
  s_waitcnt vmcnt(19) lgkmcnt(9)
  v_mfma_f32_16x16x32_bf16 v[4:7], a[172:175], a[96:99], v[4:7]
  ds_read_b64_tr_b16 a[198:199], v151 offset:16896
  ds_read_b64_tr_b16 a[200:201], v152 offset:16384
  s_waitcnt lgkmcnt(9)
  v_mfma_f32_16x16x32_bf16 v[8:11], a[176:179], a[96:99], v[8:11]
  ds_read_b64_tr_b16 a[202:203], v152 offset:16896
  ds_read_b64_tr_b16 a[204:205], v153 offset:16384
  s_waitcnt lgkmcnt(9)
  v_mfma_f32_16x16x32_bf16 v[24:27], a[180:183], a[96:99], v[24:27]
  ds_read_b64_tr_b16 a[206:207], v153 offset:16896
  ds_read_b64_tr_b16 a[208:209], v154 offset:16384
  s_waitcnt lgkmcnt(9)
  v_mfma_f32_16x16x32_bf16 v[28:31], a[184:187], a[96:99], v[28:31]
  ds_read_b64_tr_b16 a[210:211], v154 offset:16896
  ds_read_b64_tr_b16 a[212:213], v155 offset:16384
  s_waitcnt vmcnt(18) lgkmcnt(9)
  v_mfma_f32_16x16x32_bf16 v[4:7], a[192:195], a[100:103], v[4:7]
  ds_read_b64_tr_b16 a[214:215], v155 offset:16896
  ds_read_b64_tr_b16 a[216:217], v156 offset:16384
  v_lshlrev_b32 v194, 16, v178
  s_waitcnt lgkmcnt(9)
  v_mfma_f32_16x16x32_bf16 v[8:11], a[196:199], a[100:103], v[8:11]
  ds_read_b64_tr_b16 a[218:219], v156 offset:16896
  ds_read_b64_tr_b16 a[220:221], v157 offset:16384
  v_and_b32 v195, 0xffff0000, v178
  s_waitcnt lgkmcnt(9)
  v_mfma_f32_16x16x32_bf16 v[24:27], a[200:203], a[100:103], v[24:27]
  ds_read_b64_tr_b16 a[222:223], v157 offset:16896
  v_lshlrev_b32 v196, 16, v179
  s_waitcnt lgkmcnt(8)
  v_mfma_f32_16x16x32_bf16 v[28:31], a[204:207], a[100:103], v[28:31]
  v_and_b32 v197, 0xffff0000, v179
  s_waitcnt vmcnt(17) lgkmcnt(6)
  v_mfma_f32_16x16x32_bf16 v[4:7], a[208:211], a[104:107], v[4:7]
  v_add_f32 v194, v194, v172
  s_waitcnt lgkmcnt(4)
  v_mfma_f32_16x16x32_bf16 v[8:11], a[212:215], a[104:107], v[8:11]
  s_waitcnt lgkmcnt(2)
  v_mfma_f32_16x16x32_bf16 v[24:27], a[216:219], a[104:107], v[24:27]
  v_add_f32 v195, v195, v173
  s_waitcnt lgkmcnt(0)
  v_mfma_f32_16x16x32_bf16 v[28:31], a[220:223], a[104:107], v[28:31]
  s_waitcnt vmcnt(15)
  v_mfma_f32_16x16x32_bf16 v[198:201], v[84:87], v[64:67], 0
  v_add_f32 v196, v196, v174
  v_mfma_f32_16x16x32_bf16 v[202:205], v[88:91], v[64:67], 0
  v_mfma_f32_16x16x32_bf16 v[206:209], v[92:95], v[64:67], 0
  v_add_f32 v197, v197, v175
  s_waitcnt vmcnt(14)
  v_mfma_f32_16x16x32_bf16 v[198:201], v[100:103], v[68:71], v[198:201]
  v_mfma_f32_16x16x32_bf16 v[202:205], v[104:107], v[68:71], v[202:205]
  v_mfma_f32_16x16x32_bf16 v[206:209], v[108:111], v[68:71], v[206:209]
  s_waitcnt vmcnt(13)
  v_mfma_f32_16x16x32_bf16 v[198:201], v[116:119], v[72:75], v[198:201]
  v_mfma_f32_16x16x32_bf16 v[202:205], v[120:123], v[72:75], v[202:205]
  v_mfma_f32_16x16x32_bf16 v[206:209], v[124:127], v[72:75], v[206:209]
  s_waitcnt vmcnt(12)
  v_mfma_f32_16x16x32_bf16 v[198:201], a[244:247], v[128:131], v[198:201]
  v_mfma_f32_16x16x32_bf16 v[202:205], a[248:251], v[128:131], v[202:205]
  v_lshlrev_b32 v140, 3, v164
  v_lshl_add_u32 v140, v165, 11, v140
  v_mfma_f32_16x16x32_bf16 v[206:209], a[252:255], v[128:131], v[206:209]
  v_lshlrev_b32 v144, 4, v2
  v_mfma_f32_16x16x32_bf16 v[194:197], v[80:83], v[64:67], v[194:197]
  v_add_u32 v144, 65536, v144
  v_mfma_f32_16x16x32_bf16 v[194:197], v[96:99], v[68:71], v[194:197]
  v_add_u32 v141, s10, v144
  v_mfma_f32_16x16x32_bf16 v[194:197], v[112:115], v[72:75], v[194:197]
  v_mfma_f32_16x16x32_bf16 v[194:197], a[240:243], v[128:131], v[194:197]
  s_waitcnt vmcnt(11)
  v_mfma_f32_16x16x32_bf16 v[194:197], a[224:227], v[136:139], v[194:197]
  v_mfma_f32_16x16x32_bf16 v[198:201], a[228:231], v[136:139], v[198:201]
  v_mfma_f32_16x16x32_bf16 v[202:205], a[232:235], v[136:139], v[202:205]
  v_mfma_f32_16x16x32_bf16 v[206:209], a[236:239], v[136:139], v[206:209]
  s_sub_u32 s4, s26, 1
  s_and_b32 s4, s4, 3
  s_lshl_b32 s4, s4, 12
  s_add_u32 s4, s4, 0
  v_add_u32 v142, s4, v144
  s_waitcnt vmcnt(10)
  v_mfma_f32_16x16x32_bf16 v[194:197], a[0:3], v[20:23], v[194:197]
  buffer_load_dwordx4 a[48:51], v162, s[16:19], 0 offen offset:0 sc1
  v_mfma_f32_16x16x32_bf16 v[198:201], a[4:7], v[20:23], v[198:201]
  v_mfma_f32_16x16x32_bf16 v[202:205], a[8:11], v[20:23], v[202:205]
  buffer_load_dwordx4 a[52:55], v162, s[16:19], s59 offen offset:1024 sc1
  v_mfma_f32_16x16x32_bf16 v[206:209], a[12:15], v[20:23], v[206:209]
  s_waitcnt vmcnt(11)
  v_mfma_f32_16x16x32_bf16 v[194:197], a[16:19], v[40:43], v[194:197]
  s_sub_u32 s4, s26, 2
  s_and_b32 s4, s4, 3
  s_lshl_b32 s4, s4, 12
  s_add_u32 s4, s4, 1024
  v_add_u32 v143, s4, v144
  v_mfma_f32_16x16x32_bf16 v[198:201], a[20:23], v[40:43], v[198:201]
  buffer_load_dwordx4 a[56:59], v162, s[16:19], s60 offen offset:1024 sc1
  v_mfma_f32_16x16x32_bf16 v[202:205], a[24:27], v[40:43], v[202:205]
  v_mfma_f32_16x16x32_bf16 v[206:209], a[28:31], v[40:43], v[206:209]
  buffer_load_dwordx4 a[60:63], v162, s[16:19], s61 offen offset:1024 sc1
  s_waitcnt vmcnt(12)
  v_mfma_f32_16x16x32_bf16 v[194:197], a[32:35], v[60:63], v[194:197]
  v_mfma_f32_16x16x32_bf16 v[198:201], a[36:39], v[60:63], v[198:201]
  s_sub_u32 s4, s26, 3
  s_and_b32 s4, s4, 3
  s_lshl_b32 s4, s4, 12
  s_add_u32 s4, s4, 2048
  v_add_u32 v144, s4, v144
  v_mfma_f32_16x16x32_bf16 v[202:205], a[40:43], v[60:63], v[202:205]
  buffer_load_dwordx4 a[64:67], v162, s[16:19], s62 offen offset:1024 sc1
  v_mfma_f32_16x16x32_bf16 v[206:209], a[44:47], v[60:63], v[206:209]
  ds_write_b128 v141, v[8:11] offset:0
  s_waitcnt vmcnt(12)
  v_mfma_f32_16x16x32_bf16 v[194:197], a[108:111], v[132:135], v[194:197]
  buffer_load_dwordx4 a[68:71], v162, s[16:19], s63 offen offset:1024 sc1
  v_mfma_f32_16x16x32_bf16 v[198:201], a[112:115], v[132:135], v[198:201]
  ds_write_b128 v141, v[24:27] offset:1024
  v_mfma_f32_16x16x32_bf16 v[202:205], a[116:119], v[132:135], v[202:205]
  v_mfma_f32_16x16x32_bf16 v[206:209], a[120:123], v[132:135], v[206:209]
  buffer_load_dwordx4 a[72:75], v162, s[16:19], s64 offen offset:1024 sc1
  s_waitcnt vmcnt(12)
  v_mfma_f32_16x16x32_bf16 v[194:197], a[124:127], v[44:47], v[194:197]
  ds_write_b128 v141, v[28:31] offset:2048
  v_mfma_f32_16x16x32_bf16 v[198:201], a[128:131], v[44:47], v[198:201]
  buffer_load_dwordx4 a[76:79], v162, s[16:19], s65 offen offset:1024 sc1
  v_mfma_f32_16x16x32_bf16 v[202:205], a[132:135], v[44:47], v[202:205]
  v_lshlrev_b32 v210, 16, v180
  v_mfma_f32_16x16x32_bf16 v[206:209], a[136:139], v[44:47], v[206:209]
  v_and_b32 v211, 0xffff0000, v180
  s_waitcnt vmcnt(12)
  v_mfma_f32_16x16x32_bf16 v[194:197], a[140:143], v[48:51], v[194:197]
  buffer_load_dwordx4 a[80:83], v162, s[16:19], s66 offen offset:1024 sc1
  v_mfma_f32_16x16x32_bf16 v[198:201], a[144:147], v[48:51], v[198:201]
  v_lshlrev_b32 v212, 16, v181
  v_and_b32 v213, 0xffff0000, v181
  v_mfma_f32_16x16x32_bf16 v[202:205], a[148:151], v[48:51], v[202:205]
  buffer_load_dwordx4 a[84:87], v162, s[16:19], s67 offen offset:1024 sc1
  v_mfma_f32_16x16x32_bf16 v[206:209], a[152:155], v[48:51], v[206:209]
  v_add_f32 v210, v210, v172
  v_add_f32 v211, v211, v173
  s_waitcnt vmcnt(13)
  v_mfma_f32_16x16x32_bf16 v[194:197], a[156:159], v[12:15], v[194:197]
  v_add_f32 v212, v212, v174
  v_mfma_f32_16x16x32_bf16 v[198:201], a[160:163], v[12:15], v[198:201]
  buffer_load_dwordx4 a[88:91], v162, s[16:19], s68 offen offset:1024 sc1
  v_mfma_f32_16x16x32_bf16 v[202:205], a[164:167], v[12:15], v[202:205]
  v_add_f32 v213, v213, v175
  v_lshlrev_b32 v226, 16, v182
  v_mfma_f32_16x16x32_bf16 v[206:209], a[168:171], v[12:15], v[206:209]
  buffer_load_dwordx4 a[92:95], v162, s[16:19], s70 offen offset:1024 sc1
  s_waitcnt vmcnt(14)
  v_mfma_f32_16x16x32_bf16 v[194:197], a[172:175], v[16:19], v[194:197]
  v_and_b32 v227, 0xffff0000, v182
  v_lshlrev_b32 v228, 16, v183
  v_mfma_f32_16x16x32_bf16 v[198:201], a[176:179], v[16:19], v[198:201]
  v_and_b32 v229, 0xffff0000, v183
  v_mfma_f32_16x16x32_bf16 v[202:205], a[180:183], v[16:19], v[202:205]
  buffer_load_dwordx4 a[96:99], v162, s[16:19], s71 offen offset:1024 sc1
  v_mfma_f32_16x16x32_bf16 v[206:209], a[184:187], v[16:19], v[206:209]
  v_add_f32 v226, v226, v172
  v_add_f32 v227, v227, v173
  s_waitcnt vmcnt(14)
  v_mfma_f32_16x16x32_bf16 v[194:197], a[192:195], v[32:35], v[194:197]
  s_waitcnt vmcnt(12)
  v_accvgpr_read_b32 v1, a48
  v_add_f32 v228, v228, v174
  v_mfma_f32_16x16x32_bf16 v[198:201], a[196:199], v[32:35], v[198:201]
  buffer_load_dwordx4 a[100:103], v162, s[16:19], s72 offen offset:1024 sc1
  v_accvgpr_read_b32 v3, a50
  v_max_u32 v168, v1, v3
  v_mfma_f32_16x16x32_bf16 v[202:205], a[200:203], v[32:35], v[202:205]
  s_waitcnt vmcnt(12)
  v_accvgpr_read_b32 v1, a52
  v_accvgpr_read_b32 v3, a54
  v_mfma_f32_16x16x32_bf16 v[206:209], a[204:207], v[32:35], v[206:209]
  v_max3_u32 v168, v1, v3, v168
  s_waitcnt vmcnt(11)
  v_accvgpr_read_b32 v1, a56
  v_mfma_f32_16x16x32_bf16 v[194:197], a[208:211], v[36:39], v[194:197]
  buffer_load_dwordx4 a[104:107], v162, s[16:19], s73 offen offset:1024 sc1
  v_accvgpr_read_b32 v3, a58
  v_max3_u32 v168, v1, v3, v168
  v_mfma_f32_16x16x32_bf16 v[198:201], a[212:215], v[36:39], v[198:201]
  s_waitcnt vmcnt(11)
  v_accvgpr_read_b32 v1, a60
  v_accvgpr_read_b32 v3, a62
  v_mfma_f32_16x16x32_bf16 v[202:205], a[216:219], v[36:39], v[202:205]
  v_max3_u32 v168, v1, v3, v168
  v_add_f32 v229, v229, v175
  v_add_u32 v162, 122880, v162
  v_mfma_f32_16x16x32_bf16 v[206:209], a[220:223], v[36:39], v[206:209]
  v_cmp_eq_u32 vcc, -1, v168
  s_cbranch_vccnz L_h2g0a
L_h2g0aok:
  v_mfma_f32_16x16x32_bf16 v[210:213], v[80:83], a[48:51], v[210:213]
  v_mfma_f32_16x16x32_bf16 v[214:217], v[84:87], a[48:51], 0
  v_mfma_f32_16x16x32_bf16 v[218:221], v[88:91], a[48:51], 0
  v_mfma_f32_16x16x32_bf16 v[222:225], v[92:95], a[48:51], 0
  v_mfma_f32_16x16x32_bf16 v[210:213], v[96:99], a[52:55], v[210:213]
  v_mfma_f32_16x16x32_bf16 v[214:217], v[100:103], a[52:55], v[214:217]
  v_mfma_f32_16x16x32_bf16 v[218:221], v[104:107], a[52:55], v[218:221]
  v_mfma_f32_16x16x32_bf16 v[222:225], v[108:111], a[52:55], v[222:225]
  v_mfma_f32_16x16x32_bf16 v[210:213], v[112:115], a[56:59], v[210:213]
  s_waitcnt vmcnt(10)
  v_accvgpr_read_b32 v1, a64
  v_mfma_f32_16x16x32_bf16 v[214:217], v[116:119], a[56:59], v[214:217]
  v_accvgpr_read_b32 v3, a66
  v_max_u32 v168, v1, v3
  v_mfma_f32_16x16x32_bf16 v[218:221], v[120:123], a[56:59], v[218:221]
  s_waitcnt vmcnt(9)
  v_accvgpr_read_b32 v1, a68
  v_accvgpr_read_b32 v3, a70
  v_mfma_f32_16x16x32_bf16 v[222:225], v[124:127], a[56:59], v[222:225]
  v_max3_u32 v168, v1, v3, v168
  s_waitcnt vmcnt(8)
  v_accvgpr_read_b32 v1, a72
  v_mfma_f32_16x16x32_bf16 v[210:213], a[240:243], a[60:63], v[210:213]
  v_accvgpr_read_b32 v3, a74
  v_max3_u32 v168, v1, v3, v168
  v_mfma_f32_16x16x32_bf16 v[214:217], a[244:247], a[60:63], v[214:217]
  s_waitcnt vmcnt(7)
  v_accvgpr_read_b32 v1, a76
  v_accvgpr_read_b32 v3, a78
  v_mfma_f32_16x16x32_bf16 v[218:221], a[248:251], a[60:63], v[218:221]
  v_max3_u32 v168, v1, v3, v168
  v_mfma_f32_16x16x32_bf16 v[222:225], a[252:255], a[60:63], v[222:225]
  v_cmp_eq_u32 vcc, -1, v168
  s_cbranch_vccnz L_h2g1a
L_h2g1aok:
  v_mfma_f32_16x16x32_bf16 v[210:213], a[224:227], a[64:67], v[210:213]
  ds_write_b128 v141, v[198:201] offset:16384
  v_mfma_f32_16x16x32_bf16 v[214:217], a[228:231], a[64:67], v[214:217]
  v_mfma_f32_16x16x32_bf16 v[218:221], a[232:235], a[64:67], v[218:221]
  ds_write_b128 v141, v[202:205] offset:17408
  v_mfma_f32_16x16x32_bf16 v[222:225], a[236:239], a[64:67], v[222:225]
  v_mfma_f32_16x16x32_bf16 v[210:213], a[0:3], a[68:71], v[210:213]
  buffer_load_dwordx4 v[64:67], v162, s[16:19], 0 offen offset:0 sc1
  v_mfma_f32_16x16x32_bf16 v[214:217], a[4:7], a[68:71], v[214:217]
  ds_write_b128 v141, v[206:209] offset:18432
  v_mfma_f32_16x16x32_bf16 v[218:221], a[8:11], a[68:71], v[218:221]
  buffer_load_dwordx4 v[68:71], v162, s[16:19], s59 offen offset:1024 sc1
  v_mfma_f32_16x16x32_bf16 v[222:225], a[12:15], a[68:71], v[222:225]
  v_mfma_f32_16x16x32_bf16 v[210:213], a[16:19], a[72:75], v[210:213]
  s_waitcnt vmcnt(8)
  v_accvgpr_read_b32 v1, a80
  v_mfma_f32_16x16x32_bf16 v[214:217], a[20:23], a[72:75], v[214:217]
  v_accvgpr_read_b32 v3, a82
  v_max_u32 v168, v1, v3
  v_mfma_f32_16x16x32_bf16 v[218:221], a[24:27], a[72:75], v[218:221]
  buffer_load_dwordx4 v[72:75], v162, s[16:19], s60 offen offset:1024 sc1
  s_waitcnt vmcnt(8)
  v_accvgpr_read_b32 v1, a84
  v_accvgpr_read_b32 v3, a86
  v_mfma_f32_16x16x32_bf16 v[222:225], a[28:31], a[72:75], v[222:225]
  v_max3_u32 v168, v1, v3, v168
  s_waitcnt vmcnt(7)
  v_accvgpr_read_b32 v1, a88
  v_mfma_f32_16x16x32_bf16 v[210:213], a[32:35], a[76:79], v[210:213]
  buffer_load_dwordx4 v[128:131], v162, s[16:19], s61 offen offset:1024 sc1
  v_accvgpr_read_b32 v3, a90
  v_max3_u32 v168, v1, v3, v168
  v_mfma_f32_16x16x32_bf16 v[214:217], a[36:39], a[76:79], v[214:217]
  s_waitcnt vmcnt(7)
  v_accvgpr_read_b32 v1, a92
  v_accvgpr_read_b32 v3, a94
  v_mfma_f32_16x16x32_bf16 v[218:221], a[40:43], a[76:79], v[218:221]
  v_max3_u32 v168, v1, v3, v168
  v_mfma_f32_16x16x32_bf16 v[222:225], a[44:47], a[76:79], v[222:225]
  buffer_load_dwordx4 v[136:139], v162, s[16:19], s62 offen offset:1024 sc1
  v_cmp_eq_u32 vcc, -1, v168
  s_cbranch_vccnz L_h2g2a
L_h2g2aok:
  v_mfma_f32_16x16x32_bf16 v[210:213], a[108:111], a[80:83], v[210:213]
  buffer_load_dwordx4 v[20:23], v162, s[16:19], s63 offen offset:1024 sc1
  v_mfma_f32_16x16x32_bf16 v[214:217], a[112:115], a[80:83], v[214:217]
  v_mfma_f32_16x16x32_bf16 v[218:221], a[116:119], a[80:83], v[218:221]
  v_mfma_f32_16x16x32_bf16 v[222:225], a[120:123], a[80:83], v[222:225]
  buffer_load_dwordx4 v[40:43], v162, s[16:19], s64 offen offset:1024 sc1
  v_mfma_f32_16x16x32_bf16 v[210:213], a[124:127], a[84:87], v[210:213]
  v_mfma_f32_16x16x32_bf16 v[214:217], a[128:131], a[84:87], v[214:217]
  buffer_load_dwordx4 v[60:63], v162, s[16:19], s65 offen offset:1024 sc1
  v_mfma_f32_16x16x32_bf16 v[218:221], a[132:135], a[84:87], v[218:221]
  v_mfma_f32_16x16x32_bf16 v[222:225], a[136:139], a[84:87], v[222:225]
  v_mfma_f32_16x16x32_bf16 v[210:213], a[140:143], a[88:91], v[210:213]
  buffer_load_dwordx4 v[132:135], v162, s[16:19], s66 offen offset:1024 sc1
  v_mfma_f32_16x16x32_bf16 v[214:217], a[144:147], a[88:91], v[214:217]
  v_mfma_f32_16x16x32_bf16 v[218:221], a[148:151], a[88:91], v[218:221]
  s_waitcnt vmcnt(11)
  v_accvgpr_read_b32 v1, a96
  v_accvgpr_read_b32 v3, a98
  v_mfma_f32_16x16x32_bf16 v[222:225], a[152:155], a[88:91], v[222:225]
  buffer_load_dwordx4 v[44:47], v162, s[16:19], s67 offen offset:1024 sc1
  v_max_u32 v168, v1, v3
  s_waitcnt vmcnt(11)
  v_accvgpr_read_b32 v1, a100
  v_mfma_f32_16x16x32_bf16 v[210:213], a[156:159], a[92:95], v[210:213]
  v_accvgpr_read_b32 v3, a102
  v_max3_u32 v168, v1, v3, v168
  v_mfma_f32_16x16x32_bf16 v[214:217], a[160:163], a[92:95], v[214:217]
  s_waitcnt vmcnt(10)
  v_accvgpr_read_b32 v1, a104
  v_accvgpr_read_b32 v3, a106
  v_mfma_f32_16x16x32_bf16 v[218:221], a[164:167], a[92:95], v[218:221]
  buffer_load_dwordx4 v[48:51], v162, s[16:19], s68 offen offset:1024 sc1
  v_max3_u32 v168, v1, v3, v168
  v_mfma_f32_16x16x32_bf16 v[222:225], a[168:171], a[92:95], v[222:225]
  v_cmp_eq_u32 vcc, -1, v168
  s_cbranch_vccnz L_h2g3a
L_h2g3aok:
  v_mfma_f32_16x16x32_bf16 v[210:213], a[172:175], a[96:99], v[210:213]
  buffer_load_dwordx4 v[12:15], v162, s[16:19], s70 offen offset:1024 sc1
  v_mfma_f32_16x16x32_bf16 v[214:217], a[176:179], a[96:99], v[214:217]
  v_mfma_f32_16x16x32_bf16 v[218:221], a[180:183], a[96:99], v[218:221]
  buffer_load_dwordx4 v[16:19], v162, s[16:19], s71 offen offset:1024 sc1
  v_mfma_f32_16x16x32_bf16 v[222:225], a[184:187], a[96:99], v[222:225]
  v_mfma_f32_16x16x32_bf16 v[210:213], a[192:195], a[100:103], v[210:213]
  buffer_load_dwordx4 v[32:35], v162, s[16:19], s72 offen offset:1024 sc1
  v_mfma_f32_16x16x32_bf16 v[214:217], a[196:199], a[100:103], v[214:217]
  v_mfma_f32_16x16x32_bf16 v[218:221], a[200:203], a[100:103], v[218:221]
  v_mfma_f32_16x16x32_bf16 v[222:225], a[204:207], a[100:103], v[222:225]
  buffer_load_dwordx4 v[36:39], v162, s[16:19], s73 offen offset:1024 sc1
  v_mfma_f32_16x16x32_bf16 v[210:213], a[208:211], a[104:107], v[210:213]
  s_waitcnt vmcnt(14)
  v_max_u32 v168, v64, v66
  v_mfma_f32_16x16x32_bf16 v[214:217], a[212:215], a[104:107], v[214:217]
  s_waitcnt vmcnt(13)
  v_max3_u32 v168, v68, v70, v168
  s_waitcnt vmcnt(12)
  v_max3_u32 v168, v72, v74, v168
  v_mfma_f32_16x16x32_bf16 v[218:221], a[216:219], a[104:107], v[218:221]
  s_waitcnt vmcnt(11)
  v_max3_u32 v168, v128, v130, v168
  v_mfma_f32_16x16x32_bf16 v[222:225], a[220:223], a[104:107], v[222:225]
  v_cmp_eq_u32 vcc, -1, v168
  s_cbranch_vccnz L_h3g0a
L_h3g0aok:
  v_mfma_f32_16x16x32_bf16 v[226:229], v[80:83], v[64:67], v[226:229]
  v_mfma_f32_16x16x32_bf16 v[230:233], v[84:87], v[64:67], 0
  v_mfma_f32_16x16x32_bf16 v[234:237], v[88:91], v[64:67], 0
  ds_write_b128 v141, v[214:217] offset:32768
  v_mfma_f32_16x16x32_bf16 v[238:241], v[92:95], v[64:67], 0
  ds_write_b128 v141, v[218:221] offset:33792
  v_mfma_f32_16x16x32_bf16 v[226:229], v[96:99], v[68:71], v[226:229]
  v_mfma_f32_16x16x32_bf16 v[230:233], v[100:103], v[68:71], v[230:233]
  v_mfma_f32_16x16x32_bf16 v[234:237], v[104:107], v[68:71], v[234:237]
  ds_write_b128 v141, v[222:225] offset:34816
  v_mfma_f32_16x16x32_bf16 v[238:241], v[108:111], v[68:71], v[238:241]
  v_mfma_f32_16x16x32_bf16 v[226:229], v[112:115], v[72:75], v[226:229]
  v_mfma_f32_16x16x32_bf16 v[230:233], v[116:119], v[72:75], v[230:233]
  v_mfma_f32_16x16x32_bf16 v[234:237], v[120:123], v[72:75], v[234:237]
  s_waitcnt lgkmcnt(0)
  s_barrier
  v_mfma_f32_16x16x32_bf16 v[238:241], v[124:127], v[72:75], v[238:241]
  ds_read_b128 v[8:11], v142 offset:0
  v_mfma_f32_16x16x32_bf16 v[226:229], a[240:243], v[128:131], v[226:229]
  ds_read_b128 v[24:27], v143 offset:0
  s_waitcnt vmcnt(10)
  v_max_u32 v168, v136, v138
  v_mfma_f32_16x16x32_bf16 v[230:233], a[244:247], v[128:131], v[230:233]
  s_waitcnt vmcnt(9)
  v_max3_u32 v168, v20, v22, v168
  s_waitcnt vmcnt(8)
  v_max3_u32 v168, v40, v42, v168
  v_mfma_f32_16x16x32_bf16 v[234:237], a[248:251], v[128:131], v[234:237]
  ds_read_b128 v[28:31], v144 offset:0
  s_waitcnt vmcnt(7)
  v_max3_u32 v168, v60, v62, v168
  v_mfma_f32_16x16x32_bf16 v[238:241], a[252:255], v[128:131], v[238:241]
  v_cmp_eq_u32 vcc, -1, v168
  s_cbranch_vccnz L_h3g1a
L_h3g1aok:
  v_mfma_f32_16x16x32_bf16 v[226:229], a[224:227], v[136:139], v[226:229]
  ds_read_b128 v[198:201], v142 offset:16384
  v_mfma_f32_16x16x32_bf16 v[230:233], a[228:231], v[136:139], v[230:233]
  ds_read_b128 v[202:205], v143 offset:16384
  v_mfma_f32_16x16x32_bf16 v[234:237], a[232:235], v[136:139], v[234:237]
  ds_read_b128 v[206:209], v144 offset:16384
  v_mfma_f32_16x16x32_bf16 v[238:241], a[236:239], v[136:139], v[238:241]
  ds_read_b128 v[214:217], v142 offset:32768
  v_mfma_f32_16x16x32_bf16 v[226:229], a[0:3], v[20:23], v[226:229]
  ds_read_b128 v[218:221], v143 offset:32768
  v_mfma_f32_16x16x32_bf16 v[230:233], a[4:7], v[20:23], v[230:233]
  ds_read_b128 v[222:225], v144 offset:32768
  s_waitcnt lgkmcnt(7)
  v_add_f32 v8, v8, v24
  v_mfma_f32_16x16x32_bf16 v[234:237], a[8:11], v[20:23], v[234:237]
  v_add_f32 v9, v9, v25
  v_add_f32 v10, v10, v26
  v_mfma_f32_16x16x32_bf16 v[238:241], a[12:15], v[20:23], v[238:241]
  v_add_f32 v11, v11, v27
  s_waitcnt lgkmcnt(6)
  v_add_f32 v4, v4, v28
  v_mfma_f32_16x16x32_bf16 v[226:229], a[16:19], v[40:43], v[226:229]
  v_add_f32 v5, v5, v29
  v_add_f32 v6, v6, v30
  v_mfma_f32_16x16x32_bf16 v[230:233], a[20:23], v[40:43], v[230:233]
  v_add_f32 v7, v7, v31
  v_add_f32 v4, v4, v8
  v_mfma_f32_16x16x32_bf16 v[234:237], a[24:27], v[40:43], v[234:237]
  v_add_f32 v5, v5, v9
  v_add_f32 v6, v6, v10
  v_mfma_f32_16x16x32_bf16 v[238:241], a[28:31], v[40:43], v[238:241]
  v_add_f32 v7, v7, v11
  v_cvt_pk_bf16_f32 v4, v4, v5
  v_mfma_f32_16x16x32_bf16 v[226:229], a[32:35], v[60:63], v[226:229]
  s_waitcnt vmcnt(6)
  v_max_u32 v168, v132, v134
  v_cvt_pk_bf16_f32 v5, v6, v7
  v_mfma_f32_16x16x32_bf16 v[230:233], a[36:39], v[60:63], v[230:233]
  s_waitcnt vmcnt(5)
  v_max3_u32 v168, v44, v46, v168
  s_waitcnt vmcnt(4)
  v_max3_u32 v168, v48, v50, v168
  v_mfma_f32_16x16x32_bf16 v[234:237], a[40:43], v[60:63], v[234:237]
  s_waitcnt vmcnt(3)
  v_max3_u32 v168, v12, v14, v168
  v_mfma_f32_16x16x32_bf16 v[238:241], a[44:47], v[60:63], v[238:241]
  v_cmp_eq_u32 vcc, -1, v168
  s_cbranch_vccnz L_h3g2a
L_h3g2aok:
  v_mfma_f32_16x16x32_bf16 v[226:229], a[108:111], v[132:135], v[226:229]
  s_mov_b32 s4, 0
  buffer_store_dwordx2 v[4:5], v140, s[52:55], s4 offen
  v_mfma_f32_16x16x32_bf16 v[230:233], a[112:115], v[132:135], v[230:233]
  s_waitcnt lgkmcnt(4)
  v_add_f32 v198, v198, v202
  v_add_f32 v199, v199, v203
  v_mfma_f32_16x16x32_bf16 v[234:237], a[116:119], v[132:135], v[234:237]
  v_add_f32 v200, v200, v204
  v_add_f32 v201, v201, v205
  v_mfma_f32_16x16x32_bf16 v[238:241], a[120:123], v[132:135], v[238:241]
  s_waitcnt lgkmcnt(3)
  v_add_f32 v194, v194, v206
  v_add_f32 v195, v195, v207
  v_mfma_f32_16x16x32_bf16 v[226:229], a[124:127], v[44:47], v[226:229]
  v_add_f32 v196, v196, v208
  v_add_f32 v197, v197, v209
  v_mfma_f32_16x16x32_bf16 v[230:233], a[128:131], v[44:47], v[230:233]
  v_add_f32 v194, v194, v198
  v_add_f32 v195, v195, v199
  v_mfma_f32_16x16x32_bf16 v[234:237], a[132:135], v[44:47], v[234:237]
  v_add_f32 v196, v196, v200
  v_add_f32 v197, v197, v201
  v_mfma_f32_16x16x32_bf16 v[238:241], a[136:139], v[44:47], v[238:241]
  v_cvt_pk_bf16_f32 v194, v194, v195
  v_cvt_pk_bf16_f32 v195, v196, v197
  v_mfma_f32_16x16x32_bf16 v[226:229], a[140:143], v[48:51], v[226:229]
  s_mov_b32 s4, 65536
  buffer_store_dwordx2 v[194:195], v140, s[52:55], s4 offen
  v_mfma_f32_16x16x32_bf16 v[230:233], a[144:147], v[48:51], v[230:233]
  v_mfma_f32_16x16x32_bf16 v[234:237], a[148:151], v[48:51], v[234:237]
  s_waitcnt lgkmcnt(1)
  v_add_f32 v214, v214, v218
  v_mfma_f32_16x16x32_bf16 v[238:241], a[152:155], v[48:51], v[238:241]
  v_add_f32 v215, v215, v219
  v_add_f32 v216, v216, v220
  v_mfma_f32_16x16x32_bf16 v[226:229], a[156:159], v[12:15], v[226:229]
  v_add_f32 v217, v217, v221
  v_mfma_f32_16x16x32_bf16 v[230:233], a[160:163], v[12:15], v[230:233]
  s_waitcnt vmcnt(4)
  v_max_u32 v168, v16, v18
  s_waitcnt vmcnt(3)
  v_max3_u32 v168, v32, v34, v168
  v_mfma_f32_16x16x32_bf16 v[234:237], a[164:167], v[12:15], v[234:237]
  s_waitcnt vmcnt(2)
  v_max3_u32 v168, v36, v38, v168
  s_waitcnt lgkmcnt(0)
  v_add_f32 v210, v210, v222
  v_mfma_f32_16x16x32_bf16 v[238:241], a[168:171], v[12:15], v[238:241]
  v_cmp_eq_u32 vcc, -1, v168
  s_cbranch_vccnz L_h3g3a
L_h3g3aok:
  v_mfma_f32_16x16x32_bf16 v[226:229], a[172:175], v[16:19], v[226:229]
  v_add_f32 v211, v211, v223
  v_add_f32 v212, v212, v224
  v_mfma_f32_16x16x32_bf16 v[230:233], a[176:179], v[16:19], v[230:233]
  v_add_f32 v213, v213, v225
  v_add_f32 v210, v210, v214
  v_mfma_f32_16x16x32_bf16 v[234:237], a[180:183], v[16:19], v[234:237]
  v_add_f32 v211, v211, v215
  v_add_f32 v212, v212, v216
  v_mfma_f32_16x16x32_bf16 v[238:241], a[184:187], v[16:19], v[238:241]
  v_add_f32 v213, v213, v217
  v_cvt_pk_bf16_f32 v210, v210, v211
  v_mfma_f32_16x16x32_bf16 v[226:229], a[192:195], v[32:35], v[226:229]
  v_cvt_pk_bf16_f32 v211, v212, v213
  v_mfma_f32_16x16x32_bf16 v[230:233], a[196:199], v[32:35], v[230:233]
  s_mov_b32 s4, 131072
  buffer_store_dwordx2 v[210:211], v140, s[52:55], s4 offen
  v_mfma_f32_16x16x32_bf16 v[234:237], a[200:203], v[32:35], v[234:237]
  v_mfma_f32_16x16x32_bf16 v[238:241], a[204:207], v[32:35], v[238:241]
  v_mfma_f32_16x16x32_bf16 v[226:229], a[208:211], v[36:39], v[226:229]
  v_mfma_f32_16x16x32_bf16 v[230:233], a[212:215], v[36:39], v[230:233]
  v_mfma_f32_16x16x32_bf16 v[234:237], a[216:219], v[36:39], v[234:237]
  v_mfma_f32_16x16x32_bf16 v[238:241], a[220:223], v[36:39], v[238:241]
  s_nop 5
  ds_write_b128 v141, v[230:233] offset:49152
  ds_write_b128 v141, v[234:237] offset:50176
  ds_write_b128 v141, v[238:241] offset:51200
  s_waitcnt lgkmcnt(0)
  s_barrier
  ds_read_b128 v[230:233], v142 offset:49152
  ds_read_b128 v[234:237], v143 offset:49152
  ds_read_b128 v[238:241], v144 offset:49152
  s_waitcnt lgkmcnt(1)
  v_pk_add_f32 v[230:231], v[230:231], v[234:235]
  v_pk_add_f32 v[232:233], v[232:233], v[236:237]
  s_waitcnt lgkmcnt(0)
  v_pk_add_f32 v[226:227], v[226:227], v[238:239]
  v_pk_add_f32 v[228:229], v[228:229], v[240:241]
  v_pk_add_f32 v[226:227], v[226:227], v[230:231]
  v_pk_add_f32 v[228:229], v[228:229], v[232:233]
  v_cvt_pk_bf16_f32 v226, v226, v227
  v_cvt_pk_bf16_f32 v227, v228, v229
  s_mov_b32 s4, 196608
  buffer_store_dwordx2 v[226:227], v140, s[52:55], s4 offen
  s_endpgm

L_epa:
  s_sub_u32 s81, s81, 1
  s_cselect_b32 s81, 0, s81
  s_cbranch_scc1 L_epaok
  buffer_load_dword v167, v166, s[84:87], 0 offen offset:0 sc1
  s_waitcnt vmcnt(0)
  v_readlane_b32 s24, v167, s27
  v_readlane_b32 s25, v167, s5
  s_nop 1
  s_min_u32 s4, s24, s25
  s_cmp_eq_u32 s4, 0
  s_cbranch_scc1 L_epa
  s_branch L_epaok

L_h2g0a:
  s_sub_u32 s81, s81, 1
  s_cselect_b32 s81, 0, s81
  s_cbranch_scc1 L_h2g0aok
  v_subrev_u32 v167, 122880, v162
  s_waitcnt vmcnt(0)
  v_accvgpr_read_b32 v1, a48
  v_accvgpr_read_b32 v3, a50
  v_max_u32 v168, v1, v3
  v_cmp_eq_u32 vcc, -1, v168
  s_cbranch_vccz L_h2g0as0
  buffer_load_dwordx4 a[48:51], v167, s[16:19], 0 offen offset:0 sc1
L_h2g0as0:
  v_accvgpr_read_b32 v1, a52
  v_accvgpr_read_b32 v3, a54
  v_max_u32 v168, v1, v3
  v_cmp_eq_u32 vcc, -1, v168
  s_cbranch_vccz L_h2g0as1
  buffer_load_dwordx4 a[52:55], v167, s[16:19], s59 offen offset:1024 sc1
L_h2g0as1:
  v_accvgpr_read_b32 v1, a56
  v_accvgpr_read_b32 v3, a58
  v_max_u32 v168, v1, v3
  v_cmp_eq_u32 vcc, -1, v168
  s_cbranch_vccz L_h2g0as2
  buffer_load_dwordx4 a[56:59], v167, s[16:19], s60 offen offset:1024 sc1
L_h2g0as2:
  v_accvgpr_read_b32 v1, a60
  v_accvgpr_read_b32 v3, a62
  v_max_u32 v168, v1, v3
  v_cmp_eq_u32 vcc, -1, v168
  s_cbranch_vccz L_h2g0as3
  buffer_load_dwordx4 a[60:63], v167, s[16:19], s61 offen offset:1024 sc1
L_h2g0as3:
  v_accvgpr_read_b32 v1, a64
  v_accvgpr_read_b32 v3, a66
  v_max_u32 v168, v1, v3
  v_cmp_eq_u32 vcc, -1, v168
  s_cbranch_vccz L_h2g0as4
  buffer_load_dwordx4 a[64:67], v167, s[16:19], s62 offen offset:1024 sc1
L_h2g0as4:
  v_accvgpr_read_b32 v1, a68
  v_accvgpr_read_b32 v3, a70
  v_max_u32 v168, v1, v3
  v_cmp_eq_u32 vcc, -1, v168
  s_cbranch_vccz L_h2g0as5
  buffer_load_dwordx4 a[68:71], v167, s[16:19], s63 offen offset:1024 sc1
L_h2g0as5:
  v_accvgpr_read_b32 v1, a72
  v_accvgpr_read_b32 v3, a74
  v_max_u32 v168, v1, v3
  v_cmp_eq_u32 vcc, -1, v168
  s_cbranch_vccz L_h2g0as6
  buffer_load_dwordx4 a[72:75], v167, s[16:19], s64 offen offset:1024 sc1
L_h2g0as6:
  v_accvgpr_read_b32 v1, a76
  v_accvgpr_read_b32 v3, a78
  v_max_u32 v168, v1, v3
  v_cmp_eq_u32 vcc, -1, v168
  s_cbranch_vccz L_h2g0as7
  buffer_load_dwordx4 a[76:79], v167, s[16:19], s65 offen offset:1024 sc1
L_h2g0as7:
  v_accvgpr_read_b32 v1, a80
  v_accvgpr_read_b32 v3, a82
  v_max_u32 v168, v1, v3
  v_cmp_eq_u32 vcc, -1, v168
  s_cbranch_vccz L_h2g0as8
  buffer_load_dwordx4 a[80:83], v167, s[16:19], s66 offen offset:1024 sc1
L_h2g0as8:
  v_accvgpr_read_b32 v1, a84
  v_accvgpr_read_b32 v3, a86
  v_max_u32 v168, v1, v3
  v_cmp_eq_u32 vcc, -1, v168
  s_cbranch_vccz L_h2g0as9
  buffer_load_dwordx4 a[84:87], v167, s[16:19], s67 offen offset:1024 sc1
L_h2g0as9:
  v_accvgpr_read_b32 v1, a88
  v_accvgpr_read_b32 v3, a90
  v_max_u32 v168, v1, v3
  v_cmp_eq_u32 vcc, -1, v168
  s_cbranch_vccz L_h2g0as10
  buffer_load_dwordx4 a[88:91], v167, s[16:19], s68 offen offset:1024 sc1
L_h2g0as10:
  v_accvgpr_read_b32 v1, a92
  v_accvgpr_read_b32 v3, a94
  v_max_u32 v168, v1, v3
  v_cmp_eq_u32 vcc, -1, v168
  s_cbranch_vccz L_h2g0as11
  buffer_load_dwordx4 a[92:95], v167, s[16:19], s70 offen offset:1024 sc1
L_h2g0as11:
  v_accvgpr_read_b32 v1, a96
  v_accvgpr_read_b32 v3, a98
  v_max_u32 v168, v1, v3
  v_cmp_eq_u32 vcc, -1, v168
  s_cbranch_vccz L_h2g0as12
  buffer_load_dwordx4 a[96:99], v167, s[16:19], s71 offen offset:1024 sc1
L_h2g0as12:
  v_accvgpr_read_b32 v1, a100
  v_accvgpr_read_b32 v3, a102
  v_max_u32 v168, v1, v3
  v_cmp_eq_u32 vcc, -1, v168
  s_cbranch_vccz L_h2g0as13
  buffer_load_dwordx4 a[100:103], v167, s[16:19], s72 offen offset:1024 sc1
L_h2g0as13:
  v_accvgpr_read_b32 v1, a104
  v_accvgpr_read_b32 v3, a106
  v_max_u32 v168, v1, v3
  v_cmp_eq_u32 vcc, -1, v168
  s_cbranch_vccz L_h2g0as14
  buffer_load_dwordx4 a[104:107], v167, s[16:19], s73 offen offset:1024 sc1
L_h2g0as14:
  s_waitcnt vmcnt(0)
  v_accvgpr_read_b32 v1, a48
  v_accvgpr_read_b32 v3, a50
  v_max_u32 v168, v1, v3
  v_accvgpr_read_b32 v1, a52
  v_accvgpr_read_b32 v3, a54
  v_max3_u32 v168, v1, v3, v168
  v_accvgpr_read_b32 v1, a56
  v_accvgpr_read_b32 v3, a58
  v_max3_u32 v168, v1, v3, v168
  v_accvgpr_read_b32 v1, a60
  v_accvgpr_read_b32 v3, a62
  v_max3_u32 v168, v1, v3, v168
  v_cmp_eq_u32 vcc, -1, v168
  s_cbranch_vccnz L_h2g0a
  s_branch L_h2g0aok

L_h2g1a:
  s_sub_u32 s81, s81, 1
  s_cselect_b32 s81, 0, s81
  s_cbranch_scc1 L_h2g1aok
  v_subrev_u32 v167, 122880, v162
  s_waitcnt vmcnt(0)
  v_accvgpr_read_b32 v1, a64
  v_accvgpr_read_b32 v3, a66
  v_max_u32 v168, v1, v3
  v_cmp_eq_u32 vcc, -1, v168
  s_cbranch_vccz L_h2g1as4
  buffer_load_dwordx4 a[64:67], v167, s[16:19], s62 offen offset:1024 sc1
L_h2g1as4:
  v_accvgpr_read_b32 v1, a68
  v_accvgpr_read_b32 v3, a70
  v_max_u32 v168, v1, v3
  v_cmp_eq_u32 vcc, -1, v168
  s_cbranch_vccz L_h2g1as5
  buffer_load_dwordx4 a[68:71], v167, s[16:19], s63 offen offset:1024 sc1
L_h2g1as5:
  v_accvgpr_read_b32 v1, a72
  v_accvgpr_read_b32 v3, a74
  v_max_u32 v168, v1, v3
  v_cmp_eq_u32 vcc, -1, v168
  s_cbranch_vccz L_h2g1as6
  buffer_load_dwordx4 a[72:75], v167, s[16:19], s64 offen offset:1024 sc1
L_h2g1as6:
  v_accvgpr_read_b32 v1, a76
  v_accvgpr_read_b32 v3, a78
  v_max_u32 v168, v1, v3
  v_cmp_eq_u32 vcc, -1, v168
  s_cbranch_vccz L_h2g1as7
  buffer_load_dwordx4 a[76:79], v167, s[16:19], s65 offen offset:1024 sc1
L_h2g1as7:
  v_accvgpr_read_b32 v1, a80
  v_accvgpr_read_b32 v3, a82
  v_max_u32 v168, v1, v3
  v_cmp_eq_u32 vcc, -1, v168
  s_cbranch_vccz L_h2g1as8
  buffer_load_dwordx4 a[80:83], v167, s[16:19], s66 offen offset:1024 sc1
L_h2g1as8:
  v_accvgpr_read_b32 v1, a84
  v_accvgpr_read_b32 v3, a86
  v_max_u32 v168, v1, v3
  v_cmp_eq_u32 vcc, -1, v168
  s_cbranch_vccz L_h2g1as9
  buffer_load_dwordx4 a[84:87], v167, s[16:19], s67 offen offset:1024 sc1
L_h2g1as9:
  v_accvgpr_read_b32 v1, a88
  v_accvgpr_read_b32 v3, a90
  v_max_u32 v168, v1, v3
  v_cmp_eq_u32 vcc, -1, v168
  s_cbranch_vccz L_h2g1as10
  buffer_load_dwordx4 a[88:91], v167, s[16:19], s68 offen offset:1024 sc1
L_h2g1as10:
  v_accvgpr_read_b32 v1, a92
  v_accvgpr_read_b32 v3, a94
  v_max_u32 v168, v1, v3
  v_cmp_eq_u32 vcc, -1, v168
  s_cbranch_vccz L_h2g1as11
  buffer_load_dwordx4 a[92:95], v167, s[16:19], s70 offen offset:1024 sc1
L_h2g1as11:
  v_accvgpr_read_b32 v1, a96
  v_accvgpr_read_b32 v3, a98
  v_max_u32 v168, v1, v3
  v_cmp_eq_u32 vcc, -1, v168
  s_cbranch_vccz L_h2g1as12
  buffer_load_dwordx4 a[96:99], v167, s[16:19], s71 offen offset:1024 sc1
L_h2g1as12:
  v_accvgpr_read_b32 v1, a100
  v_accvgpr_read_b32 v3, a102
  v_max_u32 v168, v1, v3
  v_cmp_eq_u32 vcc, -1, v168
  s_cbranch_vccz L_h2g1as13
  buffer_load_dwordx4 a[100:103], v167, s[16:19], s72 offen offset:1024 sc1
L_h2g1as13:
  v_accvgpr_read_b32 v1, a104
  v_accvgpr_read_b32 v3, a106
  v_max_u32 v168, v1, v3
  v_cmp_eq_u32 vcc, -1, v168
  s_cbranch_vccz L_h2g1as14
  buffer_load_dwordx4 a[104:107], v167, s[16:19], s73 offen offset:1024 sc1
L_h2g1as14:
  s_waitcnt vmcnt(0)
  v_accvgpr_read_b32 v1, a64
  v_accvgpr_read_b32 v3, a66
  v_max_u32 v168, v1, v3
  v_accvgpr_read_b32 v1, a68
  v_accvgpr_read_b32 v3, a70
  v_max3_u32 v168, v1, v3, v168
  v_accvgpr_read_b32 v1, a72
  v_accvgpr_read_b32 v3, a74
  v_max3_u32 v168, v1, v3, v168
  v_accvgpr_read_b32 v1, a76
  v_accvgpr_read_b32 v3, a78
  v_max3_u32 v168, v1, v3, v168
  v_cmp_eq_u32 vcc, -1, v168
  s_cbranch_vccnz L_h2g1a
  s_branch L_h2g1aok

L_h2g2a:
  s_sub_u32 s81, s81, 1
  s_cselect_b32 s81, 0, s81
  s_cbranch_scc1 L_h2g2aok
  v_subrev_u32 v167, 122880, v162
  s_waitcnt vmcnt(0)
  v_accvgpr_read_b32 v1, a80
  v_accvgpr_read_b32 v3, a82
  v_max_u32 v168, v1, v3
  v_cmp_eq_u32 vcc, -1, v168
  s_cbranch_vccz L_h2g2as8
  buffer_load_dwordx4 a[80:83], v167, s[16:19], s66 offen offset:1024 sc1
L_h2g2as8:
  v_accvgpr_read_b32 v1, a84
  v_accvgpr_read_b32 v3, a86
  v_max_u32 v168, v1, v3
  v_cmp_eq_u32 vcc, -1, v168
  s_cbranch_vccz L_h2g2as9
  buffer_load_dwordx4 a[84:87], v167, s[16:19], s67 offen offset:1024 sc1
L_h2g2as9:
  v_accvgpr_read_b32 v1, a88
  v_accvgpr_read_b32 v3, a90
  v_max_u32 v168, v1, v3
  v_cmp_eq_u32 vcc, -1, v168
  s_cbranch_vccz L_h2g2as10
  buffer_load_dwordx4 a[88:91], v167, s[16:19], s68 offen offset:1024 sc1
L_h2g2as10:
  v_accvgpr_read_b32 v1, a92
  v_accvgpr_read_b32 v3, a94
  v_max_u32 v168, v1, v3
  v_cmp_eq_u32 vcc, -1, v168
  s_cbranch_vccz L_h2g2as11
  buffer_load_dwordx4 a[92:95], v167, s[16:19], s70 offen offset:1024 sc1
L_h2g2as11:
  v_accvgpr_read_b32 v1, a96
  v_accvgpr_read_b32 v3, a98
  v_max_u32 v168, v1, v3
  v_cmp_eq_u32 vcc, -1, v168
  s_cbranch_vccz L_h2g2as12
  buffer_load_dwordx4 a[96:99], v167, s[16:19], s71 offen offset:1024 sc1
L_h2g2as12:
  v_accvgpr_read_b32 v1, a100
  v_accvgpr_read_b32 v3, a102
  v_max_u32 v168, v1, v3
  v_cmp_eq_u32 vcc, -1, v168
  s_cbranch_vccz L_h2g2as13
  buffer_load_dwordx4 a[100:103], v167, s[16:19], s72 offen offset:1024 sc1
L_h2g2as13:
  v_accvgpr_read_b32 v1, a104
  v_accvgpr_read_b32 v3, a106
  v_max_u32 v168, v1, v3
  v_cmp_eq_u32 vcc, -1, v168
  s_cbranch_vccz L_h2g2as14
  buffer_load_dwordx4 a[104:107], v167, s[16:19], s73 offen offset:1024 sc1
L_h2g2as14:
  s_waitcnt vmcnt(0)
  v_accvgpr_read_b32 v1, a80
  v_accvgpr_read_b32 v3, a82
  v_max_u32 v168, v1, v3
  v_accvgpr_read_b32 v1, a84
  v_accvgpr_read_b32 v3, a86
  v_max3_u32 v168, v1, v3, v168
  v_accvgpr_read_b32 v1, a88
  v_accvgpr_read_b32 v3, a90
  v_max3_u32 v168, v1, v3, v168
  v_accvgpr_read_b32 v1, a92
  v_accvgpr_read_b32 v3, a94
  v_max3_u32 v168, v1, v3, v168
  v_cmp_eq_u32 vcc, -1, v168
  s_cbranch_vccnz L_h2g2a
  s_branch L_h2g2aok

L_h2g3a:
  s_sub_u32 s81, s81, 1
  s_cselect_b32 s81, 0, s81
  s_cbranch_scc1 L_h2g3aok
  v_subrev_u32 v167, 122880, v162
  s_waitcnt vmcnt(0)
  v_accvgpr_read_b32 v1, a96
  v_accvgpr_read_b32 v3, a98
  v_max_u32 v168, v1, v3
  v_cmp_eq_u32 vcc, -1, v168
  s_cbranch_vccz L_h2g3as12
  buffer_load_dwordx4 a[96:99], v167, s[16:19], s71 offen offset:1024 sc1
L_h2g3as12:
  v_accvgpr_read_b32 v1, a100
  v_accvgpr_read_b32 v3, a102
  v_max_u32 v168, v1, v3
  v_cmp_eq_u32 vcc, -1, v168
  s_cbranch_vccz L_h2g3as13
  buffer_load_dwordx4 a[100:103], v167, s[16:19], s72 offen offset:1024 sc1
L_h2g3as13:
  v_accvgpr_read_b32 v1, a104
  v_accvgpr_read_b32 v3, a106
  v_max_u32 v168, v1, v3
  v_cmp_eq_u32 vcc, -1, v168
  s_cbranch_vccz L_h2g3as14
  buffer_load_dwordx4 a[104:107], v167, s[16:19], s73 offen offset:1024 sc1
L_h2g3as14:
  s_waitcnt vmcnt(0)
  v_accvgpr_read_b32 v1, a96
  v_accvgpr_read_b32 v3, a98
  v_max_u32 v168, v1, v3
  v_accvgpr_read_b32 v1, a100
  v_accvgpr_read_b32 v3, a102
  v_max3_u32 v168, v1, v3, v168
  v_accvgpr_read_b32 v1, a104
  v_accvgpr_read_b32 v3, a106
  v_max3_u32 v168, v1, v3, v168
  v_cmp_eq_u32 vcc, -1, v168
  s_cbranch_vccnz L_h2g3a
  s_branch L_h2g3aok

L_h3g0a:
  s_sub_u32 s81, s81, 1
  s_cselect_b32 s81, 0, s81
  s_cbranch_scc1 L_h3g0aok
  v_subrev_u32 v167, 0, v162
  s_waitcnt vmcnt(0)
  v_max_u32 v168, v64, v66
  v_cmp_eq_u32 vcc, -1, v168
  s_cbranch_vccz L_h3g0as0
  buffer_load_dwordx4 v[64:67], v167, s[16:19], 0 offen offset:0 sc1
L_h3g0as0:
  v_max_u32 v168, v68, v70
  v_cmp_eq_u32 vcc, -1, v168
  s_cbranch_vccz L_h3g0as1
  buffer_load_dwordx4 v[68:71], v167, s[16:19], s59 offen offset:1024 sc1
L_h3g0as1:
  v_max_u32 v168, v72, v74
  v_cmp_eq_u32 vcc, -1, v168
  s_cbranch_vccz L_h3g0as2
  buffer_load_dwordx4 v[72:75], v167, s[16:19], s60 offen offset:1024 sc1
L_h3g0as2:
  v_max_u32 v168, v128, v130
  v_cmp_eq_u32 vcc, -1, v168
  s_cbranch_vccz L_h3g0as3
  buffer_load_dwordx4 v[128:131], v167, s[16:19], s61 offen offset:1024 sc1
L_h3g0as3:
  v_max_u32 v168, v136, v138
  v_cmp_eq_u32 vcc, -1, v168
  s_cbranch_vccz L_h3g0as4
  buffer_load_dwordx4 v[136:139], v167, s[16:19], s62 offen offset:1024 sc1
L_h3g0as4:
  v_max_u32 v168, v20, v22
  v_cmp_eq_u32 vcc, -1, v168
  s_cbranch_vccz L_h3g0as5
  buffer_load_dwordx4 v[20:23], v167, s[16:19], s63 offen offset:1024 sc1
L_h3g0as5:
  v_max_u32 v168, v40, v42
  v_cmp_eq_u32 vcc, -1, v168
  s_cbranch_vccz L_h3g0as6
  buffer_load_dwordx4 v[40:43], v167, s[16:19], s64 offen offset:1024 sc1
L_h3g0as6:
  v_max_u32 v168, v60, v62
  v_cmp_eq_u32 vcc, -1, v168
  s_cbranch_vccz L_h3g0as7
  buffer_load_dwordx4 v[60:63], v167, s[16:19], s65 offen offset:1024 sc1
L_h3g0as7:
  v_max_u32 v168, v132, v134
  v_cmp_eq_u32 vcc, -1, v168
  s_cbranch_vccz L_h3g0as8
  buffer_load_dwordx4 v[132:135], v167, s[16:19], s66 offen offset:1024 sc1
L_h3g0as8:
  v_max_u32 v168, v44, v46
  v_cmp_eq_u32 vcc, -1, v168
  s_cbranch_vccz L_h3g0as9
  buffer_load_dwordx4 v[44:47], v167, s[16:19], s67 offen offset:1024 sc1
L_h3g0as9:
  v_max_u32 v168, v48, v50
  v_cmp_eq_u32 vcc, -1, v168
  s_cbranch_vccz L_h3g0as10
  buffer_load_dwordx4 v[48:51], v167, s[16:19], s68 offen offset:1024 sc1
L_h3g0as10:
  v_max_u32 v168, v12, v14
  v_cmp_eq_u32 vcc, -1, v168
  s_cbranch_vccz L_h3g0as11
  buffer_load_dwordx4 v[12:15], v167, s[16:19], s70 offen offset:1024 sc1
L_h3g0as11:
  v_max_u32 v168, v16, v18
  v_cmp_eq_u32 vcc, -1, v168
  s_cbranch_vccz L_h3g0as12
  buffer_load_dwordx4 v[16:19], v167, s[16:19], s71 offen offset:1024 sc1
L_h3g0as12:
  v_max_u32 v168, v32, v34
  v_cmp_eq_u32 vcc, -1, v168
  s_cbranch_vccz L_h3g0as13
  buffer_load_dwordx4 v[32:35], v167, s[16:19], s72 offen offset:1024 sc1
L_h3g0as13:
  v_max_u32 v168, v36, v38
  v_cmp_eq_u32 vcc, -1, v168
  s_cbranch_vccz L_h3g0as14
  buffer_load_dwordx4 v[36:39], v167, s[16:19], s73 offen offset:1024 sc1
L_h3g0as14:
  s_waitcnt vmcnt(0)
  v_max_u32 v168, v64, v66
  v_max3_u32 v168, v68, v70, v168
  v_max3_u32 v168, v72, v74, v168
  v_max3_u32 v168, v128, v130, v168
  v_cmp_eq_u32 vcc, -1, v168
  s_cbranch_vccnz L_h3g0a
  s_branch L_h3g0aok

L_h3g1a:
  s_sub_u32 s81, s81, 1
  s_cselect_b32 s81, 0, s81
  s_cbranch_scc1 L_h3g1aok
  v_subrev_u32 v167, 0, v162
  s_waitcnt vmcnt(0)
  v_max_u32 v168, v136, v138
  v_cmp_eq_u32 vcc, -1, v168
  s_cbranch_vccz L_h3g1as4
  buffer_load_dwordx4 v[136:139], v167, s[16:19], s62 offen offset:1024 sc1
L_h3g1as4:
  v_max_u32 v168, v20, v22
  v_cmp_eq_u32 vcc, -1, v168
  s_cbranch_vccz L_h3g1as5
  buffer_load_dwordx4 v[20:23], v167, s[16:19], s63 offen offset:1024 sc1
L_h3g1as5:
  v_max_u32 v168, v40, v42
  v_cmp_eq_u32 vcc, -1, v168
  s_cbranch_vccz L_h3g1as6
  buffer_load_dwordx4 v[40:43], v167, s[16:19], s64 offen offset:1024 sc1
L_h3g1as6:
  v_max_u32 v168, v60, v62
  v_cmp_eq_u32 vcc, -1, v168
  s_cbranch_vccz L_h3g1as7
  buffer_load_dwordx4 v[60:63], v167, s[16:19], s65 offen offset:1024 sc1
L_h3g1as7:
  v_max_u32 v168, v132, v134
  v_cmp_eq_u32 vcc, -1, v168
  s_cbranch_vccz L_h3g1as8
  buffer_load_dwordx4 v[132:135], v167, s[16:19], s66 offen offset:1024 sc1
L_h3g1as8:
  v_max_u32 v168, v44, v46
  v_cmp_eq_u32 vcc, -1, v168
  s_cbranch_vccz L_h3g1as9
  buffer_load_dwordx4 v[44:47], v167, s[16:19], s67 offen offset:1024 sc1
L_h3g1as9:
  v_max_u32 v168, v48, v50
  v_cmp_eq_u32 vcc, -1, v168
  s_cbranch_vccz L_h3g1as10
  buffer_load_dwordx4 v[48:51], v167, s[16:19], s68 offen offset:1024 sc1
L_h3g1as10:
  v_max_u32 v168, v12, v14
  v_cmp_eq_u32 vcc, -1, v168
  s_cbranch_vccz L_h3g1as11
  buffer_load_dwordx4 v[12:15], v167, s[16:19], s70 offen offset:1024 sc1
L_h3g1as11:
  v_max_u32 v168, v16, v18
  v_cmp_eq_u32 vcc, -1, v168
  s_cbranch_vccz L_h3g1as12
  buffer_load_dwordx4 v[16:19], v167, s[16:19], s71 offen offset:1024 sc1
L_h3g1as12:
  v_max_u32 v168, v32, v34
  v_cmp_eq_u32 vcc, -1, v168
  s_cbranch_vccz L_h3g1as13
  buffer_load_dwordx4 v[32:35], v167, s[16:19], s72 offen offset:1024 sc1
L_h3g1as13:
  v_max_u32 v168, v36, v38
  v_cmp_eq_u32 vcc, -1, v168
  s_cbranch_vccz L_h3g1as14
  buffer_load_dwordx4 v[36:39], v167, s[16:19], s73 offen offset:1024 sc1
L_h3g1as14:
  s_waitcnt vmcnt(0)
  v_max_u32 v168, v136, v138
  v_max3_u32 v168, v20, v22, v168
  v_max3_u32 v168, v40, v42, v168
  v_max3_u32 v168, v60, v62, v168
  v_cmp_eq_u32 vcc, -1, v168
  s_cbranch_vccnz L_h3g1a
  s_branch L_h3g1aok

L_h3g2a:
  s_sub_u32 s81, s81, 1
  s_cselect_b32 s81, 0, s81
  s_cbranch_scc1 L_h3g2aok
  v_subrev_u32 v167, 0, v162
  s_waitcnt vmcnt(0)
  v_max_u32 v168, v132, v134
  v_cmp_eq_u32 vcc, -1, v168
  s_cbranch_vccz L_h3g2as8
  buffer_load_dwordx4 v[132:135], v167, s[16:19], s66 offen offset:1024 sc1
L_h3g2as8:
  v_max_u32 v168, v44, v46
  v_cmp_eq_u32 vcc, -1, v168
  s_cbranch_vccz L_h3g2as9
  buffer_load_dwordx4 v[44:47], v167, s[16:19], s67 offen offset:1024 sc1
L_h3g2as9:
  v_max_u32 v168, v48, v50
  v_cmp_eq_u32 vcc, -1, v168
  s_cbranch_vccz L_h3g2as10
  buffer_load_dwordx4 v[48:51], v167, s[16:19], s68 offen offset:1024 sc1
L_h3g2as10:
  v_max_u32 v168, v12, v14
  v_cmp_eq_u32 vcc, -1, v168
  s_cbranch_vccz L_h3g2as11
  buffer_load_dwordx4 v[12:15], v167, s[16:19], s70 offen offset:1024 sc1
L_h3g2as11:
  v_max_u32 v168, v16, v18
  v_cmp_eq_u32 vcc, -1, v168
  s_cbranch_vccz L_h3g2as12
  buffer_load_dwordx4 v[16:19], v167, s[16:19], s71 offen offset:1024 sc1
L_h3g2as12:
  v_max_u32 v168, v32, v34
  v_cmp_eq_u32 vcc, -1, v168
  s_cbranch_vccz L_h3g2as13
  buffer_load_dwordx4 v[32:35], v167, s[16:19], s72 offen offset:1024 sc1
L_h3g2as13:
  v_max_u32 v168, v36, v38
  v_cmp_eq_u32 vcc, -1, v168
  s_cbranch_vccz L_h3g2as14
  buffer_load_dwordx4 v[36:39], v167, s[16:19], s73 offen offset:1024 sc1
L_h3g2as14:
  s_waitcnt vmcnt(0)
  v_max_u32 v168, v132, v134
  v_max3_u32 v168, v44, v46, v168
  v_max3_u32 v168, v48, v50, v168
  v_max3_u32 v168, v12, v14, v168
  v_cmp_eq_u32 vcc, -1, v168
  s_cbranch_vccnz L_h3g2a
  s_branch L_h3g2aok

L_h3g3a:
  s_sub_u32 s81, s81, 1
  s_cselect_b32 s81, 0, s81
  s_cbranch_scc1 L_h3g3aok
  v_subrev_u32 v167, 0, v162
  s_waitcnt vmcnt(0)
  v_max_u32 v168, v16, v18
  v_cmp_eq_u32 vcc, -1, v168
  s_cbranch_vccz L_h3g3as12
  buffer_load_dwordx4 v[16:19], v167, s[16:19], s71 offen offset:1024 sc1
L_h3g3as12:
  v_max_u32 v168, v32, v34
  v_cmp_eq_u32 vcc, -1, v168
  s_cbranch_vccz L_h3g3as13
  buffer_load_dwordx4 v[32:35], v167, s[16:19], s72 offen offset:1024 sc1
L_h3g3as13:
  v_max_u32 v168, v36, v38
  v_cmp_eq_u32 vcc, -1, v168
  s_cbranch_vccz L_h3g3as14
  buffer_load_dwordx4 v[36:39], v167, s[16:19], s73 offen offset:1024 sc1
L_h3g3as14:
  s_waitcnt vmcnt(0)
  v_max_u32 v168, v16, v18
  v_max3_u32 v168, v32, v34, v168
  v_max3_u32 v168, v36, v38, v168
  v_cmp_eq_u32 vcc, -1, v168
  s_cbranch_vccnz L_h3g3a
  s_branch L_h3g3aok

L_sta:
  s_sub_u32 s81, s81, 1
  s_cselect_b32 s81, 0, s81
  s_cbranch_scc1 L_staok
  buffer_load_dword v168, v166, s[16:19], s22 offen sc1
  s_waitcnt vmcnt(0)
  s_add_u32 s4, s24, 1
  v_subrev_u32 v1, s4, v168
  v_cmp_lt_u32 vcc, 4, v1
  s_nop 0
  s_and_b32 s4, vcc_lo, 0xffff
  s_cbranch_scc1 L_sta
  s_branch L_staok

L_c2a:
  s_sub_u32 s81, s81, 1
  s_cselect_b32 s81, 0, s81
  s_cbranch_scc1 L_c2aok
  buffer_load_dword v168, v166, s[16:19], s21 offen sc1
  s_waitcnt vmcnt(0)
  s_add_u32 s4, s25, 2
  v_subrev_u32 v1, s4, v168
  v_cmp_lt_u32 vcc, 3, v1
  s_nop 0
  s_and_b32 s4, vcc_lo, s77
  s_cbranch_scc1 L_c2a
  s_branch L_c2aok

L_c3a:
  s_sub_u32 s81, s81, 1
  s_cselect_b32 s81, 0, s81
  s_cbranch_scc1 L_c3aok
  buffer_load_dword v168, v166, s[16:19], s21 offen sc1
  s_waitcnt vmcnt(0)
  s_add_u32 s4, s25, 3
  v_subrev_u32 v1, s4, v168
  v_cmp_lt_u32 vcc, 2, v1
  s_nop 0
  s_and_b32 s4, vcc_lo, s77
  s_cbranch_scc1 L_c3a
  s_branch L_c3aok
L_ffn:
  s_add_u32 s3, s58, 8
  s_add_u32 m0, s67, 32768
  s_add_u32 s63, s63, 176128
  s_sub_u32 s65, s63, 1409024
  s_min_u32 s63, s63, s65
  buffer_load_dwordx4 v132, s[32:35], s63 offen offset:0 lds
  s_and_b32 s74, s2, 1
  s_lshl_b32 s74, s74, 7
  s_bfe_u32 s75, s2, 0x20001
  s_lshl_b32 s75, s75, 5
  s_add_u32 s74, s74, s75
  s_add_u32 s74, s74, s70
  s_cmp_eq_u32 s26, 3
  s_cselect_b32 s82, s16, s8
  s_cselect_b32 s83, s17, s9
  s_cselect_b32 s75, 43, 16
  s_mul_i32 s72, s74, s75
  s_sub_u32 s75, s75, 1
  v_min_u32 v12, s75, v2
  v_add_lshl_u32 v221, v12, s72, 7
  s_bfe_u32 s4, s2, 0x20001
  s_lshl_b32 s4, s4, 2
  s_and_b32 s5, s2, 1
  s_xor_b32 s5, s5, 1
  s_lshl_b32 s5, s5, 4
  s_add_u32 s4, s4, s5
  s_and_b32 s5, s70, 3
  s_add_u32 s6, s4, s5
  s_lshr_b32 s7, s70, 2
  s_xor_b32 s7, s7, 2
  s_lshl_b32 s72, s7, 7
  s_mul_i32 s12, s26, 491520
  s_add_u32 s12, s12, s72
  s_sub_u32 s13, s12, 524288
  s_cmp_lt_u32 s26, 2
  s_cselect_b32 s44, s8, s16
  s_cselect_b32 s45, s9, s17
  s_cselect_b32 s75, s12, s13
  s_mov_b32 s76, 1409024
  s_cmov_b32 s76, 524288
  buffer_load_dwordx4 v133, s[32:35], s63 offen offset:1024 lds
  s_add_u32 s44, s44, s75
  s_addc_u32 s45, s45, 0
  s_sub_u32 s46, s76, s75
  s_mov_b32 s47, 0x20000
  s_add_u32 s12, s12, 32768
  s_add_u32 s13, s13, 32768
  s_cmp_lt_u32 s26, 1
  s_cselect_b32 s48, s8, s16
  s_cselect_b32 s49, s9, s17
  s_cselect_b32 s75, s12, s13
  s_mov_b32 s76, 1409024
  s_cmov_b32 s76, 524288
  s_add_u32 s48, s48, s75
  s_addc_u32 s49, s49, 0
  s_sub_u32 s50, s76, s75
  s_mov_b32 s51, 0x20000
  s_mov_b32 s40, s14
  s_mov_b32 s41, s15
  s_mov_b32 s42, 2752
  s_mov_b32 s43, 0x20000
  s_mov_b32 s12, s18
  s_mov_b32 s13, s19
  s_mov_b32 s14, 1024
  s_mov_b32 s15, 0x20000
  s_mov_b32 s16, s24
  s_mov_b32 s17, s25
  s_mov_b32 s18, 7882752
  s_mov_b32 s19, 0x20000
  s_mov_b32 s84, s22
  s_mov_b32 s85, s23
  s_mov_b32 s86, 256
  s_mov_b32 s87, 0x20000
  v_and_b32 v165, 15, v2
  s_add_u32 m0, s66, 32768
  s_add_u32 s60, s60, 128
  s_bitset0_b32 s60, 10
  buffer_load_dwordx4 v128, s[28:31], s60 offen offset:0 lds
  v_lshlrev_b32 v166, 2, v165
  s_lshl_b32 s74, s27, 7
  s_add_u32 s22, s74, 7864320
  s_lshl_b32 s75, s26, 5
  s_add_u32 s9, s72, s75
  s_lshr_b32 s74, s6, 2
  s_lshl_b32 s74, s74, 18
  s_bfe_u32 s75, s6, 0x10001
  s_lshl_b32 s75, s75, 10
  s_add_u32 s74, s74, s75
  s_and_b32 s75, s6, 1
  s_lshl_b32 s75, s75, 15
  s_add_u32 s74, s74, s75
  s_add_u32 s8, s74, s9
  s_add_u32 s52, s20, s8
  s_addc_u32 s53, s21, 0
  s_sub_u32 s54, 0x200000, s8
  s_mov_b32 s55, 0x20000
  s_lshl_b32 s74, s3, 2
  s_add_u32 s75, s74, s26
  s_lshl_b32 s76, s75, 11
  s_add_u32 s76, s76, s59
  s_add_u32 s69, s76, 131072
  v_lshlrev_b32 v20, 4, v2
  s_add_u32 s20, s22, s74
  s_lshl_b32 s57, s27, 10
  s_add_u32 s57, s57, 7866368
  buffer_load_dwordx4 v129, s[28:31], s60 offen offset:1024 lds
  s_lshl_b32 s75, s75, 2
  s_add_u32 s56, s57, s75
  s_lshr_b32 s75, s6, 1
  s_lshl_b32 s21, s75, 7
  s_add_u32 s21, s21, 7864320
  s_lshl_b32 s10, s26, 12
  s_lshl_b32 s62, s26, 10
  s_mov_b32 s81, 30000
  s_and_b32 s74, s6, 3
  s_lshl_b32 s74, s74, 1
  s_add_u32 s74, s74, s7
  s_lshl_b32 s74, s74, 2
  s_and_b32 s75, s2, 7
  s_add_u32 s74, s74, s75
  s_and_b32 s74, s74, 31
  s_mul_i32 s74, s74, 7
  s_lshr_b32 s23, s74, 4
  s_lshl_b32 s23, s23, 15
  v_and_b32 v12, 1, v1
  v_lshlrev_b32 v12, 6, v12
  v_xor_b32 v12, v12, v6
  v_lshl_add_u32 v12, v1, 14, v12
  v_add_u32 v130, 131072, v12
  v_lshl_add_u32 v158, v3, 10, v10
  v_xor_b32 v12, 64, v158
  v_add_u32 v159, 7168, v12
  s_add_u32 m0, s67, 40960
  s_nop 0
  buffer_load_dwordx4 v80, s[32:35], s63 offen offset:0 lds
  v_add_u32 v160, 14336, v158
  v_add_u32 v161, 21504, v12
  s_mul_i32 s75, s27, 491520
  s_mul_i32 s76, s58, 6144
  s_add_u32 s74, s75, s76
  s_add_u32 s74, s74, 16384
  s_add_u32 s36, s24, s74
  s_addc_u32 s37, s25, 0
  s_mov_b32 s38, 491520
  s_mov_b32 s39, 0x20000
  v_mov_b32 v76, 0x3f803f80
  v_mov_b32 v77, 0x3f803f80
  v_mov_b32 v78, 0x3f803f80
  v_mov_b32 v79, 0x3f803f80
  v_lshlrev_b32 v8, 2, v0
  v_add_u32 v8, 131072, v8
  v_mov_b32 v9, 0
  ds_write_b32 v8, v9 offset:9728
  v_bfe_u32 v12, v2, 1, 3
  v_xor_b32 v12, v12, v164
  v_lshlrev_b32 v12, 4, v12
  v_lshl_add_u32 v134, v165, 7, v12
  v_xor_b32 v135, 64, v134
  v_add_u32 v136, 0x10000, v134
  v_add_u32 v137, 0x10000, v135
  v_lshl_add_u32 v140, v1, 11, v134
  v_lshl_add_u32 v141, v1, 11, v135
  buffer_load_dwordx4 v81, s[32:35], s63 offen offset:1024 lds
  v_lshl_add_u32 v142, v1, 11, v136
  v_lshl_add_u32 v143, v1, 11, v137
  v_bfe_u32 v15, v2, 2, 2
  v_lshl_add_u32 v12, v164, 3, v15
  v_bfe_u32 v13, v2, 1, 1
  v_lshl_add_u32 v13, v1, 1, v13
  v_and_b32 v14, 2, v15
  v_xor_b32 v13, v13, v14
  v_and_b32 v14, 1, v164
  v_lshlrev_b32 v14, 2, v14
  v_xor_b32 v13, v13, v14
  v_and_b32 v14, 1, v2
  v_lshl_add_u32 v13, v13, 1, v14
  v_lshlrev_b32 v13, 3, v13
  v_lshl_add_u32 v13, v12, 7, v13
  v_add_u32 v144, 0, v13
  v_add_u32 v145, 65536, v13
  v_and_b32 v16, 1, v164
  v_mul_u32_u24 v16, 61440, v16
  v_and_b32 v12, 1, v1
  v_lshlrev_b32 v12, 1, v12
  v_lshrrev_b32 v13, 1, v164
  v_add_u32 v12, v12, v13
  v_lshl_add_u32 v16, v12, 8, v16
  v_lshl_add_u32 v16, v165, 4, v16
  v_lshrrev_b32 v12, 1, v1
  s_add_u32 m0, s67, 49152
  s_nop 0
  buffer_load_dwordx4 v82, s[32:35], s63 offen offset:0 lds
  v_lshl_add_u32 v163, v12, 10, v16
  v_lshlrev_b32 v169, 24, v2
  v_mov_b32 v170, 140800
  s_lshr_b32 s75, s6, 1
  s_lshl_b32 s75, s75, 3
  s_and_b32 s76, s6, 1
  s_add_u32 s75, s75, s76
  s_mul_i32 s75, s75, 61440
  s_mul_i32 s76, s26, 15360
  s_add_u32 s75, s75, s76
  v_lshlrev_b32 v12, 4, v2
  v_add_u32 v162, s75, v12
  v_bfe_u32 v150, v2, 2, 2
  v_lshl_add_u32 v151, v164, 3, v150
  v_bfe_u32 v152, v2, 1, 1
  v_and_b32 v150, 2, v150
  v_xor_b32 v152, v152, v150
  v_and_b32 v150, 1, v164
  v_lshlrev_b32 v150, 2, v150
  v_xor_b32 v152, v152, v150
  v_and_b32 v150, 1, v2
  v_lshl_add_u32 v152, v152, 1, v150
  v_lshlrev_b32 v152, 3, v152
  v_lshl_add_u32 v152, v151, 7, v152
  v_add_u32 v152, s10, v152
  s_add_u32 s4, s26, 0
  s_and_b32 s4, s4, 3
  s_lshl_b32 s4, s4, 5
  buffer_load_dwordx4 v83, s[32:35], s63 offen offset:1024 lds
  v_xor_b32 v146, s4, v152
  s_add_u32 s4, s26, 1
  s_and_b32 s4, s4, 3
  s_lshl_b32 s4, s4, 5
  v_xor_b32 v147, s4, v152
  s_add_u32 s4, s26, 2
  s_and_b32 s4, s4, 3
  s_lshl_b32 s4, s4, 5
  v_xor_b32 v148, s4, v152
  s_add_u32 s4, s26, 3
  s_and_b32 s4, s4, 3
  s_lshl_b32 s4, s4, 5
  v_xor_b32 v149, s4, v152
  v_add_u32 v150, 65536, v146
  v_add_u32 v151, 65536, v147
  v_add_u32 v152, 65536, v148
  v_add_u32 v153, 65536, v149
  v_add_u32 v154, 131072, v146
  v_add_u32 v155, 131072, v147
  v_add_u32 v156, 131072, v148
  v_add_u32 v157, 131072, v149
  v_lshlrev_b32 v21, 5, v1
  v_lshl_add_u32 v21, v164, 3, v21
  s_mul_i32 s76, s58, 384
  v_add_u32 v21, s76, v21
  s_mul_i32 s74, s58, 12
  s_add_u32 s74, s74, s26
  s_mov_b32 s78, 1073741824
  s_cmp_lt_u32 s74, 88
  s_cmov_b32 s78, 0
  s_mov_b32 s79, 1073741824
  s_cmp_lt_u32 s74, 84
  s_cmov_b32 s79, 2048
  s_mov_b32 s80, 1073741824
  s_cmp_lt_u32 s74, 80
  s_cmov_b32 s80, 4096
  v_mov_b32 v236, 0xbdd2d3e8
  v_mov_b32 v237, 0xc0135761
  v_and_b32 v11, 3, v2
  v_bfe_u32 v15, v2, 2, 2
  v_cmp_eq_u32 s[70:71], 1, v11
  v_cmp_eq_u32 s[72:73], 2, v11
  v_cmp_eq_u32 s[74:75], 3, v11
  v_cmp_eq_u32 s[76:77], v15, v164
  v_lshl_add_u32 v12, v1, 4, v165
  v_lshlrev_b32 v13, 3, v12
  v_add_u32 v13, 139264, v13
  v_lshlrev_b32 v14, 2, v12
  v_add_u32 v14, 139904, v14
  v_lshlrev_b32 v175, 3, v165
  v_add_u32 v15, 139776, v175
  v_add_u32 v16, 140160, v166
  v_mov_b32 v17, 140544
  v_cndmask_b32 v171, v17, v13, s[76:77]
  v_cndmask_b32 v172, v17, v14, s[76:77]
  v_cndmask_b32 v173, v17, v15, s[76:77]
  v_cndmask_b32 v174, v17, v16, s[76:77]
  v_add_u32 v175, 139264, v175
  buffer_load_dword v222, v166, s[16:19], s22 offen sc1
  buffer_load_dwordx4 v[210:213], v20, s[28:31], s69 offen
  buffer_load_dword v167, v166, s[84:87], 0 offen offset:0 sc1
  buffer_load_dwordx2 v[238:239], v21, s[40:43], 0 offen offset:0
  buffer_load_dwordx2 v[240:241], v21, s[40:43], 0 offen offset:128
  buffer_load_dwordx2 v[242:243], v21, s[40:43], 0 offen offset:256
  s_waitcnt vmcnt(14) lgkmcnt(0)
  s_barrier
  ds_read_b128 a[212:215], v140 offset:24576
  ds_read_b64_tr_b16 a[0:1], v144 offset:0
  ds_read_b64_tr_b16 a[2:3], v144 offset:512
  ds_read_b128 a[192:195], v134 offset:24576
  ds_read_b64_tr_b16 a[4:5], v144 offset:8192
  ds_read_b64_tr_b16 a[6:7], v144 offset:8704
  ds_read_b64_tr_b16 a[8:9], v144 offset:16384
  ds_read_b64_tr_b16 a[10:11], v144 offset:16896
  ds_read_b128 a[196:199], v134 offset:26624
  ds_read_b128 a[200:203], v134 offset:28672
  ds_read_b128 a[204:207], v134 offset:30720
  s_waitcnt lgkmcnt(7)
  v_mfma_f32_16x16x32_bf16 v[4:7], a[0:3], a[192:195], 0
  s_add_u32 m0, s67, 65536
  ds_read_b128 a[236:239], v141 offset:24576
  s_waitcnt lgkmcnt(6)
  v_mfma_f32_16x16x32_bf16 v[24:27], a[4:7], a[192:195], 0
  s_add_u32 s63, s63, 176128
  s_sub_u32 s65, s63, 1409024
  s_min_u32 s63, s63, s65
  s_waitcnt lgkmcnt(4)
  v_mfma_f32_16x16x32_bf16 v[44:47], a[8:11], a[192:195], 0
  buffer_load_dwordx4 v132, s[32:35], s63 offen offset:0 lds
  s_waitcnt lgkmcnt(3)
  v_mfma_f32_16x16x32_bf16 v[8:11], a[0:3], a[196:199], 0
  ds_read_b64_tr_b16 a[12:13], v144 offset:4096
  v_mfma_f32_16x16x32_bf16 v[28:31], a[4:7], a[196:199], 0
  ds_read_b64_tr_b16 a[14:15], v144 offset:4608
  v_mfma_f32_16x16x32_bf16 v[48:51], a[8:11], a[196:199], 0
  buffer_load_dwordx4 v133, s[32:35], s63 offen offset:1024 lds
  s_waitcnt lgkmcnt(4)
  v_mfma_f32_16x16x32_bf16 v[12:15], a[0:3], a[200:203], 0
  s_add_u32 m0, s66, 65536
  ds_read_b128 a[216:219], v135 offset:24576
  v_mfma_f32_16x16x32_bf16 v[32:35], a[4:7], a[200:203], 0
  s_add_u32 s60, s60, 128
  s_bitset0_b32 s60, 10
  v_mfma_f32_16x16x32_bf16 v[52:55], a[8:11], a[200:203], 0
  ds_read_b64_tr_b16 a[16:17], v144 offset:12288
  s_waitcnt lgkmcnt(5)
  v_mfma_f32_16x16x32_bf16 v[16:19], a[0:3], a[204:207], 0
  buffer_load_dwordx4 v128, s[28:31], s60 offen offset:0 lds
  v_mfma_f32_16x16x32_bf16 v[36:39], a[4:7], a[204:207], 0
  ds_read_b64_tr_b16 a[18:19], v144 offset:12800
  v_mfma_f32_16x16x32_bf16 v[56:59], a[8:11], a[204:207], 0
  ds_read_b64_tr_b16 a[20:21], v144 offset:20480
  v_mfma_f32_16x16x32_bf16 v[20:23], a[0:3], v[76:79], 0
  buffer_load_dwordx4 v129, s[28:31], s60 offen offset:1024 lds
  v_mfma_f32_16x16x32_bf16 v[40:43], a[4:7], v[76:79], 0
  s_add_u32 m0, s67, 73728
  ds_read_b64_tr_b16 a[22:23], v144 offset:20992
  v_mfma_f32_16x16x32_bf16 v[60:63], a[8:11], v[76:79], 0
  ds_read_b128 a[220:223], v135 offset:26624
  v_mfma_f32_16x16x32_bf16 v[64:67], v[76:79], a[212:215], 0
  buffer_load_dwordx4 v80, s[32:35], s63 offen offset:0 lds
  v_mfma_f32_16x16x32_bf16 v[68:71], a[212:215], a[212:215], 0
  ds_read_b128 a[224:227], v135 offset:28672
  s_waitcnt lgkmcnt(9)
  v_mfma_f32_16x16x32_bf16 v[64:67], v[76:79], a[236:239], v[64:67]
  s_waitcnt lgkmcnt(1)
  ds_read_b128 a[228:231], v135 offset:30720
  v_mfma_f32_16x16x32_bf16 v[68:71], a[236:239], a[236:239], v[68:71]
  buffer_load_dwordx4 v81, s[32:35], s63 offen offset:1024 lds
  v_mfma_f32_16x16x32_bf16 v[4:7], a[12:15], a[216:219], v[4:7]
  s_add_u32 m0, s67, 81920
  v_mfma_f32_16x16x32_bf16 v[24:27], a[16:19], a[216:219], v[24:27]
  s_waitcnt vmcnt(12) lgkmcnt(0)
  s_barrier
  v_mfma_f32_16x16x32_bf16 v[44:47], a[20:23], a[216:219], v[44:47]
  buffer_load_dwordx4 v82, s[32:35], s63 offen offset:0 lds
  v_mfma_f32_16x16x32_bf16 v[8:11], a[12:15], a[220:223], v[8:11]
  ds_read_b128 a[212:215], v140 offset:57344
  v_mfma_f32_16x16x32_bf16 v[28:31], a[16:19], a[220:223], v[28:31]
  ds_read_b64_tr_b16 a[24:25], v144 offset:32768
  v_mfma_f32_16x16x32_bf16 v[48:51], a[20:23], a[220:223], v[48:51]
  buffer_load_dwordx4 v83, s[32:35], s63 offen offset:1024 lds
  v_mfma_f32_16x16x32_bf16 v[12:15], a[12:15], a[224:227], v[12:15]
  s_add_u32 m0, s67, 98304
  ds_read_b64_tr_b16 a[26:27], v144 offset:33280
  s_add_u32 s63, s63, 176128
  s_sub_u32 s65, s63, 1409024
  s_min_u32 s63, s63, s65
  v_mfma_f32_16x16x32_bf16 v[32:35], a[16:19], a[224:227], v[32:35]
  ds_read_b128 a[192:195], v134 offset:57344
  v_mfma_f32_16x16x32_bf16 v[52:55], a[20:23], a[224:227], v[52:55]
  ds_read_b64_tr_b16 a[28:29], v144 offset:40960
  buffer_load_dwordx4 v132, s[32:35], s63 offen offset:0 lds
  v_mfma_f32_16x16x32_bf16 v[16:19], a[12:15], a[228:231], v[16:19]
  ds_read_b64_tr_b16 a[30:31], v144 offset:41472
  v_mfma_f32_16x16x32_bf16 v[36:39], a[16:19], a[228:231], v[36:39]
  ds_read_b64_tr_b16 a[32:33], v144 offset:49152
  v_mfma_f32_16x16x32_bf16 v[56:59], a[20:23], a[228:231], v[56:59]
  buffer_load_dwordx4 v133, s[32:35], s63 offen offset:1024 lds
  v_mfma_f32_16x16x32_bf16 v[20:23], a[12:15], v[76:79], v[20:23]
  s_add_u32 m0, s66, 98304
  ds_read_b64_tr_b16 a[34:35], v144 offset:49664
  s_add_u32 s60, s60, 128
  s_bitset0_b32 s60, 10
  v_mfma_f32_16x16x32_bf16 v[40:43], a[16:19], v[76:79], v[40:43]
  ds_read_b128 a[196:199], v134 offset:59392
  v_mfma_f32_16x16x32_bf16 v[60:63], a[20:23], v[76:79], v[60:63]
  ds_read_b128 a[200:203], v134 offset:61440
  buffer_load_dwordx4 v128, s[28:31], s60 offen offset:0 lds
  s_waitcnt lgkmcnt(9)
  v_mfma_f32_16x16x32_bf16 v[64:67], v[76:79], a[212:215], v[64:67]
  s_waitcnt lgkmcnt(1)
  ds_read_b128 a[204:207], v134 offset:63488
  v_mfma_f32_16x16x32_bf16 v[68:71], a[212:215], a[212:215], v[68:71]
  buffer_load_dwordx4 v129, s[28:31], s60 offen offset:1024 lds
  v_mfma_f32_16x16x32_bf16 v[4:7], a[24:27], a[192:195], v[4:7]
  s_add_u32 m0, s67, 106496
  ds_read_b128 a[236:239], v141 offset:57344
  v_mfma_f32_16x16x32_bf16 v[24:27], a[28:31], a[192:195], v[24:27]
  buffer_load_dwordx4 v80, s[32:35], s63 offen offset:0 lds
  v_mfma_f32_16x16x32_bf16 v[44:47], a[32:35], a[192:195], v[44:47]
  ds_read_b64_tr_b16 a[36:37], v144 offset:36864
  v_mfma_f32_16x16x32_bf16 v[8:11], a[24:27], a[196:199], v[8:11]
  s_waitcnt lgkmcnt(2)
  ds_read_b64_tr_b16 a[38:39], v144 offset:37376
  v_mfma_f32_16x16x32_bf16 v[28:31], a[28:31], a[196:199], v[28:31]
  ds_read_b128 a[216:219], v135 offset:57344
  v_mfma_f32_16x16x32_bf16 v[48:51], a[32:35], a[196:199], v[48:51]
  buffer_load_dwordx4 v81, s[32:35], s63 offen offset:1024 lds
  v_mfma_f32_16x16x32_bf16 v[12:15], a[24:27], a[200:203], v[12:15]
  s_add_u32 m0, s67, 114688
  ds_read_b64_tr_b16 a[40:41], v144 offset:45056
  v_mfma_f32_16x16x32_bf16 v[32:35], a[28:31], a[200:203], v[32:35]
  ds_read_b64_tr_b16 a[42:43], v144 offset:45568
  v_mfma_f32_16x16x32_bf16 v[52:55], a[32:35], a[200:203], v[52:55]
  buffer_load_dwordx4 v82, s[32:35], s63 offen offset:0 lds
  v_mfma_f32_16x16x32_bf16 v[16:19], a[24:27], a[204:207], v[16:19]
  ds_read_b64_tr_b16 a[44:45], v144 offset:53248
  v_mfma_f32_16x16x32_bf16 v[36:39], a[28:31], a[204:207], v[36:39]
  ds_read_b64_tr_b16 a[46:47], v144 offset:53760
  v_mfma_f32_16x16x32_bf16 v[56:59], a[32:35], a[204:207], v[56:59]
  buffer_load_dwordx4 v83, s[32:35], s63 offen offset:1024 lds
  v_mfma_f32_16x16x32_bf16 v[20:23], a[24:27], v[76:79], v[20:23]
  s_add_u32 m0, s67, 0
  ds_read_b128 a[220:223], v135 offset:59392
  v_mfma_f32_16x16x32_bf16 v[40:43], a[28:31], v[76:79], v[40:43]
  s_add_u32 s63, s63, 176128
  s_sub_u32 s65, s63, 1409024
  s_min_u32 s63, s63, s65
  v_mfma_f32_16x16x32_bf16 v[60:63], a[32:35], v[76:79], v[60:63]
  ds_read_b128 a[224:227], v135 offset:61440
  s_waitcnt lgkmcnt(9)
  v_mfma_f32_16x16x32_bf16 v[64:67], v[76:79], a[236:239], v[64:67]
  s_waitcnt lgkmcnt(1)
  ds_read_b128 a[228:231], v135 offset:63488
  buffer_load_dwordx4 v132, s[32:35], s63 offen offset:0 lds
  v_mfma_f32_16x16x32_bf16 v[68:71], a[236:239], a[236:239], v[68:71]
  buffer_load_dwordx4 v133, s[32:35], s63 offen offset:1024 lds
  v_mfma_f32_16x16x32_bf16 v[4:7], a[36:39], a[216:219], v[4:7]
  s_add_u32 m0, s66, 0
  s_add_u32 s60, s60, 128
  s_bitset0_b32 s60, 10
  v_mfma_f32_16x16x32_bf16 v[24:27], a[40:43], a[216:219], v[24:27]
  s_waitcnt vmcnt(10) lgkmcnt(0)
  s_barrier
  v_mfma_f32_16x16x32_bf16 v[44:47], a[44:47], a[216:219], v[44:47]
  ds_read_b128 a[212:215], v142 offset:24576
  v_mfma_f32_16x16x32_bf16 v[8:11], a[36:39], a[220:223], v[8:11]
  buffer_load_dwordx4 v128, s[28:31], s60 offen offset:0 lds
  v_mfma_f32_16x16x32_bf16 v[28:31], a[40:43], a[220:223], v[28:31]
  ds_read_b64_tr_b16 a[48:49], v145 offset:0
  v_mfma_f32_16x16x32_bf16 v[48:51], a[44:47], a[220:223], v[48:51]
  ds_read_b64_tr_b16 a[50:51], v145 offset:512
  v_mfma_f32_16x16x32_bf16 v[12:15], a[36:39], a[224:227], v[12:15]
  ds_read_b128 a[192:195], v136 offset:24576
  v_mfma_f32_16x16x32_bf16 v[32:35], a[40:43], a[224:227], v[32:35]
  buffer_load_dwordx4 v129, s[28:31], s60 offen offset:1024 lds
  v_mfma_f32_16x16x32_bf16 v[52:55], a[44:47], a[224:227], v[52:55]
  s_add_u32 m0, s67, 8192
  ds_read_b64_tr_b16 a[52:53], v145 offset:8192
  v_mfma_f32_16x16x32_bf16 v[16:19], a[36:39], a[228:231], v[16:19]
  ds_read_b64_tr_b16 a[54:55], v145 offset:8704
  v_mfma_f32_16x16x32_bf16 v[36:39], a[40:43], a[228:231], v[36:39]
  buffer_load_dwordx4 v80, s[32:35], s63 offen offset:0 lds
  v_mfma_f32_16x16x32_bf16 v[56:59], a[44:47], a[228:231], v[56:59]
  ds_read_b64_tr_b16 a[56:57], v145 offset:16384
  v_mfma_f32_16x16x32_bf16 v[20:23], a[36:39], v[76:79], v[20:23]
  ds_read_b64_tr_b16 a[58:59], v145 offset:16896
  v_mfma_f32_16x16x32_bf16 v[40:43], a[40:43], v[76:79], v[40:43]
  ds_read_b128 a[196:199], v136 offset:26624
  buffer_load_dwordx4 v81, s[32:35], s63 offen offset:1024 lds
  v_mfma_f32_16x16x32_bf16 v[60:63], a[44:47], v[76:79], v[60:63]
  s_add_u32 m0, s67, 16384
  ds_read_b128 a[200:203], v136 offset:28672
  s_waitcnt lgkmcnt(9)
  v_mfma_f32_16x16x32_bf16 v[64:67], v[76:79], a[212:215], v[64:67]
  s_waitcnt lgkmcnt(1)
  ds_read_b128 a[204:207], v136 offset:30720
  v_mfma_f32_16x16x32_bf16 v[68:71], a[212:215], a[212:215], v[68:71]
  buffer_load_dwordx4 v82, s[32:35], s63 offen offset:0 lds
  v_mfma_f32_16x16x32_bf16 v[4:7], a[48:51], a[192:195], v[4:7]
  ds_read_b128 a[236:239], v143 offset:24576
  v_mfma_f32_16x16x32_bf16 v[24:27], a[52:55], a[192:195], v[24:27]
  buffer_load_dwordx4 v83, s[32:35], s63 offen offset:1024 lds
  v_mfma_f32_16x16x32_bf16 v[44:47], a[56:59], a[192:195], v[44:47]
  s_add_u32 m0, s67, 32768
  s_add_u32 s63, s63, 176128
  s_sub_u32 s65, s63, 1409024
  v_mfma_f32_16x16x32_bf16 v[8:11], a[48:51], a[196:199], v[8:11]
  s_waitcnt lgkmcnt(1)
  s_min_u32 s63, s63, s65
  v_mfma_f32_16x16x32_bf16 v[28:31], a[52:55], a[196:199], v[28:31]
  ds_read_b64_tr_b16 a[60:61], v145 offset:4096
  v_mfma_f32_16x16x32_bf16 v[48:51], a[56:59], a[196:199], v[48:51]
  ds_read_b64_tr_b16 a[62:63], v145 offset:4608
  buffer_load_dwordx4 v132, s[32:35], s63 offen offset:0 lds
  v_mfma_f32_16x16x32_bf16 v[12:15], a[48:51], a[200:203], v[12:15]
  ds_read_b128 a[216:219], v137 offset:24576
  v_mfma_f32_16x16x32_bf16 v[32:35], a[52:55], a[200:203], v[32:35]
  ds_read_b64_tr_b16 a[64:65], v145 offset:12288
  v_mfma_f32_16x16x32_bf16 v[52:55], a[56:59], a[200:203], v[52:55]
  buffer_load_dwordx4 v133, s[32:35], s63 offen offset:1024 lds
  v_mfma_f32_16x16x32_bf16 v[16:19], a[48:51], a[204:207], v[16:19]
  s_add_u32 m0, s66, 32768
  ds_read_b64_tr_b16 a[66:67], v145 offset:12800
  s_add_u32 s60, s60, 128
  s_bitset0_b32 s60, 10
  v_mfma_f32_16x16x32_bf16 v[36:39], a[52:55], a[204:207], v[36:39]
  ds_read_b64_tr_b16 a[68:69], v145 offset:20480
  v_mfma_f32_16x16x32_bf16 v[56:59], a[56:59], a[204:207], v[56:59]
  ds_read_b64_tr_b16 a[70:71], v145 offset:20992
  buffer_load_dwordx4 v128, s[28:31], s60 offen offset:0 lds
  v_mfma_f32_16x16x32_bf16 v[20:23], a[48:51], v[76:79], v[20:23]
  ds_read_b128 a[220:223], v137 offset:26624
  v_mfma_f32_16x16x32_bf16 v[40:43], a[52:55], v[76:79], v[40:43]
  ds_read_b128 a[224:227], v137 offset:28672
  v_mfma_f32_16x16x32_bf16 v[60:63], a[56:59], v[76:79], v[60:63]
  buffer_load_dwordx4 v129, s[28:31], s60 offen offset:1024 lds
  s_waitcnt lgkmcnt(9)
  v_mfma_f32_16x16x32_bf16 v[64:67], v[76:79], a[236:239], v[64:67]
  s_waitcnt lgkmcnt(1)
  ds_read_b128 a[228:231], v137 offset:30720
  s_add_u32 m0, s67, 40960
  v_mfma_f32_16x16x32_bf16 v[68:71], a[236:239], a[236:239], v[68:71]
  buffer_load_dwordx4 v80, s[32:35], s63 offen offset:0 lds
  v_mfma_f32_16x16x32_bf16 v[4:7], a[60:63], a[216:219], v[4:7]
  buffer_load_dwordx4 v81, s[32:35], s63 offen offset:1024 lds
  v_mfma_f32_16x16x32_bf16 v[24:27], a[64:67], a[216:219], v[24:27]
  s_waitcnt vmcnt(14) lgkmcnt(0)
  s_barrier
  s_add_u32 m0, s67, 49152
  v_mfma_f32_16x16x32_bf16 v[44:47], a[68:71], a[216:219], v[44:47]
  ds_read_b128 a[212:215], v142 offset:57344
  v_lshrrev_b32 v222, 3, v222
  v_mfma_f32_16x16x32_bf16 v[8:11], a[60:63], a[220:223], v[8:11]
  ds_read_b64_tr_b16 a[72:73], v145 offset:32768
  v_lshlrev_b32 v222, v222, 1
  v_mfma_f32_16x16x32_bf16 v[28:31], a[64:67], a[220:223], v[28:31]
  ds_read_b64_tr_b16 a[74:75], v145 offset:33280
  v_or_b32_dpp v222, v222, v222 row_ror:8 row_mask:0xf bank_mask:0xf
  v_mfma_f32_16x16x32_bf16 v[48:51], a[68:71], a[220:223], v[48:51]
  buffer_load_dwordx4 v82, s[32:35], s63 offen offset:0 lds
  v_mfma_f32_16x16x32_bf16 v[12:15], a[60:63], a[224:227], v[12:15]
  ds_read_b128 a[192:195], v136 offset:57344
  v_or_b32_dpp v222, v222, v222 row_ror:4 row_mask:0xf bank_mask:0xf
  v_mfma_f32_16x16x32_bf16 v[32:35], a[64:67], a[224:227], v[32:35]
  ds_read_b64_tr_b16 a[76:77], v145 offset:40960
  v_or_b32_dpp v222, v222, v222 row_ror:2 row_mask:0xf bank_mask:0xf
  v_mfma_f32_16x16x32_bf16 v[52:55], a[68:71], a[224:227], v[52:55]
  ds_read_b64_tr_b16 a[78:79], v145 offset:41472
  v_or_b32_dpp v222, v222, v222 row_ror:1 row_mask:0xf bank_mask:0xf
  v_mfma_f32_16x16x32_bf16 v[16:19], a[60:63], a[228:231], v[16:19]
  buffer_load_dwordx4 v83, s[32:35], s63 offen offset:1024 lds
  v_mfma_f32_16x16x32_bf16 v[36:39], a[64:67], a[228:231], v[36:39]
  s_add_u32 m0, s67, 65536
  s_add_u32 s63, s63, 176128
  s_sub_u32 s65, s63, 1409024
  s_min_u32 s63, s63, s65
  v_mfma_f32_16x16x32_bf16 v[56:59], a[68:71], a[228:231], v[56:59]
  ds_read_b64_tr_b16 a[80:81], v145 offset:49152
  v_lshlrev_b32 v223, 24, v0
  v_mfma_f32_16x16x32_bf16 v[20:23], a[60:63], v[76:79], v[20:23]
  ds_read_b64_tr_b16 a[82:83], v145 offset:49664
  buffer_load_dwordx4 v132, s[32:35], s63 offen offset:0 lds
  v_readfirstlane_b32 s4, v222
  v_mfma_f32_16x16x32_bf16 v[40:43], a[64:67], v[76:79], v[40:43]
  s_lshl_b32 s5, s27, 2
  ds_read_b128 a[196:199], v136 offset:59392
  v_mfma_f32_16x16x32_bf16 v[60:63], a[68:71], v[76:79], v[60:63]
  s_ff0_i32_b32 s4, s4
  ds_read_b128 a[200:203], v136 offset:61440
  s_waitcnt lgkmcnt(9)
  v_mfma_f32_16x16x32_bf16 v[64:67], v[76:79], a[212:215], v[64:67]
  s_waitcnt lgkmcnt(1)
  ds_read_b128 a[204:207], v136 offset:63488
  buffer_load_dwordx4 v133, s[32:35], s63 offen offset:1024 lds
  s_or_b32 s4, s4, 32
  s_lshl_b32 s4, s4, 3
  v_mfma_f32_16x16x32_bf16 v[68:71], a[212:215], a[212:215], v[68:71]
  s_add_u32 m0, s66, 65536
  s_add_u32 s60, s60, 128
  s_bitset0_b32 s60, 10
  v_mfma_f32_16x16x32_bf16 v[4:7], a[72:75], a[192:195], v[4:7]
  ds_read_b128 a[236:239], v143 offset:57344
  v_mov_b32 v222, s4
  v_mfma_f32_16x16x32_bf16 v[24:27], a[76:79], a[192:195], v[24:27]
  s_cmp_lg_u32 s3, 0
  s_cmov_b32 s5, 1073741824
  buffer_load_dwordx4 v128, s[28:31], s60 offen offset:0 lds
  v_dot2_f32_bf16 v215, v210, v76, 0
  v_mfma_f32_16x16x32_bf16 v[44:47], a[80:83], a[192:195], v[44:47]
  buffer_store_dword v222, v223, s[84:87], s5 offen offset:0 sc1
  v_mfma_f32_16x16x32_bf16 v[8:11], a[72:75], a[196:199], v[8:11]
  s_waitcnt lgkmcnt(1)
  ds_read_b64_tr_b16 a[84:85], v145 offset:36864
  v_mfma_f32_16x16x32_bf16 v[28:31], a[76:79], a[196:199], v[28:31]
  buffer_load_dwordx4 v129, s[28:31], s60 offen offset:1024 lds
  v_mfma_f32_16x16x32_bf16 v[48:51], a[80:83], a[196:199], v[48:51]
  s_add_u32 m0, s67, 73728
  ds_read_b64_tr_b16 a[86:87], v145 offset:37376
  v_mfma_f32_16x16x32_bf16 v[12:15], a[72:75], a[200:203], v[12:15]
  ds_read_b128 a[216:219], v137 offset:57344
  v_dot2_f32_bf16 v214, v210, v210, 0
  v_mfma_f32_16x16x32_bf16 v[32:35], a[76:79], a[200:203], v[32:35]
  ds_read_b64_tr_b16 a[88:89], v145 offset:45056
  buffer_load_dwordx4 v80, s[32:35], s63 offen offset:0 lds
  v_dot2_f32_bf16 v215, v211, v76, v215
  v_mfma_f32_16x16x32_bf16 v[52:55], a[80:83], a[200:203], v[52:55]
  ds_read_b64_tr_b16 a[90:91], v145 offset:45568
  v_dot2_f32_bf16 v214, v211, v211, v214
  v_mfma_f32_16x16x32_bf16 v[16:19], a[72:75], a[204:207], v[16:19]
  v_dot2_f32_bf16 v215, v212, v76, v215
  s_nop 0
  v_dot2_f32_bf16 v214, v212, v212, v214
  v_mfma_f32_16x16x32_bf16 v[36:39], a[76:79], a[204:207], v[36:39]
  ds_read_b64_tr_b16 a[92:93], v145 offset:53248
  buffer_load_dwordx4 v81, s[32:35], s63 offen offset:1024 lds
  v_dot2_f32_bf16 v215, v213, v76, v215
  v_mfma_f32_16x16x32_bf16 v[56:59], a[80:83], a[204:207], v[56:59]
  s_add_u32 m0, s67, 81920
  ds_read_b64_tr_b16 a[94:95], v145 offset:53760
  v_mfma_f32_16x16x32_bf16 v[20:23], a[72:75], v[76:79], v[20:23]
  ds_read_b128 a[220:223], v137 offset:59392
  v_dot2_f32_bf16 v214, v213, v213, v214
  v_mfma_f32_16x16x32_bf16 v[40:43], a[76:79], v[76:79], v[40:43]
  buffer_load_dwordx4 v82, s[32:35], s63 offen offset:0 lds
  s_nop 0
  v_permlane32_swap_b32 v215, v214
  v_mfma_f32_16x16x32_bf16 v[60:63], a[80:83], v[76:79], v[60:63]
  ds_read_b128 a[224:227], v137 offset:61440
  v_add_f32 v215, v215, v214
  s_waitcnt lgkmcnt(9)
  v_mfma_f32_16x16x32_bf16 v[64:67], v[76:79], a[236:239], v[64:67]
  s_waitcnt lgkmcnt(1)
  ds_read_b128 a[228:231], v137 offset:63488
  v_mfma_f32_16x16x32_bf16 v[68:71], a[236:239], a[236:239], v[68:71]
  buffer_load_dwordx4 v83, s[32:35], s63 offen offset:1024 lds
  v_mfma_f32_16x16x32_bf16 v[4:7], a[84:87], a[216:219], v[4:7]
  v_mov_b32 v214, v215
  v_mfma_f32_16x16x32_bf16 v[24:27], a[88:91], a[216:219], v[24:27]
  s_waitcnt vmcnt(17) lgkmcnt(0)
  s_barrier
  s_add_u32 m0, s67, 98304
  v_mfma_f32_16x16x32_bf16 v[44:47], a[92:95], a[216:219], v[44:47]
  s_add_u32 s63, s63, 176128
  v_permlane16_swap_b32 v215, v214
  v_mfma_f32_16x16x32_bf16 v[8:11], a[84:87], a[220:223], v[8:11]
  ds_read_b128 a[212:215], v140 offset:24576
  v_add_f32 v215, v215, v214
  v_mfma_f32_16x16x32_bf16 v[28:31], a[88:91], a[220:223], v[28:31]
  s_sub_u32 s65, s63, 1409024
  v_add_f32_dpp v215, v215, v215 row_ror:8 row_mask:0xf bank_mask:0xf
  s_min_u32 s63, s63, s65
  buffer_load_dwordx4 v132, s[32:35], s63 offen offset:0 lds
  v_mfma_f32_16x16x32_bf16 v[48:51], a[92:95], a[220:223], v[48:51]
  ds_read_b64_tr_b16 a[96:97], v144 offset:0
  v_add_f32_dpp v215, v215, v215 row_ror:4 row_mask:0xf bank_mask:0xf
  v_mfma_f32_16x16x32_bf16 v[12:15], a[84:87], a[224:227], v[12:15]
  ds_read_b64_tr_b16 a[98:99], v144 offset:512
  v_add_f32_dpp v215, v215, v215 row_ror:2 row_mask:0xf bank_mask:0xf
  v_mfma_f32_16x16x32_bf16 v[32:35], a[88:91], a[224:227], v[32:35]
  ds_read_b128 a[192:195], v134 offset:24576
  buffer_load_dwordx4 v133, s[32:35], s63 offen offset:1024 lds
  v_add_f32_dpp v215, v215, v215 row_ror:1 row_mask:0xf bank_mask:0xf
  v_mfma_f32_16x16x32_bf16 v[52:55], a[92:95], a[224:227], v[52:55]
  s_add_u32 m0, s66, 98304
  ds_read_b64_tr_b16 a[100:101], v144 offset:8192
  s_add_u32 s60, s60, 128
  s_bitset0_b32 s60, 10
  v_mfma_f32_16x16x32_bf16 v[16:19], a[84:87], a[228:231], v[16:19]
  ds_read_b64_tr_b16 a[102:103], v144 offset:8704
  v_mul_f32 v215, 0x3b000000, v215
  v_mfma_f32_16x16x32_bf16 v[36:39], a[88:91], a[228:231], v[36:39]
  ds_read_b64_tr_b16 a[104:105], v144 offset:16384
  buffer_load_dwordx4 v128, s[28:31], s60 offen offset:0 lds
  v_mov_b32 v214, v215
  v_mfma_f32_16x16x32_bf16 v[56:59], a[92:95], a[228:231], v[56:59]
  s_nop 0
  v_permlane32_swap_b32 v215, v214
  v_mfma_f32_16x16x32_bf16 v[20:23], a[84:87], v[76:79], v[20:23]
  ds_read_b64_tr_b16 a[106:107], v144 offset:16896
  v_fma_f32 v214, -v215, v215, v214
  v_mfma_f32_16x16x32_bf16 v[40:43], a[88:91], v[76:79], v[40:43]
  ds_read_b128 a[196:199], v134 offset:26624
  buffer_load_dwordx4 v129, s[28:31], s60 offen offset:1024 lds
  v_max_f32 v214, 0, v214
  v_mfma_f32_16x16x32_bf16 v[60:63], a[92:95], v[76:79], v[60:63]
  s_add_u32 m0, s67, 106496
  ds_read_b128 a[200:203], v134 offset:28672
  s_waitcnt lgkmcnt(9)
  v_mfma_f32_16x16x32_bf16 v[64:67], v[76:79], a[212:215], v[64:67]
  s_waitcnt lgkmcnt(1)
  ds_read_b128 a[204:207], v134 offset:30720
  v_cvt_pk_bf16_f32 v214, v215, v214
  v_lshlrev_b32 v215, 16, v214
  v_mfma_f32_16x16x32_bf16 v[68:71], a[212:215], a[212:215], v[68:71]
  buffer_load_dwordx4 v80, s[32:35], s63 offen offset:0 lds
  v_mfma_f32_16x16x32_bf16 v[4:7], a[96:99], a[192:195], v[4:7]
  v_and_b32 v214, 0xffff0000, v214
  v_add_f32 v214, 0x3727c5ac, v214
  v_mfma_f32_16x16x32_bf16 v[24:27], a[100:103], a[192:195], v[24:27]
  ds_read_b128 a[236:239], v141 offset:24576
  v_cvt_pk_bf16_f32 v214, v214, v214
  v_mfma_f32_16x16x32_bf16 v[44:47], a[104:107], a[192:195], v[44:47]
  buffer_load_dwordx4 v81, s[32:35], s63 offen offset:1024 lds
  v_mfma_f32_16x16x32_bf16 v[8:11], a[96:99], a[196:199], v[8:11]
  s_waitcnt lgkmcnt(1)
  v_and_b32 v214, 0xffff0000, v214
  s_add_u32 m0, s67, 114688
  v_mfma_f32_16x16x32_bf16 v[28:31], a[100:103], a[196:199], v[28:31]
  ds_read_b64_tr_b16 a[108:109], v144 offset:4096
  v_mfma_f32_16x16x32_bf16 v[48:51], a[104:107], a[196:199], v[48:51]
  ds_read_b64_tr_b16 a[110:111], v144 offset:4608
  buffer_load_dwordx4 v82, s[32:35], s63 offen offset:0 lds
  v_sqrt_f32 v214, v214
  v_mfma_f32_16x16x32_bf16 v[12:15], a[96:99], a[200:203], v[12:15]
  ds_read_b128 a[216:219], v135 offset:24576
  v_cvt_pk_bf16_f32 v214, v214, v214
  v_mfma_f32_16x16x32_bf16 v[32:35], a[100:103], a[200:203], v[32:35]
  ds_read_b64_tr_b16 a[112:113], v144 offset:12288
  v_and_b32 v214, 0xffff0000, v214
  v_mfma_f32_16x16x32_bf16 v[52:55], a[104:107], a[200:203], v[52:55]
  buffer_load_dwordx4 v83, s[32:35], s63 offen offset:1024 lds
  v_mfma_f32_16x16x32_bf16 v[16:19], a[96:99], a[204:207], v[16:19]
  ds_read_b64_tr_b16 a[114:115], v144 offset:12800
  v_mfma_f32_16x16x32_bf16 v[36:39], a[100:103], a[204:207], v[36:39]
  ds_read_b64_tr_b16 a[116:117], v144 offset:20480
  v_rcp_f32 v214, v214
  v_mfma_f32_16x16x32_bf16 v[56:59], a[104:107], a[204:207], v[56:59]
  ds_read_b64_tr_b16 a[118:119], v144 offset:20992
  v_mul_f32 v215, -v215, v214
  v_mfma_f32_16x16x32_bf16 v[20:23], a[96:99], v[76:79], v[20:23]
  s_lshl_b32 s4, s56, 1
  s_sub_u32 s4, s4, s57
  v_mfma_f32_16x16x32_bf16 v[40:43], a[100:103], v[76:79], v[40:43]
  ds_read_b128 a[220:223], v135 offset:26624
  v_mfma_f32_16x16x32_bf16 v[60:63], a[104:107], v[76:79], v[60:63]
  ds_read_b128 a[224:227], v135 offset:28672
  s_waitcnt lgkmcnt(9)
  v_mfma_f32_16x16x32_bf16 v[64:67], v[76:79], a[236:239], v[64:67]
  s_waitcnt lgkmcnt(1)
  buffer_store_dwordx2 v[214:215], v169, s[16:19], s4 offen sc1
  ds_read_b128 a[228:231], v135 offset:30720
  v_mfma_f32_16x16x32_bf16 v[68:71], a[236:239], a[236:239], v[68:71]
  buffer_store_dword v214, v169, s[16:19], s56 offen offset:512 sc1
  v_mfma_f32_16x16x32_bf16 v[4:7], a[108:111], a[216:219], v[4:7]
  buffer_store_dword v215, v169, s[16:19], s56 offen offset:768 sc1
  v_mfma_f32_16x16x32_bf16 v[24:27], a[112:115], a[216:219], v[24:27]
  s_waitcnt vmcnt(20) lgkmcnt(0)
  s_barrier
  s_add_u32 m0, s62, 0
  v_mfma_f32_16x16x32_bf16 v[44:47], a[116:119], a[216:219], v[44:47]
  s_add_u32 s60, s60, 128
  ds_read_b128 a[212:215], v140 offset:57344
  v_mfma_f32_16x16x32_bf16 v[8:11], a[108:111], a[220:223], v[8:11]
  s_bitset0_b32 s60, 10
  buffer_load_dwordx4 v130, s[28:31], s60 offen lds
  v_mfma_f32_16x16x32_bf16 v[28:31], a[112:115], a[220:223], v[28:31]
  s_add_u32 m0, s62, 4096
  ds_read_b64_tr_b16 a[120:121], v144 offset:32768
  v_mfma_f32_16x16x32_bf16 v[48:51], a[116:119], a[220:223], v[48:51]
  s_add_u32 s60, s60, 128
  s_bitset0_b32 s60, 10
  v_mfma_f32_16x16x32_bf16 v[12:15], a[108:111], a[224:227], v[12:15]
  ds_read_b64_tr_b16 a[122:123], v144 offset:33280
  v_mfma_f32_16x16x32_bf16 v[32:35], a[112:115], a[224:227], v[32:35]
  ds_read_b128 a[192:195], v134 offset:57344
  buffer_load_dwordx4 v130, s[28:31], s60 offen lds
  v_mfma_f32_16x16x32_bf16 v[52:55], a[116:119], a[224:227], v[52:55]
  s_add_u32 m0, s62, 8192
  ds_read_b64_tr_b16 a[124:125], v144 offset:40960
  s_add_u32 s60, s60, 128
  s_bitset0_b32 s60, 10
  v_mfma_f32_16x16x32_bf16 v[16:19], a[108:111], a[228:231], v[16:19]
  ds_read_b64_tr_b16 a[126:127], v144 offset:41472
  v_mfma_f32_16x16x32_bf16 v[36:39], a[112:115], a[228:231], v[36:39]
  buffer_load_dwordx4 v130, s[28:31], s60 offen lds
  v_mfma_f32_16x16x32_bf16 v[56:59], a[116:119], a[228:231], v[56:59]
  s_add_u32 m0, s62, 12288
  ds_read_b64_tr_b16 a[128:129], v144 offset:49152
  s_add_u32 s60, s60, 128
  s_bitset0_b32 s60, 10
  v_mfma_f32_16x16x32_bf16 v[20:23], a[108:111], v[76:79], v[20:23]
  ds_read_b64_tr_b16 a[130:131], v144 offset:49664
  v_mfma_f32_16x16x32_bf16 v[40:43], a[112:115], v[76:79], v[40:43]
  ds_read_b128 a[196:199], v134 offset:59392
  buffer_load_dwordx4 v130, s[28:31], s60 offen lds
  v_mfma_f32_16x16x32_bf16 v[60:63], a[116:119], v[76:79], v[60:63]
  s_add_u32 m0, s62, 16384
  ds_read_b128 a[200:203], v134 offset:61440
  s_add_u32 s60, s60, 128
  s_bitset0_b32 s60, 10
  s_waitcnt lgkmcnt(9)
  v_mfma_f32_16x16x32_bf16 v[64:67], v[76:79], a[212:215], v[64:67]
  s_waitcnt lgkmcnt(1)
  ds_read_b128 a[204:207], v134 offset:63488
  v_mfma_f32_16x16x32_bf16 v[68:71], a[212:215], a[212:215], v[68:71]
  buffer_load_dwordx4 v130, s[28:31], s60 offen lds
  v_mfma_f32_16x16x32_bf16 v[4:7], a[120:123], a[192:195], v[4:7]
  s_add_u32 m0, s62, 20480
  s_add_u32 s60, s60, 128
  s_bitset0_b32 s60, 10
  v_mfma_f32_16x16x32_bf16 v[24:27], a[124:127], a[192:195], v[24:27]
  ds_read_b128 a[236:239], v141 offset:57344
  v_mfma_f32_16x16x32_bf16 v[44:47], a[128:131], a[192:195], v[44:47]
  buffer_load_dwordx4 v130, s[28:31], s60 offen lds
  v_mfma_f32_16x16x32_bf16 v[8:11], a[120:123], a[196:199], v[8:11]
  s_waitcnt lgkmcnt(1)
  s_add_u32 m0, s62, 24576
  s_add_u32 s60, s60, 128
  s_bitset0_b32 s60, 10
  v_mfma_f32_16x16x32_bf16 v[28:31], a[124:127], a[196:199], v[28:31]
  ds_read_b64_tr_b16 a[132:133], v144 offset:36864
  v_mfma_f32_16x16x32_bf16 v[48:51], a[128:131], a[196:199], v[48:51]
  buffer_load_dword v167, v166, s[84:87], 0 offen offset:0 sc1
  ds_read_b64_tr_b16 a[134:135], v144 offset:37376
  buffer_load_dwordx4 v130, s[28:31], s60 offen lds
  v_mfma_f32_16x16x32_bf16 v[12:15], a[120:123], a[200:203], v[12:15]
  s_add_u32 m0, s62, 28672
  ds_read_b128 a[216:219], v135 offset:57344
  s_add_u32 s60, s60, 128
  s_bitset0_b32 s60, 10
  v_mfma_f32_16x16x32_bf16 v[32:35], a[124:127], a[200:203], v[32:35]
  ds_read_b64_tr_b16 a[136:137], v144 offset:45056
  v_mfma_f32_16x16x32_bf16 v[52:55], a[128:131], a[200:203], v[52:55]
  buffer_load_dwordx4 v130, s[28:31], s60 offen lds
  v_mfma_f32_16x16x32_bf16 v[16:19], a[120:123], a[204:207], v[16:19]
  ds_read_b64_tr_b16 a[138:139], v144 offset:45568
  v_mfma_f32_16x16x32_bf16 v[36:39], a[124:127], a[204:207], v[36:39]
  ds_read_b64_tr_b16 a[140:141], v144 offset:53248
  v_mfma_f32_16x16x32_bf16 v[56:59], a[128:131], a[204:207], v[56:59]
  ds_read_b64_tr_b16 a[142:143], v144 offset:53760
  v_mfma_f32_16x16x32_bf16 v[20:23], a[120:123], v[76:79], v[20:23]
  ds_read_b128 a[220:223], v135 offset:59392
  v_mfma_f32_16x16x32_bf16 v[40:43], a[124:127], v[76:79], v[40:43]
  ds_read_b128 a[224:227], v135 offset:61440
  v_mfma_f32_16x16x32_bf16 v[60:63], a[128:131], v[76:79], v[60:63]
  ds_read_b128 a[228:231], v135 offset:63488
  s_waitcnt lgkmcnt(10)
  v_mfma_f32_16x16x32_bf16 v[64:67], v[76:79], a[236:239], v[64:67]
  s_waitcnt lgkmcnt(2)
  v_mfma_f32_16x16x32_bf16 v[68:71], a[236:239], a[236:239], v[68:71]
  v_mfma_f32_16x16x32_bf16 v[4:7], a[132:135], a[216:219], v[4:7]
  v_lshlrev_b32 v224, 16, v238
  v_mfma_f32_16x16x32_bf16 v[24:27], a[136:139], a[216:219], v[24:27]
  s_waitcnt vmcnt(20) lgkmcnt(0)
  s_barrier
  v_add_u32 v128, 65536, v130
  v_mfma_f32_16x16x32_bf16 v[44:47], a[140:143], a[216:219], v[44:47]
  s_add_u32 m0, s62, 32768
  ds_read_b128 a[212:215], v142 offset:24576
  v_mfma_f32_16x16x32_bf16 v[8:11], a[132:135], a[220:223], v[8:11]
  s_add_u32 s60, s60, 128
  ds_read_b64_tr_b16 a[144:145], v145 offset:0
  v_mfma_f32_16x16x32_bf16 v[28:31], a[136:139], a[220:223], v[28:31]
  s_bitset0_b32 s60, 10
  ds_read_b64_tr_b16 a[146:147], v145 offset:512
  v_mfma_f32_16x16x32_bf16 v[48:51], a[140:143], a[220:223], v[48:51]
  ds_read_b128 a[192:195], v136 offset:24576
  v_and_b32 v225, 0xffff0000, v238
  v_mfma_f32_16x16x32_bf16 v[12:15], a[132:135], a[224:227], v[12:15]
  buffer_load_dwordx4 v128, s[28:31], s60 offen lds
  v_mfma_f32_16x16x32_bf16 v[32:35], a[136:139], a[224:227], v[32:35]
  s_add_u32 m0, s62, 36864
  ds_read_b64_tr_b16 a[148:149], v145 offset:8192
  v_mfma_f32_16x16x32_bf16 v[52:55], a[140:143], a[224:227], v[52:55]
  s_add_u32 s60, s60, 128
  v_lshlrev_b32 v226, 16, v239
  s_bitset0_b32 s60, 10
  v_mfma_f32_16x16x32_bf16 v[16:19], a[132:135], a[228:231], v[16:19]
  ds_read_b64_tr_b16 a[150:151], v145 offset:8704
  v_and_b32 v227, 0xffff0000, v239
  v_mfma_f32_16x16x32_bf16 v[36:39], a[136:139], a[228:231], v[36:39]
  buffer_load_dwordx4 v128, s[28:31], s60 offen lds
  v_mfma_f32_16x16x32_bf16 v[56:59], a[140:143], a[228:231], v[56:59]
  s_add_u32 m0, s62, 40960
  ds_read_b64_tr_b16 a[152:153], v145 offset:16384
  s_add_u32 s60, s60, 128
  s_bitset0_b32 s60, 10
  v_mfma_f32_16x16x32_bf16 v[20:23], a[132:135], v[76:79], v[20:23]
  ds_read_b64_tr_b16 a[154:155], v145 offset:16896
  v_lshlrev_b32 v228, 16, v240
  v_mfma_f32_16x16x32_bf16 v[40:43], a[136:139], v[76:79], v[40:43]
  ds_read_b128 a[196:199], v136 offset:26624
  buffer_load_dwordx4 v128, s[28:31], s60 offen lds
  v_and_b32 v229, 0xffff0000, v240
  v_mfma_f32_16x16x32_bf16 v[60:63], a[140:143], v[76:79], v[60:63]
  s_add_u32 m0, s62, 45056
  ds_read_b128 a[200:203], v136 offset:28672
  s_add_u32 s60, s60, 128
  s_bitset0_b32 s60, 10
  s_waitcnt lgkmcnt(9)
  v_mfma_f32_16x16x32_bf16 v[64:67], v[76:79], a[212:215], v[64:67]
  s_waitcnt lgkmcnt(1)
  ds_read_b128 a[204:207], v136 offset:30720
  v_mfma_f32_16x16x32_bf16 v[68:71], a[212:215], a[212:215], v[68:71]
  buffer_load_dwordx4 v128, s[28:31], s60 offen lds
  v_mfma_f32_16x16x32_bf16 v[4:7], a[144:147], a[192:195], v[4:7]
  s_add_u32 s11, s23, 32768
  s_sub_u32 s5, s11, 458752
  s_min_u32 s11, s11, s5
  s_add_u32 m0, s10, 147456
  v_mfma_f32_16x16x32_bf16 v[24:27], a[148:151], a[192:195], v[24:27]
  ds_read_b128 a[236:239], v143 offset:24576
  v_lshlrev_b32 v230, 16, v241
  v_mfma_f32_16x16x32_bf16 v[44:47], a[152:155], a[192:195], v[44:47]
  buffer_load_dwordx4 v158, s[48:51], s11 offen offset:0 lds
  v_mfma_f32_16x16x32_bf16 v[8:11], a[144:147], a[196:199], v[8:11]
  s_waitcnt lgkmcnt(1)
  ds_read_b64_tr_b16 a[156:157], v145 offset:4096
  v_mfma_f32_16x16x32_bf16 v[28:31], a[148:151], a[196:199], v[28:31]
  ds_read_b64_tr_b16 a[158:159], v145 offset:4608
  v_and_b32 v231, 0xffff0000, v241
  v_mfma_f32_16x16x32_bf16 v[48:51], a[152:155], a[196:199], v[48:51]
  buffer_load_dwordx4 v159, s[48:51], s11 offen offset:1024 lds
  v_mfma_f32_16x16x32_bf16 v[12:15], a[144:147], a[200:203], v[12:15]
  ds_read_b128 a[216:219], v137 offset:24576
  s_waitcnt vmcnt(15)
  s_mov_b64 exec, 1
  ds_add_rtn_u32 v3, v170, v170 offset:4
  s_mov_b64 exec, -1
  v_lshlrev_b32 v232, 16, v242
  v_mfma_f32_16x16x32_bf16 v[32:35], a[148:151], a[200:203], v[32:35]
  ds_read_b64_tr_b16 a[160:161], v145 offset:12288
  v_and_b32 v233, 0xffff0000, v242
  v_mfma_f32_16x16x32_bf16 v[52:55], a[152:155], a[200:203], v[52:55]
  buffer_load_dwordx4 v160, s[48:51], s11 offen offset:2048 lds
  v_mfma_f32_16x16x32_bf16 v[16:19], a[144:147], a[204:207], v[16:19]
  ds_read_b64_tr_b16 a[162:163], v145 offset:12800
  v_mfma_f32_16x16x32_bf16 v[36:39], a[148:151], a[204:207], v[36:39]
  ds_read_b64_tr_b16 a[164:165], v145 offset:20480
  v_lshlrev_b32 v234, 16, v243
  v_mfma_f32_16x16x32_bf16 v[56:59], a[152:155], a[204:207], v[56:59]
  ds_read_b64_tr_b16 a[166:167], v145 offset:20992
  buffer_load_dwordx4 v161, s[48:51], s11 offen offset:3072 lds
  v_mfma_f32_16x16x32_bf16 v[20:23], a[144:147], v[76:79], v[20:23]
  ds_read_b128 a[220:223], v137 offset:26624
  s_lshr_b32 s5, s6, 1
  s_waitcnt vmcnt(10)
  v_readlane_b32 s24, v167, s27
  v_readlane_b32 s25, v167, s5
  s_nop 0
  s_min_u32 s4, s24, s25
  s_cmp_eq_u32 s4, 0
  s_cbranch_scc1 L_epf
L_epfok:
  v_mfma_f32_16x16x32_bf16 v[40:43], a[148:151], v[76:79], v[40:43]
  ds_read_b128 a[224:227], v137 offset:28672
  v_and_b32 v235, 0xffff0000, v243
  v_mfma_f32_16x16x32_bf16 v[60:63], a[152:155], v[76:79], v[60:63]
  ds_read_b128 a[228:231], v137 offset:30720
  s_waitcnt lgkmcnt(11)
  v_mfma_f32_16x16x32_bf16 v[64:67], v[76:79], a[236:239], v[64:67]
  s_waitcnt lgkmcnt(2)
  v_mfma_f32_16x16x32_bf16 v[68:71], a[236:239], a[236:239], v[68:71]
  v_mfma_f32_16x16x32_bf16 v[4:7], a[156:159], a[216:219], v[4:7]
  global_load_dword v220, v221, s[82:83]
  v_mfma_f32_16x16x32_bf16 v[24:27], a[160:163], a[216:219], v[24:27]
  s_waitcnt lgkmcnt(0)
  s_barrier
  v_mfma_f32_16x16x32_bf16 v[44:47], a[164:167], a[216:219], v[44:47]
  ds_read_b128 a[212:215], v142 offset:57344
  v_mfma_f32_16x16x32_bf16 v[8:11], a[156:159], a[220:223], v[8:11]
  s_add_u32 s11, s23, 0
  s_sub_u32 s5, s11, 458752
  s_min_u32 s11, s11, s5
  v_mfma_f32_16x16x32_bf16 v[28:31], a[160:163], a[220:223], v[28:31]
  s_add_u32 m0, s10, 81920
  ds_read_b64_tr_b16 a[168:169], v145 offset:32768
  buffer_load_dwordx4 v158, s[48:51], s11 offen offset:0 lds
  v_mfma_f32_16x16x32_bf16 v[48:51], a[164:167], a[220:223], v[48:51]
  ds_read_b64_tr_b16 a[170:171], v145 offset:33280
  v_mfma_f32_16x16x32_bf16 v[12:15], a[156:159], a[224:227], v[12:15]
  ds_read_b128 a[192:195], v136 offset:57344
  s_add_u32 s5, s24, 1
  v_readfirstlane_b32 s4, v3
  v_mov_b32 v3, s5
  s_cmp_eq_u32 s4, 422400
  s_cselect_b32 s4, s20, 1073741824
  s_nop 1
  buffer_store_dword v3, v169, s[16:19], s4 offen sc1
  v_mfma_f32_16x16x32_bf16 v[32:35], a[160:163], a[224:227], v[32:35]
  buffer_load_dwordx4 v159, s[48:51], s11 offen offset:1024 lds
  v_mfma_f32_16x16x32_bf16 v[52:55], a[164:167], a[224:227], v[52:55]
  ds_read_b64_tr_b16 a[172:173], v145 offset:40960
  v_mfma_f32_16x16x32_bf16 v[16:19], a[156:159], a[228:231], v[16:19]
  ds_read_b64_tr_b16 a[174:175], v145 offset:41472
  v_mfma_f32_16x16x32_bf16 v[36:39], a[160:163], a[228:231], v[36:39]
  buffer_load_dwordx4 v160, s[48:51], s11 offen offset:2048 lds
  v_mfma_f32_16x16x32_bf16 v[56:59], a[164:167], a[228:231], v[56:59]
  ds_read_b64_tr_b16 a[176:177], v145 offset:49152
  v_mfma_f32_16x16x32_bf16 v[20:23], a[156:159], v[76:79], v[20:23]
  ds_read_b64_tr_b16 a[178:179], v145 offset:49664
  v_mfma_f32_16x16x32_bf16 v[40:43], a[160:163], v[76:79], v[40:43]
  ds_read_b128 a[196:199], v136 offset:59392
  buffer_load_dwordx4 v161, s[48:51], s11 offen offset:3072 lds
  v_mfma_f32_16x16x32_bf16 v[60:63], a[164:167], v[76:79], v[60:63]
  s_add_u32 m0, s10, 65536
  ds_read_b128 a[200:203], v136 offset:61440
  s_waitcnt lgkmcnt(9)
  v_mfma_f32_16x16x32_bf16 v[64:67], v[76:79], a[212:215], v[64:67]
  s_waitcnt lgkmcnt(1)
  ds_read_b128 a[204:207], v136 offset:63488
  v_mfma_f32_16x16x32_bf16 v[68:71], a[212:215], a[212:215], v[68:71]
  buffer_load_dwordx4 v158, s[44:47], 0 offen offset:0 lds
  v_mfma_f32_16x16x32_bf16 v[4:7], a[168:171], a[192:195], v[4:7]
  ds_read_b128 a[236:239], v143 offset:57344
  v_mfma_f32_16x16x32_bf16 v[24:27], a[172:175], a[192:195], v[24:27]
  buffer_load_dwordx4 v159, s[44:47], 0 offen offset:1024 lds
  v_mfma_f32_16x16x32_bf16 v[44:47], a[176:179], a[192:195], v[44:47]
  ds_read_b64_tr_b16 a[180:181], v145 offset:36864
  v_mfma_f32_16x16x32_bf16 v[8:11], a[168:171], a[196:199], v[8:11]
  s_waitcnt lgkmcnt(2)
  ds_read_b64_tr_b16 a[182:183], v145 offset:37376
  v_mfma_f32_16x16x32_bf16 v[28:31], a[172:175], a[196:199], v[28:31]
  buffer_load_dwordx4 v160, s[44:47], 0 offen offset:2048 lds
  v_mfma_f32_16x16x32_bf16 v[48:51], a[176:179], a[196:199], v[48:51]
  ds_read_b128 a[216:219], v137 offset:57344
  v_mfma_f32_16x16x32_bf16 v[12:15], a[168:171], a[200:203], v[12:15]
  ds_read_b64_tr_b16 a[184:185], v145 offset:45056
  v_mfma_f32_16x16x32_bf16 v[32:35], a[172:175], a[200:203], v[32:35]
  buffer_load_dwordx4 v161, s[44:47], 0 offen offset:3072 lds
  s_waitcnt lgkmcnt(4)
  v_mfma_f32_16x16x32_bf16 v[64:67], v[76:79], a[236:239], v[64:67]
  ds_read_b64_tr_b16 a[186:187], v145 offset:45568
  v_mfma_f32_16x16x32_bf16 v[68:71], a[236:239], a[236:239], v[68:71]
  ds_read_b64_tr_b16 a[188:189], v145 offset:53248
  v_mfma_f32_16x16x32_bf16 v[52:55], a[176:179], a[200:203], v[52:55]
  ds_read_b64_tr_b16 a[190:191], v145 offset:53760
  v_mfma_f32_16x16x32_bf16 v[16:19], a[168:171], a[204:207], v[16:19]
  ds_read_b128 a[220:223], v137 offset:59392
  v_mfma_f32_16x16x32_bf16 v[36:39], a[172:175], a[204:207], v[36:39]
  ds_read_b128 a[224:227], v137 offset:61440
  v_mfma_f32_16x16x32_bf16 v[56:59], a[176:179], a[204:207], v[56:59]
  v_cndmask_b32 v210, v68, v69, s[70:71]
  v_cndmask_b32 v210, v210, v70, s[72:73]
  v_mfma_f32_16x16x32_bf16 v[20:23], a[168:171], v[76:79], v[20:23]
  ds_read_b128 a[228:231], v137 offset:63488
  v_cndmask_b32 v210, v210, v71, s[74:75]
  v_mfma_f32_16x16x32_bf16 v[40:43], a[172:175], v[76:79], v[40:43]
  s_waitcnt lgkmcnt(2)
  v_mul_f32 v211, 0x3b000000, v64
  v_mul_f32 v210, 0x3b000000, v210
  v_mfma_f32_16x16x32_bf16 v[60:63], a[176:179], v[76:79], v[60:63]
  v_fma_f32 v210, -v211, v211, v210
  v_max_f32 v210, 0, v210
  v_mfma_f32_16x16x32_bf16 v[20:23], a[180:183], v[76:79], v[20:23]
  v_cvt_pk_bf16_f32 v210, v211, v210
  v_lshlrev_b32 v211, 16, v210
  v_mfma_f32_16x16x32_bf16 v[40:43], a[184:187], v[76:79], v[40:43]
  v_and_b32 v210, 0xffff0000, v210
  v_add_f32 v210, 0x3727c5ac, v210
  v_mfma_f32_16x16x32_bf16 v[60:63], a[188:191], v[76:79], v[60:63]
  v_cvt_pk_bf16_f32 v210, v210, v210
  v_and_b32 v210, 0xffff0000, v210
  v_mfma_f32_16x16x32_bf16 v[4:7], a[180:183], a[216:219], v[4:7]
  v_sqrt_f32 v210, v210
  v_mfma_f32_16x16x32_bf16 v[24:27], a[184:187], a[216:219], v[24:27]
  v_cvt_pk_bf16_f32 v210, v210, v210
  v_and_b32 v210, 0xffff0000, v210
  v_mfma_f32_16x16x32_bf16 v[44:47], a[188:191], a[216:219], v[44:47]
  v_rcp_f32 v210, v210
  v_mfma_f32_16x16x32_bf16 v[8:11], a[180:183], a[220:223], v[8:11]
  v_mul_f32 v211, -v211, v210
  v_mfma_f32_16x16x32_bf16 v[28:31], a[184:187], a[220:223], v[28:31]
  ds_write_b64 v171, v[210:211]
  v_mfma_f32_16x16x32_bf16 v[48:51], a[188:191], a[220:223], v[48:51]
  s_waitcnt lgkmcnt(2)
  v_mfma_f32_16x16x32_bf16 v[12:15], a[180:183], a[224:227], v[12:15]
  v_mfma_f32_16x16x32_bf16 v[32:35], a[184:187], a[224:227], v[32:35]
  v_mfma_f32_16x16x32_bf16 v[52:55], a[188:191], a[224:227], v[52:55]
  s_waitcnt vmcnt(18) lgkmcnt(0)
  s_barrier
  v_mfma_f32_16x16x32_bf16 v[16:19], a[180:183], a[228:231], v[16:19]
  ds_read_b64 v[176:177], v175 offset:0
  v_mfma_f32_16x16x32_bf16 v[36:39], a[184:187], a[228:231], v[36:39]
  ds_read_b64 v[178:179], v175 offset:128
  ds_read_b64 v[180:181], v175 offset:256
  v_mfma_f32_16x16x32_bf16 v[56:59], a[188:191], a[228:231], v[56:59]
  ds_read_b64 v[182:183], v175 offset:384
  s_waitcnt lgkmcnt(3)
  v_pk_fma_f32 v[194:195], v[176:177], v[20:21], v[224:225] op_sel:[1,0,0] op_sel_hi:[1,1,1]
  v_pk_fma_f32 v[196:197], v[176:177], v[22:23], v[226:227] op_sel:[1,0,0] op_sel_hi:[1,1,1]
  s_waitcnt lgkmcnt(2)
  v_pk_fma_f32 v[198:199], v[178:179], v[20:21], v[224:225] op_sel:[1,0,0] op_sel_hi:[1,1,1]
  v_pk_fma_f32 v[200:201], v[178:179], v[22:23], v[226:227] op_sel:[1,0,0] op_sel_hi:[1,1,1]
  v_pk_fma_f32 v[4:5], v[176:177], v[4:5], v[194:195] op_sel:[0,0,0] op_sel_hi:[0,1,1]
  v_pk_fma_f32 v[6:7], v[176:177], v[6:7], v[196:197] op_sel:[0,0,0] op_sel_hi:[0,1,1]
  v_pk_fma_f32 v[8:9], v[178:179], v[8:9], v[198:199] op_sel:[0,0,0] op_sel_hi:[0,1,1]
  v_pk_fma_f32 v[10:11], v[178:179], v[10:11], v[200:201] op_sel:[0,0,0] op_sel_hi:[0,1,1]
  v_pk_mul_f32 v[194:195], v[4:5], v[4:5]
  v_pk_mul_f32 v[196:197], v[6:7], v[6:7]
  v_pk_mul_f32 v[198:199], v[8:9], v[8:9]
  v_pk_mul_f32 v[200:201], v[10:11], v[10:11]
  v_pk_fma_f32 v[194:195], v[194:195], v[236:237], v[236:237] op_sel:[0,0,1] op_sel_hi:[1,0,1]
  s_add_u32 m0, s62, 49152
  s_add_u32 s60, s60, 128
  s_bitset0_b32 s60, 10
  buffer_load_dwordx4 v128, s[28:31], s60 offen lds
  v_pk_fma_f32 v[196:197], v[196:197], v[236:237], v[236:237] op_sel:[0,0,1] op_sel_hi:[1,0,1]
  v_pk_fma_f32 v[198:199], v[198:199], v[236:237], v[236:237] op_sel:[0,0,1] op_sel_hi:[1,0,1]
  v_pk_fma_f32 v[200:201], v[200:201], v[236:237], v[236:237] op_sel:[0,0,1] op_sel_hi:[1,0,1]
  v_pk_mul_f32 v[194:195], v[194:195], v[4:5]
  v_pk_mul_f32 v[196:197], v[196:197], v[6:7]
  s_add_u32 m0, s62, 53248
  s_add_u32 s60, s60, 128
  s_bitset0_b32 s60, 10
  buffer_load_dwordx4 v128, s[28:31], s60 offen lds
  v_pk_mul_f32 v[198:199], v[198:199], v[8:9]
  v_pk_mul_f32 v[200:201], v[200:201], v[10:11]
  v_exp_f32 v194, v194
  v_exp_f32 v195, v195
  v_exp_f32 v196, v196
  s_add_u32 m0, s62, 57344
  s_add_u32 s60, s60, 128
  s_bitset0_b32 s60, 10
  buffer_load_dwordx4 v128, s[28:31], s60 offen lds
  v_exp_f32 v197, v197
  v_exp_f32 v198, v198
  v_exp_f32 v199, v199
  v_exp_f32 v200, v200
  v_exp_f32 v201, v201
  v_pk_add_f32 v[194:195], v[194:195], 1.0 op_sel_hi:[1,0]
  s_add_u32 m0, s62, 61440
  s_add_u32 s60, s60, 128
  s_bitset0_b32 s60, 10
  buffer_load_dwordx4 v128, s[28:31], s60 offen lds
  v_pk_add_f32 v[196:197], v[196:197], 1.0 op_sel_hi:[1,0]
  v_pk_add_f32 v[198:199], v[198:199], 1.0 op_sel_hi:[1,0]
  v_pk_add_f32 v[200:201], v[200:201], 1.0 op_sel_hi:[1,0]
  v_rcp_f32 v194, v194
  v_rcp_f32 v195, v195
  s_add_u32 s11, s23, 65536
  s_sub_u32 s5, s11, 458752
  s_min_u32 s11, s11, s5
  s_add_u32 m0, s10, 98304
  s_nop 0
  buffer_load_dwordx4 v158, s[48:51], s11 offen offset:0 lds
  v_rcp_f32 v196, v196
  v_rcp_f32 v197, v197
  v_rcp_f32 v198, v198
  v_rcp_f32 v199, v199
  v_rcp_f32 v200, v200
  buffer_load_dwordx4 v159, s[48:51], s11 offen offset:1024 lds
  v_rcp_f32 v201, v201
  v_pk_mul_f32 v[194:195], v[194:195], v[4:5]
  v_pk_mul_f32 v[196:197], v[196:197], v[6:7]
  v_pk_mul_f32 v[198:199], v[198:199], v[8:9]
  v_pk_mul_f32 v[200:201], v[200:201], v[10:11]
  v_cvt_pk_bf16_f32 v4, v194, v195
  buffer_load_dwordx4 v160, s[48:51], s11 offen offset:2048 lds
  v_cvt_pk_bf16_f32 v6, v198, v199
  v_cvt_pk_bf16_f32 v5, v196, v197
  v_cvt_pk_bf16_f32 v7, v200, v201
  v_permlane16_swap_b32 v4, v6
  s_nop 0
  v_permlane16_swap_b32 v5, v7
  buffer_load_dwordx4 v161, s[48:51], s11 offen offset:3072 lds
  s_add_u32 s69, s78, 0
  buffer_store_dwordx4 v[4:7], v163, s[36:39], s69 offen sc1
  v_pk_fma_f32 v[202:203], v[176:177], v[40:41], v[228:229] op_sel:[1,0,0] op_sel_hi:[1,1,1]
  v_pk_fma_f32 v[204:205], v[176:177], v[42:43], v[230:231] op_sel:[1,0,0] op_sel_hi:[1,1,1]
  v_pk_fma_f32 v[206:207], v[178:179], v[40:41], v[228:229] op_sel:[1,0,0] op_sel_hi:[1,1,1]
  v_pk_fma_f32 v[208:209], v[178:179], v[42:43], v[230:231] op_sel:[1,0,0] op_sel_hi:[1,1,1]
  s_waitcnt vmcnt(19)
  ds_read_b64_tr_b16 v[112:113], v154 offset:16384
  v_pk_fma_f32 v[24:25], v[176:177], v[24:25], v[202:203] op_sel:[0,0,0] op_sel_hi:[0,1,1]
  v_pk_fma_f32 v[26:27], v[176:177], v[26:27], v[204:205] op_sel:[0,0,0] op_sel_hi:[0,1,1]
  v_pk_fma_f32 v[28:29], v[178:179], v[28:29], v[206:207] op_sel:[0,0,0] op_sel_hi:[0,1,1]
  v_pk_fma_f32 v[30:31], v[178:179], v[30:31], v[208:209] op_sel:[0,0,0] op_sel_hi:[0,1,1]
  v_pk_mul_f32 v[202:203], v[24:25], v[24:25]
  v_pk_mul_f32 v[204:205], v[26:27], v[26:27]
  ds_read_b64_tr_b16 v[114:115], v154 offset:16896
  v_pk_mul_f32 v[206:207], v[28:29], v[28:29]
  v_pk_mul_f32 v[208:209], v[30:31], v[30:31]
  v_pk_fma_f32 v[202:203], v[202:203], v[236:237], v[236:237] op_sel:[0,0,1] op_sel_hi:[1,0,1]
  v_pk_fma_f32 v[204:205], v[204:205], v[236:237], v[236:237] op_sel:[0,0,1] op_sel_hi:[1,0,1]
  v_pk_fma_f32 v[206:207], v[206:207], v[236:237], v[236:237] op_sel:[0,0,1] op_sel_hi:[1,0,1]
  ds_read_b64_tr_b16 v[116:117], v155 offset:16384
  v_pk_fma_f32 v[208:209], v[208:209], v[236:237], v[236:237] op_sel:[0,0,1] op_sel_hi:[1,0,1]
  v_pk_mul_f32 v[202:203], v[202:203], v[24:25]
  v_pk_mul_f32 v[204:205], v[204:205], v[26:27]
  v_pk_mul_f32 v[206:207], v[206:207], v[28:29]
  v_pk_mul_f32 v[208:209], v[208:209], v[30:31]
  ds_read_b64_tr_b16 v[118:119], v155 offset:16896
  v_exp_f32 v202, v202
  v_exp_f32 v203, v203
  v_exp_f32 v204, v204
  v_exp_f32 v205, v205
  v_exp_f32 v206, v206
  ds_read_b64_tr_b16 v[120:121], v156 offset:16384
  v_exp_f32 v207, v207
  v_exp_f32 v208, v208
  v_exp_f32 v209, v209
  v_pk_add_f32 v[202:203], v[202:203], 1.0 op_sel_hi:[1,0]
  v_pk_add_f32 v[204:205], v[204:205], 1.0 op_sel_hi:[1,0]
  v_pk_add_f32 v[206:207], v[206:207], 1.0 op_sel_hi:[1,0]
  ds_read_b64_tr_b16 v[122:123], v156 offset:16896
  v_pk_add_f32 v[208:209], v[208:209], 1.0 op_sel_hi:[1,0]
  v_rcp_f32 v202, v202
  v_rcp_f32 v203, v203
  v_rcp_f32 v204, v204
  v_rcp_f32 v205, v205
  ds_read_b64_tr_b16 v[124:125], v157 offset:16384
  v_rcp_f32 v206, v206
  v_rcp_f32 v207, v207
  v_rcp_f32 v208, v208
  v_rcp_f32 v209, v209
  v_pk_mul_f32 v[202:203], v[202:203], v[24:25]
  ds_read_b64_tr_b16 v[126:127], v157 offset:16896
  v_pk_mul_f32 v[204:205], v[204:205], v[26:27]
  v_pk_mul_f32 v[206:207], v[206:207], v[28:29]
  v_pk_mul_f32 v[208:209], v[208:209], v[30:31]
  v_cvt_pk_bf16_f32 v24, v202, v203
  v_cvt_pk_bf16_f32 v26, v206, v207
  v_cvt_pk_bf16_f32 v25, v204, v205
  s_waitcnt lgkmcnt(0)
  s_add_u32 s11, s23, 196608
  s_sub_u32 s5, s11, 458752
  s_min_u32 s11, s11, s5
  s_add_u32 m0, s10, 147456
  s_nop 0
  buffer_load_dwordx4 v158, s[48:51], s11 offen offset:0 lds
  v_cvt_pk_bf16_f32 v27, v208, v209
  v_permlane16_swap_b32 v24, v26
  s_nop 0
  v_permlane16_swap_b32 v25, v27
  s_add_u32 s69, s79, 0
  buffer_store_dwordx4 v[24:27], v163, s[36:39], s69 offen sc1
  v_pk_fma_f32 v[210:211], v[176:177], v[60:61], v[232:233] op_sel:[1,0,0] op_sel_hi:[1,1,1]
  buffer_load_dwordx4 v159, s[48:51], s11 offen offset:1024 lds
  v_pk_fma_f32 v[212:213], v[176:177], v[62:63], v[234:235] op_sel:[1,0,0] op_sel_hi:[1,1,1]
  v_pk_fma_f32 v[214:215], v[178:179], v[60:61], v[232:233] op_sel:[1,0,0] op_sel_hi:[1,1,1]
  v_pk_fma_f32 v[216:217], v[178:179], v[62:63], v[234:235] op_sel:[1,0,0] op_sel_hi:[1,1,1]
  v_pk_fma_f32 v[44:45], v[176:177], v[44:45], v[210:211] op_sel:[0,0,0] op_sel_hi:[0,1,1]
  v_pk_fma_f32 v[46:47], v[176:177], v[46:47], v[212:213] op_sel:[0,0,0] op_sel_hi:[0,1,1]
  buffer_load_dwordx4 v160, s[48:51], s11 offen offset:2048 lds
  v_pk_fma_f32 v[48:49], v[178:179], v[48:49], v[214:215] op_sel:[0,0,0] op_sel_hi:[0,1,1]
  v_pk_fma_f32 v[50:51], v[178:179], v[50:51], v[216:217] op_sel:[0,0,0] op_sel_hi:[0,1,1]
  v_pk_mul_f32 v[210:211], v[44:45], v[44:45]
  v_pk_mul_f32 v[212:213], v[46:47], v[46:47]
  v_pk_mul_f32 v[214:215], v[48:49], v[48:49]
  v_pk_mul_f32 v[216:217], v[50:51], v[50:51]
  buffer_load_dwordx4 v161, s[48:51], s11 offen offset:3072 lds
  v_pk_fma_f32 v[210:211], v[210:211], v[236:237], v[236:237] op_sel:[0,0,1] op_sel_hi:[1,0,1]
  v_pk_fma_f32 v[212:213], v[212:213], v[236:237], v[236:237] op_sel:[0,0,1] op_sel_hi:[1,0,1]
  v_pk_fma_f32 v[214:215], v[214:215], v[236:237], v[236:237] op_sel:[0,0,1] op_sel_hi:[1,0,1]
  v_pk_fma_f32 v[216:217], v[216:217], v[236:237], v[236:237] op_sel:[0,0,1] op_sel_hi:[1,0,1]
  v_pk_mul_f32 v[210:211], v[210:211], v[44:45]
  ds_read_b128 a[192:195], v134 offset:0
  v_pk_mul_f32 v[212:213], v[212:213], v[46:47]
  v_pk_mul_f32 v[214:215], v[214:215], v[48:49]
  v_pk_mul_f32 v[216:217], v[216:217], v[50:51]
  v_exp_f32 v210, v210
  v_exp_f32 v211, v211
  ds_read_b128 a[196:199], v134 offset:2048
  v_exp_f32 v212, v212
  v_exp_f32 v213, v213
  v_exp_f32 v214, v214
  v_exp_f32 v215, v215
  v_exp_f32 v216, v216
  v_exp_f32 v217, v217
  ds_read_b128 a[200:203], v135 offset:0
  v_pk_add_f32 v[210:211], v[210:211], 1.0 op_sel_hi:[1,0]
  v_pk_add_f32 v[212:213], v[212:213], 1.0 op_sel_hi:[1,0]
  v_pk_add_f32 v[214:215], v[214:215], 1.0 op_sel_hi:[1,0]
  v_pk_add_f32 v[216:217], v[216:217], 1.0 op_sel_hi:[1,0]
  v_rcp_f32 v210, v210
  ds_read_b128 a[204:207], v135 offset:2048
  v_rcp_f32 v211, v211
  v_rcp_f32 v212, v212
  v_rcp_f32 v213, v213
  v_rcp_f32 v214, v214
  v_rcp_f32 v215, v215
  ds_read_b128 a[208:211], v134 offset:4096
  v_rcp_f32 v216, v216
  v_rcp_f32 v217, v217
  v_pk_mul_f32 v[210:211], v[210:211], v[44:45]
  v_pk_mul_f32 v[212:213], v[212:213], v[46:47]
  v_pk_mul_f32 v[214:215], v[214:215], v[48:49]
  ds_read_b128 a[212:215], v134 offset:6144
  v_pk_mul_f32 v[216:217], v[216:217], v[50:51]
  v_cvt_pk_bf16_f32 v44, v210, v211
  v_cvt_pk_bf16_f32 v46, v214, v215
  v_cvt_pk_bf16_f32 v45, v212, v213
  v_cvt_pk_bf16_f32 v47, v216, v217
  v_permlane16_swap_b32 v44, v46
  s_nop 0
  v_permlane16_swap_b32 v45, v47
  s_add_u32 s69, s80, 0
  buffer_store_dwordx4 v[44:47], v163, s[36:39], s69 offen sc1
  s_waitcnt lgkmcnt(5)
  v_mfma_f32_16x16x32_bf16 v[4:7], a[0:3], a[192:195], 0
  ds_read_b128 a[216:219], v135 offset:4096
  v_pk_fma_f32 v[194:195], v[180:181], v[20:21], v[224:225] op_sel:[1,0,0] op_sel_hi:[1,1,1]
  v_pk_fma_f32 v[196:197], v[180:181], v[22:23], v[226:227] op_sel:[1,0,0] op_sel_hi:[1,1,1]
  v_pk_fma_f32 v[198:199], v[182:183], v[20:21], v[224:225] op_sel:[1,0,0] op_sel_hi:[1,1,1]
  v_pk_fma_f32 v[200:201], v[182:183], v[22:23], v[226:227] op_sel:[1,0,0] op_sel_hi:[1,1,1]
  v_pk_fma_f32 v[12:13], v[180:181], v[12:13], v[194:195] op_sel:[0,0,0] op_sel_hi:[0,1,1]
  v_pk_fma_f32 v[14:15], v[180:181], v[14:15], v[196:197] op_sel:[0,0,0] op_sel_hi:[0,1,1]
  v_pk_fma_f32 v[16:17], v[182:183], v[16:17], v[198:199] op_sel:[0,0,0] op_sel_hi:[0,1,1]
  v_pk_fma_f32 v[18:19], v[182:183], v[18:19], v[200:201] op_sel:[0,0,0] op_sel_hi:[0,1,1]
  v_pk_mul_f32 v[194:195], v[12:13], v[12:13]
  v_pk_mul_f32 v[196:197], v[14:15], v[14:15]
  v_pk_mul_f32 v[198:199], v[16:17], v[16:17]
  v_pk_mul_f32 v[200:201], v[18:19], v[18:19]
  v_pk_fma_f32 v[194:195], v[194:195], v[236:237], v[236:237] op_sel:[0,0,1] op_sel_hi:[1,0,1]
  v_pk_fma_f32 v[196:197], v[196:197], v[236:237], v[236:237] op_sel:[0,0,1] op_sel_hi:[1,0,1]
  v_pk_fma_f32 v[198:199], v[198:199], v[236:237], v[236:237] op_sel:[0,0,1] op_sel_hi:[1,0,1]
  v_pk_fma_f32 v[200:201], v[200:201], v[236:237], v[236:237] op_sel:[0,0,1] op_sel_hi:[1,0,1]
  v_pk_mul_f32 v[194:195], v[194:195], v[12:13]
  v_pk_mul_f32 v[196:197], v[196:197], v[14:15]
  v_pk_mul_f32 v[198:199], v[198:199], v[16:17]
  v_pk_mul_f32 v[200:201], v[200:201], v[18:19]
  v_mfma_f32_16x16x32_bf16 v[24:27], a[4:7], a[192:195], 0
  v_exp_f32 v194, v194
  v_mfma_f32_16x16x32_bf16 v[44:47], a[8:11], a[192:195], 0
  ds_read_b128 a[220:223], v135 offset:6144
  v_mov_b32 v64, -1
  s_waitcnt lgkmcnt(6)
  v_mfma_f32_16x16x32_bf16 v[8:11], a[0:3], a[196:199], 0
  s_waitcnt lgkmcnt(4)
  v_exp_f32 v195, v195
  v_mfma_f32_16x16x32_bf16 v[28:31], a[4:7], a[196:199], 0
  s_add_u32 s11, s23, 98304
  s_sub_u32 s5, s11, 458752
  s_min_u32 s11, s11, s5
  v_mfma_f32_16x16x32_bf16 v[48:51], a[8:11], a[196:199], 0
  s_lshr_b32 s77, s23, 5
  v_mov_b32 v244, v20
  v_mov_b32 v65, -1
  v_mfma_f32_16x16x32_bf16 v[4:7], a[12:15], a[200:203], v[4:7]
  s_add_u32 m0, s10, 114688
  v_exp_f32 v196, v196
  v_mfma_f32_16x16x32_bf16 v[24:27], a[16:19], a[200:203], v[24:27]
  s_add_u32 s59, s77, 0
  buffer_load_dword v168, v166, s[16:19], s22 offen sc1
  v_mfma_f32_16x16x32_bf16 v[44:47], a[20:23], a[200:203], v[44:47]
  ds_read_b128 a[192:195], v134 offset:8192
  v_mov_b32 v66, -1
  v_mfma_f32_16x16x32_bf16 v[8:11], a[12:15], a[204:207], v[8:11]
  s_waitcnt lgkmcnt(3)
  buffer_load_dwordx4 v158, s[48:51], s11 offen offset:0 lds
  v_mfma_f32_16x16x32_bf16 v[28:31], a[16:19], a[204:207], v[28:31]
  s_sub_u32 s60, s59, 14336
  v_exp_f32 v197, v197
  v_mfma_f32_16x16x32_bf16 v[48:51], a[20:23], a[204:207], v[48:51]
  s_min_u32 s59, s59, s60
  buffer_load_dwordx4 v159, s[48:51], s11 offen offset:1024 lds
  v_mfma_f32_16x16x32_bf16 v[4:7], a[24:27], a[208:211], v[4:7]
  s_add_u32 s60, s77, 1024
  buffer_load_dwordx4 v160, s[48:51], s11 offen offset:2048 lds
  v_mfma_f32_16x16x32_bf16 v[24:27], a[28:31], a[208:211], v[24:27]
  ds_read_b128 a[196:199], v134 offset:10240
  v_mov_b32 v67, -1
  v_mfma_f32_16x16x32_bf16 v[44:47], a[32:35], a[208:211], v[44:47]
  s_sub_u32 s61, s60, 14336
  buffer_load_dwordx4 v161, s[48:51], s11 offen offset:3072 lds
  v_mfma_f32_16x16x32_bf16 v[8:11], a[24:27], a[212:215], v[8:11]
  s_waitcnt lgkmcnt(2)
  v_exp_f32 v198, v198
  v_mfma_f32_16x16x32_bf16 v[28:31], a[28:31], a[212:215], v[28:31]
  s_waitcnt vmcnt(20)
  ds_read_b64_tr_b16 v[80:81], v150 offset:0
  v_mfma_f32_16x16x32_bf16 v[48:51], a[32:35], a[212:215], v[48:51]
  ds_read_b64_tr_b16 v[82:83], v150 offset:512
  s_add_u32 s69, s78, 245760
  buffer_store_dwordx4 v[64:67], v163, s[36:39], s69 offen sc1
  v_mov_b32 v245, v21
  v_mfma_f32_16x16x32_bf16 v[4:7], a[36:39], a[216:219], v[4:7]
  s_min_u32 s60, s60, s61
  v_exp_f32 v199, v199
  v_pk_fma_f32 v[202:203], v[180:181], v[40:41], v[228:229] op_sel:[1,0,0] op_sel_hi:[1,1,1]
  v_pk_fma_f32 v[204:205], v[180:181], v[42:43], v[230:231] op_sel:[1,0,0] op_sel_hi:[1,1,1]
  v_pk_fma_f32 v[206:207], v[182:183], v[40:41], v[228:229] op_sel:[1,0,0] op_sel_hi:[1,1,1]
  v_pk_fma_f32 v[208:209], v[182:183], v[42:43], v[230:231] op_sel:[1,0,0] op_sel_hi:[1,1,1]
  v_pk_fma_f32 v[32:33], v[180:181], v[32:33], v[202:203] op_sel:[0,0,0] op_sel_hi:[0,1,1]
  v_pk_fma_f32 v[34:35], v[180:181], v[34:35], v[204:205] op_sel:[0,0,0] op_sel_hi:[0,1,1]
  v_pk_fma_f32 v[36:37], v[182:183], v[36:37], v[206:207] op_sel:[0,0,0] op_sel_hi:[0,1,1]
  v_pk_fma_f32 v[38:39], v[182:183], v[38:39], v[208:209] op_sel:[0,0,0] op_sel_hi:[0,1,1]
  v_pk_mul_f32 v[202:203], v[32:33], v[32:33]
  v_pk_mul_f32 v[204:205], v[34:35], v[34:35]
  v_pk_mul_f32 v[206:207], v[36:37], v[36:37]
  v_pk_mul_f32 v[208:209], v[38:39], v[38:39]
  v_pk_fma_f32 v[202:203], v[202:203], v[236:237], v[236:237] op_sel:[0,0,1] op_sel_hi:[1,0,1]
  v_pk_fma_f32 v[204:205], v[204:205], v[236:237], v[236:237] op_sel:[0,0,1] op_sel_hi:[1,0,1]
  v_pk_fma_f32 v[206:207], v[206:207], v[236:237], v[236:237] op_sel:[0,0,1] op_sel_hi:[1,0,1]
  v_pk_fma_f32 v[208:209], v[208:209], v[236:237], v[236:237] op_sel:[0,0,1] op_sel_hi:[1,0,1]
  v_pk_mul_f32 v[202:203], v[202:203], v[32:33]
  v_pk_mul_f32 v[204:205], v[204:205], v[34:35]
  v_pk_mul_f32 v[206:207], v[206:207], v[36:37]
  v_pk_mul_f32 v[208:209], v[208:209], v[38:39]
  v_mfma_f32_16x16x32_bf16 v[24:27], a[40:43], a[216:219], v[24:27]
  s_add_u32 s61, s77, 2048
  ds_read_b128 a[200:203], v135 offset:8192
  ds_read_b64_tr_b16 v[84:85], v151 offset:0
  v_mfma_f32_16x16x32_bf16 v[44:47], a[44:47], a[216:219], v[44:47]
  s_sub_u32 s62, s61, 14336
  ds_read_b64_tr_b16 v[86:87], v151 offset:512
  ds_read_b128 a[204:207], v135 offset:10240
  v_exp_f32 v200, v200
  v_mfma_f32_16x16x32_bf16 v[8:11], a[36:39], a[220:223], v[8:11]
  s_waitcnt lgkmcnt(6)
  ds_read_b64_tr_b16 v[88:89], v152 offset:0
  v_mfma_f32_16x16x32_bf16 v[28:31], a[40:43], a[220:223], v[28:31]
  s_min_u32 s61, s61, s62
  ds_read_b64_tr_b16 v[90:91], v152 offset:512
  v_exp_f32 v201, v201
  v_mfma_f32_16x16x32_bf16 v[48:51], a[44:47], a[220:223], v[48:51]
  ds_read_b64_tr_b16 v[92:93], v153 offset:0
  v_mov_b32 v246, v22
  v_mfma_f32_16x16x32_bf16 v[4:7], a[48:51], a[192:195], v[4:7]
  ds_read_b64_tr_b16 v[94:95], v153 offset:512
  v_add_f32 v194, 1.0, v194
  v_mfma_f32_16x16x32_bf16 v[24:27], a[52:55], a[192:195], v[24:27]
  s_waitcnt lgkmcnt(0)
  ds_read_b128 a[208:211], v134 offset:12288
  s_add_u32 s69, s79, 245760
  buffer_store_dwordx4 v[64:67], v163, s[36:39], s69 offen sc1
  v_exp_f32 v202, v202
  v_add_f32 v195, 1.0, v195
  s_add_u32 s11, s23, 131072
  s_sub_u32 s5, s11, 458752
  s_min_u32 s11, s11, s5
  v_mfma_f32_16x16x32_bf16 v[44:47], a[56:59], a[192:195], v[44:47]
  s_add_u32 m0, s10, 65536
  ds_read_b128 a[212:215], v134 offset:14336
  v_add_f32 v196, 1.0, v196
  v_add_f32 v197, 1.0, v197
  v_mfma_f32_16x16x32_bf16 v[8:11], a[48:51], a[196:199], v[8:11]
  s_add_u32 s62, s77, 3072
  buffer_load_dwordx4 v158, s[48:51], s11 offen offset:0 lds
  v_exp_f32 v203, v203
  v_mfma_f32_16x16x32_bf16 v[28:31], a[52:55], a[196:199], v[28:31]
  buffer_load_dwordx4 v159, s[48:51], s11 offen offset:1024 lds
  v_add_f32 v198, 1.0, v198
  v_add_f32 v199, 1.0, v199
  v_mfma_f32_16x16x32_bf16 v[48:51], a[56:59], a[196:199], v[48:51]
  s_sub_u32 s63, s62, 14336
  buffer_load_dwordx4 v160, s[48:51], s11 offen offset:2048 lds
  v_exp_f32 v204, v204
  v_mfma_f32_16x16x32_bf16 v[4:7], a[60:63], a[200:203], v[4:7]
  s_min_u32 s62, s62, s63
  buffer_load_dwordx4 v161, s[48:51], s11 offen offset:3072 lds
  v_mov_b32 v247, v23
  v_add_f32 v200, 1.0, v200
  v_mfma_f32_16x16x32_bf16 v[24:27], a[64:67], a[200:203], v[24:27]
  ds_read_b128 a[216:219], v135 offset:12288
  ds_read_b64_tr_b16 v[96:97], v150 offset:16384
  v_add_f32 v201, 1.0, v201
  v_exp_f32 v205, v205
  v_mfma_f32_16x16x32_bf16 v[44:47], a[68:71], a[200:203], v[44:47]
  s_add_u32 s63, s77, 4096
  ds_read_b128 a[220:223], v135 offset:14336
  v_rcp_f32 v194, v194
  v_mfma_f32_16x16x32_bf16 v[8:11], a[60:63], a[204:207], v[8:11]
  s_waitcnt lgkmcnt(3)
  ds_read_b64_tr_b16 v[98:99], v150 offset:16896
  s_add_u32 s69, s80, 245760
  buffer_store_dwordx4 v[64:67], v163, s[36:39], s69 offen sc1
  v_mfma_f32_16x16x32_bf16 v[28:31], a[64:67], a[204:207], v[28:31]
  s_sub_u32 s64, s63, 14336
  ds_read_b64_tr_b16 v[100:101], v151 offset:16384
  v_exp_f32 v206, v206
  v_mfma_f32_16x16x32_bf16 v[48:51], a[68:71], a[204:207], v[48:51]
  s_min_u32 s63, s63, s64
  ds_read_b64_tr_b16 v[102:103], v151 offset:16896
  v_rcp_f32 v195, v195
  v_mfma_f32_16x16x32_bf16 v[4:7], a[72:75], a[208:211], v[4:7]
  s_add_u32 s64, s77, 5120
  ds_read_b64_tr_b16 v[104:105], v152 offset:16384
  v_exp_f32 v207, v207
  v_pk_fma_f32 v[210:211], v[180:181], v[60:61], v[232:233] op_sel:[1,0,0] op_sel_hi:[1,1,1]
  v_pk_fma_f32 v[212:213], v[180:181], v[62:63], v[234:235] op_sel:[1,0,0] op_sel_hi:[1,1,1]
  v_pk_fma_f32 v[214:215], v[182:183], v[60:61], v[232:233] op_sel:[1,0,0] op_sel_hi:[1,1,1]
  v_pk_fma_f32 v[216:217], v[182:183], v[62:63], v[234:235] op_sel:[1,0,0] op_sel_hi:[1,1,1]
  v_pk_fma_f32 v[52:53], v[180:181], v[52:53], v[210:211] op_sel:[0,0,0] op_sel_hi:[0,1,1]
  v_pk_fma_f32 v[54:55], v[180:181], v[54:55], v[212:213] op_sel:[0,0,0] op_sel_hi:[0,1,1]
  v_pk_fma_f32 v[56:57], v[182:183], v[56:57], v[214:215] op_sel:[0,0,0] op_sel_hi:[0,1,1]
  v_pk_fma_f32 v[58:59], v[182:183], v[58:59], v[216:217] op_sel:[0,0,0] op_sel_hi:[0,1,1]
  v_pk_mul_f32 v[210:211], v[52:53], v[52:53]
  v_pk_mul_f32 v[212:213], v[54:55], v[54:55]
  v_pk_mul_f32 v[214:215], v[56:57], v[56:57]
  v_pk_mul_f32 v[216:217], v[58:59], v[58:59]
  v_pk_fma_f32 v[210:211], v[210:211], v[236:237], v[236:237] op_sel:[0,0,1] op_sel_hi:[1,0,1]
  v_pk_fma_f32 v[212:213], v[212:213], v[236:237], v[236:237] op_sel:[0,0,1] op_sel_hi:[1,0,1]
  v_pk_fma_f32 v[214:215], v[214:215], v[236:237], v[236:237] op_sel:[0,0,1] op_sel_hi:[1,0,1]
  v_pk_fma_f32 v[216:217], v[216:217], v[236:237], v[236:237] op_sel:[0,0,1] op_sel_hi:[1,0,1]
  v_pk_mul_f32 v[210:211], v[210:211], v[52:53]
  v_pk_mul_f32 v[212:213], v[212:213], v[54:55]
  v_pk_mul_f32 v[214:215], v[214:215], v[56:57]
  v_pk_mul_f32 v[216:217], v[216:217], v[58:59]
  v_mfma_f32_16x16x32_bf16 v[24:27], a[76:79], a[208:211], v[24:27]
  ds_read_b128 a[192:195], v134 offset:16384
  ds_read_b64_tr_b16 v[106:107], v152 offset:16896
  v_mov_b32 v248, v40
  v_rcp_f32 v196, v196
  s_add_u32 s4, s24, 1
  s_waitcnt vmcnt(11)
  v_subrev_u32 v1, s4, v168
  v_cmp_lt_u32 vcc, 4, v1
  s_nop 0
  s_and_b32 s4, vcc_lo, 0xffff
  s_cbranch_scc1 L_stf
L_stfok:
  v_mfma_f32_16x16x32_bf16 v[44:47], a[80:83], a[208:211], v[44:47]
  s_sub_u32 s65, s64, 14336
  ds_read_b64_tr_b16 v[108:109], v153 offset:16384
  ds_read_b128 a[196:199], v134 offset:18432
  v_exp_f32 v208, v208
  v_mfma_f32_16x16x32_bf16 v[8:11], a[72:75], a[212:215], v[8:11]
  s_waitcnt lgkmcnt(8)
  ds_read_b64_tr_b16 v[110:111], v153 offset:16896
  v_rcp_f32 v197, v197
  v_mfma_f32_16x16x32_bf16 v[28:31], a[76:79], a[212:215], v[28:31]
  s_waitcnt lgkmcnt(0)
  v_exp_f32 v209, v209
  s_add_u32 s11, s23, 163840
  s_sub_u32 s5, s11, 458752
  s_min_u32 s11, s11, s5
  v_mfma_f32_16x16x32_bf16 v[48:51], a[80:83], a[212:215], v[48:51]
  s_add_u32 m0, s10, 81920
  s_add_u32 s69, s78, 368640
  buffer_store_dwordx4 v[64:67], v163, s[36:39], s69 offen sc1
  v_rcp_f32 v198, v198
  v_mfma_f32_16x16x32_bf16 v[4:7], a[84:87], a[216:219], v[4:7]
  s_min_u32 s64, s64, s65
  buffer_load_dwordx4 v158, s[48:51], s11 offen offset:0 lds
  v_add_f32 v202, 1.0, v202
  v_mov_b32 v249, v41
  v_mfma_f32_16x16x32_bf16 v[24:27], a[88:91], a[216:219], v[24:27]
  ds_read_b128 a[200:203], v135 offset:16384
  buffer_load_dwordx4 v159, s[48:51], s11 offen offset:1024 lds
  v_add_f32 v203, 1.0, v203
  v_exp_f32 v210, v210
  v_rcp_f32 v199, v199
  v_lshlrev_b32 v172, 1, v166
  v_mfma_f32_16x16x32_bf16 v[44:47], a[92:95], a[216:219], v[44:47]
  s_add_u32 s65, s77, 6144
  buffer_load_dwordx4 v160, s[48:51], s11 offen offset:2048 lds
  ds_read_b128 a[204:207], v135 offset:18432
  buffer_load_dwordx2 v[186:187], v172, s[16:19], s57 offen offset:0 sc1
  v_add_f32 v204, 1.0, v204
  v_add_f32 v205, 1.0, v205
  v_mfma_f32_16x16x32_bf16 v[8:11], a[84:87], a[220:223], v[8:11]
  s_sub_u32 s66, s65, 14336
  buffer_load_dwordx4 v161, s[48:51], s11 offen offset:3072 lds
  v_exp_f32 v211, v211
  v_rcp_f32 v200, v200
  v_mfma_f32_16x16x32_bf16 v[28:31], a[88:91], a[220:223], v[28:31]
  ds_read_b64_tr_b16 a[240:241], v150 offset:32768
  buffer_load_dwordx2 v[188:189], v172, s[16:19], s57 offen offset:128 sc1
  v_add_f32 v206, 1.0, v206
  v_add_f32 v207, 1.0, v207
  v_mfma_f32_16x16x32_bf16 v[48:51], a[92:95], a[220:223], v[48:51]
  s_min_u32 s65, s65, s66
  buffer_load_dwordx2 v[190:191], v172, s[16:19], s57 offen offset:256 sc1
  v_exp_f32 v212, v212
  v_rcp_f32 v201, v201
  v_pk_mul_f32 v[194:195], v[194:195], v[12:13]
  v_pk_mul_f32 v[196:197], v[196:197], v[14:15]
  v_pk_mul_f32 v[198:199], v[198:199], v[16:17]
  v_pk_mul_f32 v[200:201], v[200:201], v[18:19]
  v_mfma_f32_16x16x32_bf16 v[4:7], a[96:99], a[192:195], v[4:7]
  ds_read_b64_tr_b16 a[242:243], v150 offset:33280
  v_mov_b32 v250, v42
  v_mfma_f32_16x16x32_bf16 v[24:27], a[100:103], a[192:195], v[24:27]
  ds_read_b128 a[208:211], v134 offset:20480
  ds_read_b64_tr_b16 a[244:245], v151 offset:32768
  s_add_u32 s69, s79, 368640
  buffer_store_dwordx4 v[64:67], v163, s[36:39], s69 offen sc1
  buffer_load_dwordx2 v[192:193], v172, s[16:19], s57 offen offset:384 sc1
  v_add_f32 v208, 1.0, v208
  v_exp_f32 v213, v213
  v_mfma_f32_16x16x32_bf16 v[44:47], a[104:107], a[192:195], v[44:47]
  s_add_u32 s66, s77, 7168
  ds_read_b64_tr_b16 a[246:247], v151 offset:33280
  ds_read_b128 a[212:215], v134 offset:22528
  v_add_f32 v209, 1.0, v209
  v_cvt_pk_bf16_f32 v12, v194, v195
  v_mfma_f32_16x16x32_bf16 v[8:11], a[96:99], a[196:199], v[8:11]
  s_sub_u32 s67, s66, 14336
  ds_read_b64_tr_b16 a[248:249], v152 offset:32768
  s_mov_b64 exec, 1
  ds_add_rtn_u32 v3, v170, v170 offset:8
  s_mov_b64 exec, -1
  v_rcp_f32 v202, v202
  v_cvt_pk_bf16_f32 v14, v198, v199
  v_mfma_f32_16x16x32_bf16 v[28:31], a[100:103], a[196:199], v[28:31]
  s_waitcnt lgkmcnt(8)
  ds_read_b64_tr_b16 a[250:251], v152 offset:33280
  v_exp_f32 v214, v214
  v_cvt_pk_bf16_f32 v13, v196, v197
  v_mfma_f32_16x16x32_bf16 v[48:51], a[104:107], a[196:199], v[48:51]
  s_min_u32 s66, s66, s67
  ds_read_b64_tr_b16 a[252:253], v153 offset:32768
  v_rcp_f32 v203, v203
  v_cvt_pk_bf16_f32 v15, v200, v201
  v_mfma_f32_16x16x32_bf16 v[4:7], a[108:111], a[200:203], v[4:7]
  s_add_u32 s67, s77, 8192
  ds_read_b64_tr_b16 a[254:255], v153 offset:33280
  v_exp_f32 v215, v215
  v_permlane16_swap_b32 v12, v14
  v_mfma_f32_16x16x32_bf16 v[24:27], a[112:115], a[200:203], v[24:27]
  s_waitcnt lgkmcnt(0)
  ds_read_b128 a[216:219], v135 offset:20480
  v_mov_b32 v251, v43
  v_rcp_f32 v204, v204
  s_add_u32 s5, s24, 2
  v_readfirstlane_b32 s4, v3
  v_mov_b32 v3, s5
  s_cmp_eq_u32 s4, 422400
  s_cselect_b32 s4, s20, 1073741824
  s_nop 1
  buffer_store_dword v3, v169, s[16:19], s4 offen sc1
  s_add_u32 s11, s23, 229376
  s_sub_u32 s5, s11, 458752
  s_min_u32 s11, s11, s5
  v_mfma_f32_16x16x32_bf16 v[44:47], a[116:119], a[200:203], v[44:47]
  s_add_u32 m0, s10, 98304
  ds_read_b128 a[220:223], v135 offset:22528
  v_exp_f32 v216, v216
  v_permlane16_swap_b32 v13, v15
  v_mfma_f32_16x16x32_bf16 v[8:11], a[108:111], a[204:207], v[8:11]
  s_sub_u32 s68, s67, 14336
  buffer_load_dwordx4 v158, s[48:51], s11 offen offset:0 lds
  s_add_u32 s69, s80, 368640
  buffer_store_dwordx4 v[64:67], v163, s[36:39], s69 offen sc1
  v_rcp_f32 v205, v205
  v_mfma_f32_16x16x32_bf16 v[28:31], a[112:115], a[204:207], v[28:31]
  buffer_load_dwordx4 v159, s[48:51], s11 offen offset:1024 lds
  v_exp_f32 v217, v217
  v_mfma_f32_16x16x32_bf16 v[48:51], a[116:119], a[204:207], v[48:51]
  s_add_u32 s69, s78, 122880
  buffer_store_dwordx4 v[12:15], v163, s[36:39], s69 offen sc1
  buffer_load_dwordx4 v160, s[48:51], s11 offen offset:2048 lds
  v_rcp_f32 v206, v206
  v_mfma_f32_16x16x32_bf16 v[4:7], a[120:123], a[208:211], v[4:7]
  s_min_u32 s67, s67, s68
  buffer_load_dwordx4 v161, s[48:51], s11 offen offset:3072 lds
  v_add_f32 v210, 1.0, v210
  s_add_u32 s68, s77, 9216
  v_mfma_f32_16x16x32_bf16 v[24:27], a[124:127], a[208:211], v[24:27]
  ds_read_b128 a[192:195], v134 offset:24576
  s_waitcnt vmcnt(24)
  ds_read_b64_tr_b16 a[224:225], v150 offset:49152
  v_mov_b32 v252, v60
  v_add_f32 v211, 1.0, v211
  v_rcp_f32 v207, v207
  v_mfma_f32_16x16x32_bf16 v[44:47], a[128:131], a[208:211], v[44:47]
  s_sub_u32 s70, s68, 14336
  ds_read_b128 a[196:199], v134 offset:26624
  v_add_f32 v212, 1.0, v212
  v_add_f32 v213, 1.0, v213
  v_mfma_f32_16x16x32_bf16 v[8:11], a[120:123], a[212:215], v[8:11]
  s_min_u32 s68, s68, s70
  ds_read_b64_tr_b16 a[226:227], v150 offset:49664
  v_mfma_f32_16x16x32_bf16 v[28:31], a[124:127], a[212:215], v[28:31]
  s_waitcnt lgkmcnt(4)
  ds_read_b64_tr_b16 a[228:229], v151 offset:49152
  v_rcp_f32 v208, v208
  v_mfma_f32_16x16x32_bf16 v[48:51], a[128:131], a[212:215], v[48:51]
  ds_read_b64_tr_b16 a[230:231], v151 offset:49664
  v_add_f32 v214, 1.0, v214
  v_mfma_f32_16x16x32_bf16 v[4:7], a[132:135], a[216:219], v[4:7]
  ds_read_b64_tr_b16 a[232:233], v152 offset:49152
  v_add_f32 v215, 1.0, v215
  v_rcp_f32 v209, v209
  v_pk_mul_f32 v[202:203], v[202:203], v[32:33]
  v_pk_mul_f32 v[204:205], v[204:205], v[34:35]
  v_pk_mul_f32 v[206:207], v[206:207], v[36:37]
  v_pk_mul_f32 v[208:209], v[208:209], v[38:39]
  v_mfma_f32_16x16x32_bf16 v[24:27], a[136:139], a[216:219], v[24:27]
  s_add_u32 s70, s77, 10240
  ds_read_b128 a[200:203], v135 offset:24576
  ds_read_b64_tr_b16 a[234:235], v152 offset:49664
  v_add_f32 v216, 1.0, v216
  v_mfma_f32_16x16x32_bf16 v[44:47], a[140:143], a[216:219], v[44:47]
  s_sub_u32 s71, s70, 14336
  ds_read_b64_tr_b16 a[236:237], v153 offset:49152
  ds_read_b128 a[204:207], v135 offset:26624
  v_mov_b32 v253, v61
  v_add_f32 v217, 1.0, v217
  v_cvt_pk_bf16_f32 v32, v202, v203
  v_mfma_f32_16x16x32_bf16 v[8:11], a[132:135], a[220:223], v[8:11]
  s_min_u32 s70, s70, s71
  ds_read_b64_tr_b16 a[238:239], v153 offset:49664
  v_rcp_f32 v210, v210
  v_cvt_pk_bf16_f32 v34, v206, v207
  v_mfma_f32_16x16x32_bf16 v[28:31], a[136:139], a[220:223], v[28:31]
  s_waitcnt lgkmcnt(0)
  v_cvt_pk_bf16_f32 v33, v204, v205
  s_add_u32 s11, s23, 262144
  s_sub_u32 s5, s11, 458752
  s_min_u32 s11, s11, s5
  v_mfma_f32_16x16x32_bf16 v[48:51], a[140:143], a[220:223], v[48:51]
  s_add_u32 s71, s77, 11264
  v_rcp_f32 v211, v211
  v_mfma_f32_16x16x32_bf16 v[4:7], a[144:147], a[192:195], v[4:7]
  s_add_u32 m0, s10, 114688
  s_nop 0
  buffer_load_dwordx4 v158, s[48:51], s11 offen offset:0 lds
  v_cvt_pk_bf16_f32 v35, v208, v209
  s_sub_u32 s72, s71, 14336
  v_mfma_f32_16x16x32_bf16 v[24:27], a[148:151], a[192:195], v[24:27]
  ds_read_b128 a[208:211], v134 offset:28672
  buffer_load_dwordx4 v159, s[48:51], s11 offen offset:1024 lds
  v_mov_b32 v254, v62
  v_permlane16_swap_b32 v32, v34
  v_rcp_f32 v212, v212
  v_mfma_f32_16x16x32_bf16 v[44:47], a[152:155], a[192:195], v[44:47]
  s_min_u32 s71, s71, s72
  buffer_load_dwordx4 v160, s[48:51], s11 offen offset:2048 lds
  ds_read_b128 a[212:215], v134 offset:30720
  v_mfma_f32_16x16x32_bf16 v[8:11], a[144:147], a[196:199], v[8:11]
  buffer_load_dwordx4 v161, s[48:51], s11 offen offset:3072 lds
  ds_read_b128 a[216:219], v135 offset:28672
  ds_read_b128 a[220:223], v135 offset:30720
  v_permlane16_swap_b32 v33, v35
  v_rcp_f32 v213, v213
  v_mfma_f32_16x16x32_bf16 v[28:31], a[148:151], a[196:199], v[28:31]
  s_add_u32 s72, s77, 12288
  v_rcp_f32 v214, v214
  v_mfma_f32_16x16x32_bf16 v[48:51], a[152:155], a[196:199], v[48:51]
  s_waitcnt lgkmcnt(0)
  s_barrier
  s_sub_u32 s73, s72, 14336
  s_add_u32 s69, s79, 122880
  buffer_store_dwordx4 v[32:35], v163, s[36:39], s69 offen sc1
  v_mfma_f32_16x16x32_bf16 v[4:7], a[156:159], a[200:203], v[4:7]
  s_min_u32 s72, s72, s73
  v_rcp_f32 v215, v215
  v_mfma_f32_16x16x32_bf16 v[24:27], a[160:163], a[200:203], v[24:27]
  s_add_u32 s73, s77, 13312
  v_mov_b32 v255, v63
  s_sub_u32 s77, s73, 14336
  v_mfma_f32_16x16x32_bf16 v[44:47], a[164:167], a[200:203], v[44:47]
  s_min_u32 s73, s73, s77
  v_rcp_f32 v216, v216
  v_mfma_f32_16x16x32_bf16 v[8:11], a[156:159], a[204:207], v[8:11]
  v_rcp_f32 v217, v217
  v_pk_mul_f32 v[210:211], v[210:211], v[52:53]
  v_pk_mul_f32 v[212:213], v[212:213], v[54:55]
  v_pk_mul_f32 v[214:215], v[214:215], v[56:57]
  v_pk_mul_f32 v[216:217], v[216:217], v[58:59]
  v_mfma_f32_16x16x32_bf16 v[28:31], a[160:163], a[204:207], v[28:31]
  ds_read_b128 a[192:195], v134 offset:32768
  v_cvt_pk_bf16_f32 v52, v210, v211
  v_mfma_f32_16x16x32_bf16 v[48:51], a[164:167], a[204:207], v[48:51]
  s_add_u32 s11, s23, 294912
  s_sub_u32 s5, s11, 458752
  s_min_u32 s11, s11, s5
  v_mfma_f32_16x16x32_bf16 v[4:7], a[168:171], a[208:211], v[4:7]
  s_add_u32 m0, s10, 0
  ds_read_b128 a[196:199], v134 offset:34816
  v_mfma_f32_16x16x32_bf16 v[24:27], a[172:175], a[208:211], v[24:27]
  buffer_load_dwordx4 v158, s[48:51], s11 offen offset:0 lds
  v_mfma_f32_16x16x32_bf16 v[44:47], a[176:179], a[208:211], v[44:47]
  buffer_load_dwordx4 v159, s[48:51], s11 offen offset:1024 lds
  v_mfma_f32_16x16x32_bf16 v[8:11], a[168:171], a[212:215], v[8:11]
  v_cvt_pk_bf16_f32 v54, v214, v215
  v_cvt_pk_bf16_f32 v53, v212, v213
  v_mfma_f32_16x16x32_bf16 v[28:31], a[172:175], a[212:215], v[28:31]
  buffer_load_dwordx4 v160, s[48:51], s11 offen offset:2048 lds
  v_mfma_f32_16x16x32_bf16 v[48:51], a[176:179], a[212:215], v[48:51]
  buffer_load_dwordx4 v161, s[48:51], s11 offen offset:3072 lds
  v_mfma_f32_16x16x32_bf16 v[4:7], a[180:183], a[216:219], v[4:7]
  s_add_u32 s11, s23, 327680
  s_sub_u32 s5, s11, 458752
  s_min_u32 s11, s11, s5
  ds_read_b128 a[200:203], v135 offset:32768
  v_cvt_pk_bf16_f32 v55, v216, v217
  v_mfma_f32_16x16x32_bf16 v[24:27], a[184:187], a[216:219], v[24:27]
  s_add_u32 m0, s10, 16384
  v_permlane16_swap_b32 v52, v54
  v_mfma_f32_16x16x32_bf16 v[44:47], a[188:191], a[216:219], v[44:47]
  buffer_load_dwordx4 v158, s[48:51], s11 offen offset:0 lds
  ds_read_b128 a[204:207], v135 offset:34816
  v_mfma_f32_16x16x32_bf16 v[8:11], a[180:183], a[220:223], v[8:11]
  s_waitcnt lgkmcnt(2)
  buffer_load_dwordx4 v159, s[48:51], s11 offen offset:1024 lds
  v_permlane16_swap_b32 v53, v55
  v_mfma_f32_16x16x32_bf16 v[28:31], a[184:187], a[220:223], v[28:31]
  buffer_load_dwordx4 v160, s[48:51], s11 offen offset:2048 lds
  v_mfma_f32_16x16x32_bf16 v[48:51], a[188:191], a[220:223], v[48:51]
  s_add_u32 s69, s80, 122880
  buffer_store_dwordx4 v[52:55], v163, s[36:39], s69 offen sc1
  buffer_load_dwordx4 v161, s[48:51], s11 offen offset:3072 lds
  v_mfma_f32_16x16x32_bf16 v[12:15], a[0:3], a[192:195], 0
  ds_read_b128 a[208:211], v134 offset:36864
  s_waitcnt vmcnt(26)
  v_pk_fma_f32 v[194:195], v[186:187], v[244:245], v[224:225] op_sel:[1,0,0] op_sel_hi:[1,1,1]
  v_pk_fma_f32 v[196:197], v[186:187], v[246:247], v[226:227] op_sel:[1,0,0] op_sel_hi:[1,1,1]
  s_waitcnt vmcnt(24)
  v_pk_fma_f32 v[198:199], v[188:189], v[244:245], v[224:225] op_sel:[1,0,0] op_sel_hi:[1,1,1]
  v_pk_fma_f32 v[200:201], v[188:189], v[246:247], v[226:227] op_sel:[1,0,0] op_sel_hi:[1,1,1]
  v_pk_fma_f32 v[4:5], v[186:187], v[4:5], v[194:195] op_sel:[0,0,0] op_sel_hi:[0,1,1]
  v_pk_fma_f32 v[6:7], v[186:187], v[6:7], v[196:197] op_sel:[0,0,0] op_sel_hi:[0,1,1]
  v_pk_fma_f32 v[8:9], v[188:189], v[8:9], v[198:199] op_sel:[0,0,0] op_sel_hi:[0,1,1]
  v_pk_fma_f32 v[10:11], v[188:189], v[10:11], v[200:201] op_sel:[0,0,0] op_sel_hi:[0,1,1]
  v_pk_mul_f32 v[194:195], v[4:5], v[4:5]
  v_pk_mul_f32 v[196:197], v[6:7], v[6:7]
  v_pk_mul_f32 v[198:199], v[8:9], v[8:9]
  v_pk_mul_f32 v[200:201], v[10:11], v[10:11]
  v_pk_fma_f32 v[194:195], v[194:195], v[236:237], v[236:237] op_sel:[0,0,1] op_sel_hi:[1,0,1]
  v_pk_fma_f32 v[196:197], v[196:197], v[236:237], v[236:237] op_sel:[0,0,1] op_sel_hi:[1,0,1]
  v_pk_fma_f32 v[198:199], v[198:199], v[236:237], v[236:237] op_sel:[0,0,1] op_sel_hi:[1,0,1]
  v_pk_fma_f32 v[200:201], v[200:201], v[236:237], v[236:237] op_sel:[0,0,1] op_sel_hi:[1,0,1]
  v_pk_mul_f32 v[194:195], v[194:195], v[4:5]
  v_pk_mul_f32 v[196:197], v[196:197], v[6:7]
  v_pk_mul_f32 v[198:199], v[198:199], v[8:9]
  v_pk_mul_f32 v[200:201], v[200:201], v[10:11]
  v_mfma_f32_16x16x32_bf16 v[32:35], a[4:7], a[192:195], 0
  ds_read_b128 a[212:215], v134 offset:38912
  v_mfma_f32_16x16x32_bf16 v[52:55], a[8:11], a[192:195], 0
  ds_read_b128 a[216:219], v135 offset:36864
  v_mfma_f32_16x16x32_bf16 v[16:19], a[0:3], a[196:199], 0
  s_waitcnt lgkmcnt(3)
  v_exp_f32 v194, v194
  v_mfma_f32_16x16x32_bf16 v[36:39], a[4:7], a[196:199], 0
  v_exp_f32 v195, v195
  v_mfma_f32_16x16x32_bf16 v[56:59], a[8:11], a[196:199], 0
  ds_read_b128 a[220:223], v135 offset:38912
  v_lshlrev_b32 v174, 3, v164
  v_mfma_f32_16x16x32_bf16 v[12:15], a[12:15], a[200:203], v[12:15]
  s_mov_b32 s4, 0x078000ff
  s_mov_b32 s5, 0xf0001c00
  s_lshl_b32 s77, s26, 4
  s_lshr_b64 s[4:5], s[4:5], s77
  s_and_b32 s77, s4, 0xffff
  v_exp_f32 v196, v196
  v_mfma_f32_16x16x32_bf16 v[32:35], a[16:19], a[200:203], v[32:35]
  ds_read_b128 a[192:195], v134 offset:40960
  v_lshl_add_u32 v175, v165, 11, v174
  v_mfma_f32_16x16x32_bf16 v[52:55], a[20:23], a[200:203], v[52:55]
  v_exp_f32 v197, v197
  v_mfma_f32_16x16x32_bf16 v[16:19], a[12:15], a[204:207], v[16:19]
  s_waitcnt lgkmcnt(3)
  v_exp_f32 v198, v198
  v_mfma_f32_16x16x32_bf16 v[36:39], a[16:19], a[204:207], v[36:39]
  s_add_u32 s4, s8, 0
  buffer_load_dwordx2 v[176:177], v175, s[28:31], s4 offen
  v_mfma_f32_16x16x32_bf16 v[56:59], a[20:23], a[204:207], v[56:59]
  ds_read_b128 a[196:199], v134 offset:43008
  v_mfma_f32_16x16x32_bf16 v[12:15], a[24:27], a[208:211], v[12:15]
  v_exp_f32 v199, v199
  v_mfma_f32_16x16x32_bf16 v[32:35], a[28:31], a[208:211], v[32:35]
  s_add_u32 s4, s8, 65536
  buffer_load_dwordx2 v[178:179], v175, s[28:31], s4 offen
  v_mfma_f32_16x16x32_bf16 v[52:55], a[32:35], a[208:211], v[52:55]
  ds_read_b128 a[200:203], v135 offset:40960
  v_mfma_f32_16x16x32_bf16 v[16:19], a[24:27], a[212:215], v[16:19]
  s_waitcnt lgkmcnt(3)
  v_exp_f32 v200, v200
  v_mfma_f32_16x16x32_bf16 v[36:39], a[28:31], a[212:215], v[36:39]
  ds_read_b64_tr_b16 a[0:1], v150 offset:0
  v_mfma_f32_16x16x32_bf16 v[56:59], a[32:35], a[212:215], v[56:59]
  ds_read_b64_tr_b16 a[2:3], v150 offset:512
  v_mfma_f32_16x16x32_bf16 v[12:15], a[36:39], a[216:219], v[12:15]
  ds_read_b64_tr_b16 a[4:5], v151 offset:0
  v_pk_fma_f32 v[202:203], v[186:187], v[248:249], v[228:229] op_sel:[1,0,0] op_sel_hi:[1,1,1]
  v_pk_fma_f32 v[204:205], v[186:187], v[250:251], v[230:231] op_sel:[1,0,0] op_sel_hi:[1,1,1]
  v_pk_fma_f32 v[206:207], v[188:189], v[248:249], v[228:229] op_sel:[1,0,0] op_sel_hi:[1,1,1]
  v_pk_fma_f32 v[208:209], v[188:189], v[250:251], v[230:231] op_sel:[1,0,0] op_sel_hi:[1,1,1]
  v_pk_fma_f32 v[24:25], v[186:187], v[24:25], v[202:203] op_sel:[0,0,0] op_sel_hi:[0,1,1]
  v_pk_fma_f32 v[26:27], v[186:187], v[26:27], v[204:205] op_sel:[0,0,0] op_sel_hi:[0,1,1]
  v_pk_fma_f32 v[28:29], v[188:189], v[28:29], v[206:207] op_sel:[0,0,0] op_sel_hi:[0,1,1]
  v_pk_fma_f32 v[30:31], v[188:189], v[30:31], v[208:209] op_sel:[0,0,0] op_sel_hi:[0,1,1]
  v_pk_mul_f32 v[202:203], v[24:25], v[24:25]
  v_pk_mul_f32 v[204:205], v[26:27], v[26:27]
  v_pk_mul_f32 v[206:207], v[28:29], v[28:29]
  v_pk_mul_f32 v[208:209], v[30:31], v[30:31]
  v_pk_fma_f32 v[202:203], v[202:203], v[236:237], v[236:237] op_sel:[0,0,1] op_sel_hi:[1,0,1]
  v_pk_fma_f32 v[204:205], v[204:205], v[236:237], v[236:237] op_sel:[0,0,1] op_sel_hi:[1,0,1]
  v_pk_fma_f32 v[206:207], v[206:207], v[236:237], v[236:237] op_sel:[0,0,1] op_sel_hi:[1,0,1]
  v_pk_fma_f32 v[208:209], v[208:209], v[236:237], v[236:237] op_sel:[0,0,1] op_sel_hi:[1,0,1]
  v_pk_mul_f32 v[202:203], v[202:203], v[24:25]
  v_pk_mul_f32 v[204:205], v[204:205], v[26:27]
  v_pk_mul_f32 v[206:207], v[206:207], v[28:29]
  v_pk_mul_f32 v[208:209], v[208:209], v[30:31]
  v_mfma_f32_16x16x32_bf16 v[32:35], a[40:43], a[216:219], v[32:35]
  v_exp_f32 v201, v201
  v_mfma_f32_16x16x32_bf16 v[52:55], a[44:47], a[216:219], v[52:55]
  ds_read_b128 a[204:207], v135 offset:43008
  v_add_f32 v194, 1.0, v194
  v_mfma_f32_16x16x32_bf16 v[16:19], a[36:39], a[220:223], v[16:19]
  s_waitcnt lgkmcnt(5)
  ds_read_b64_tr_b16 a[6:7], v151 offset:512
  v_mfma_f32_16x16x32_bf16 v[36:39], a[40:43], a[220:223], v[36:39]
  ds_read_b64_tr_b16 a[8:9], v152 offset:0
  v_add_f32 v195, 1.0, v195
  v_mfma_f32_16x16x32_bf16 v[56:59], a[44:47], a[220:223], v[56:59]
  s_add_u32 s4, s8, 131072
  buffer_load_dwordx2 v[180:181], v175, s[28:31], s4 offen
  v_mfma_f32_16x16x32_bf16 v[12:15], a[48:51], a[192:195], v[12:15]
  ds_read_b64_tr_b16 a[10:11], v152 offset:512
  v_add_f32 v196, 1.0, v196
  v_mfma_f32_16x16x32_bf16 v[32:35], a[52:55], a[192:195], v[32:35]
  ds_read_b128 a[208:211], v134 offset:45056
  ds_read_b64_tr_b16 a[12:13], v153 offset:0
  s_waitcnt vmcnt(4)
  s_mov_b64 exec, 1
  ds_add_rtn_u32 v3, v170, v170 offset:12
  s_mov_b64 exec, -1
  v_add_f32 v197, 1.0, v197
  v_exp_f32 v202, v202
  v_mfma_f32_16x16x32_bf16 v[52:55], a[56:59], a[192:195], v[52:55]
  ds_read_b64_tr_b16 a[14:15], v153 offset:512
  ds_read_b128 a[212:215], v134 offset:47104
  s_waitcnt lgkmcnt(1)
  v_mfma_f32_16x16x32_bf16 v[16:19], a[48:51], a[196:199], v[16:19]
  v_exp_f32 v203, v203
  v_add_f32 v198, 1.0, v198
  s_add_u32 s11, s23, 360448
  s_sub_u32 s5, s11, 458752
  s_min_u32 s11, s11, s5
  v_mfma_f32_16x16x32_bf16 v[36:39], a[52:55], a[196:199], v[36:39]
  s_add_u32 s4, s8, 196608
  buffer_load_dwordx2 v[182:183], v175, s[28:31], s4 offen
  buffer_load_dword v168, v166, s[16:19], s21 offen sc1
  v_add_f32 v199, 1.0, v199
  v_mfma_f32_16x16x32_bf16 v[56:59], a[56:59], a[196:199], v[56:59]
  s_add_u32 m0, s10, 65536
  s_nop 0
  buffer_load_dwordx4 v158, s[48:51], s11 offen offset:0 lds
  v_exp_f32 v204, v204
  v_add_f32 v200, 1.0, v200
  s_add_u32 s5, s24, 3
  v_readfirstlane_b32 s4, v3
  v_mov_b32 v3, s5
  s_cmp_eq_u32 s4, 422400
  s_cselect_b32 s4, s20, 1073741824
  s_nop 1
  buffer_store_dword v3, v169, s[16:19], s4 offen sc1
  v_mfma_f32_16x16x32_bf16 v[12:15], a[60:63], a[200:203], v[12:15]
  ds_read_b128 a[216:219], v135 offset:45056
  buffer_load_dwordx4 v159, s[48:51], s11 offen offset:1024 lds
  v_add_f32 v201, 1.0, v201
  v_mfma_f32_16x16x32_bf16 v[32:35], a[64:67], a[200:203], v[32:35]
  buffer_load_dwordx4 v160, s[48:51], s11 offen offset:2048 lds
  v_exp_f32 v205, v205
  v_mfma_f32_16x16x32_bf16 v[52:55], a[68:71], a[200:203], v[52:55]
  buffer_load_dwordx2 v[184:185], v174, s[12:15], s9 offen
  buffer_load_dwordx4 v161, s[48:51], s11 offen offset:3072 lds
  ds_read_b128 a[220:223], v135 offset:47104
  v_rcp_f32 v194, v194
  v_mfma_f32_16x16x32_bf16 v[16:19], a[60:63], a[204:207], v[16:19]
  s_waitcnt lgkmcnt(2)
  ds_read_b64_tr_b16 a[16:17], v150 offset:16384
  v_exp_f32 v206, v206
  v_mfma_f32_16x16x32_bf16 v[36:39], a[64:67], a[204:207], v[36:39]
  v_rcp_f32 v195, v195
  v_mfma_f32_16x16x32_bf16 v[56:59], a[68:71], a[204:207], v[56:59]
  ds_read_b64_tr_b16 a[18:19], v150 offset:16896
  v_exp_f32 v207, v207
  v_mfma_f32_16x16x32_bf16 v[12:15], a[72:75], a[208:211], v[12:15]
  ds_read_b64_tr_b16 a[20:21], v151 offset:16384
  v_rcp_f32 v196, v196
  v_pk_fma_f32 v[210:211], v[186:187], v[252:253], v[232:233] op_sel:[1,0,0] op_sel_hi:[1,1,1]
  v_pk_fma_f32 v[212:213], v[186:187], v[254:255], v[234:235] op_sel:[1,0,0] op_sel_hi:[1,1,1]
  v_pk_fma_f32 v[214:215], v[188:189], v[252:253], v[232:233] op_sel:[1,0,0] op_sel_hi:[1,1,1]
  v_pk_fma_f32 v[216:217], v[188:189], v[254:255], v[234:235] op_sel:[1,0,0] op_sel_hi:[1,1,1]
  v_pk_fma_f32 v[44:45], v[186:187], v[44:45], v[210:211] op_sel:[0,0,0] op_sel_hi:[0,1,1]
  v_pk_fma_f32 v[46:47], v[186:187], v[46:47], v[212:213] op_sel:[0,0,0] op_sel_hi:[0,1,1]
  v_pk_fma_f32 v[48:49], v[188:189], v[48:49], v[214:215] op_sel:[0,0,0] op_sel_hi:[0,1,1]
  v_pk_fma_f32 v[50:51], v[188:189], v[50:51], v[216:217] op_sel:[0,0,0] op_sel_hi:[0,1,1]
  v_pk_mul_f32 v[210:211], v[44:45], v[44:45]
  v_pk_mul_f32 v[212:213], v[46:47], v[46:47]
  v_pk_mul_f32 v[214:215], v[48:49], v[48:49]
  v_pk_mul_f32 v[216:217], v[50:51], v[50:51]
  v_pk_fma_f32 v[210:211], v[210:211], v[236:237], v[236:237] op_sel:[0,0,1] op_sel_hi:[1,0,1]
  v_pk_fma_f32 v[212:213], v[212:213], v[236:237], v[236:237] op_sel:[0,0,1] op_sel_hi:[1,0,1]
  v_pk_fma_f32 v[214:215], v[214:215], v[236:237], v[236:237] op_sel:[0,0,1] op_sel_hi:[1,0,1]
  v_pk_fma_f32 v[216:217], v[216:217], v[236:237], v[236:237] op_sel:[0,0,1] op_sel_hi:[1,0,1]
  v_pk_mul_f32 v[210:211], v[210:211], v[44:45]
  v_pk_mul_f32 v[212:213], v[212:213], v[46:47]
  v_pk_mul_f32 v[214:215], v[214:215], v[48:49]
  v_pk_mul_f32 v[216:217], v[216:217], v[50:51]
  v_mfma_f32_16x16x32_bf16 v[32:35], a[76:79], a[208:211], v[32:35]
  ds_read_b128 a[192:195], v134 offset:49152
  ds_read_b64_tr_b16 a[22:23], v151 offset:16896
  v_exp_f32 v208, v208
  v_mfma_f32_16x16x32_bf16 v[52:55], a[80:83], a[208:211], v[52:55]
  ds_read_b64_tr_b16 a[24:25], v152 offset:16384
  ds_read_b128 a[196:199], v134 offset:51200
  v_rcp_f32 v197, v197
  v_mfma_f32_16x16x32_bf16 v[16:19], a[72:75], a[212:215], v[16:19]
  s_waitcnt lgkmcnt(7)
  ds_read_b64_tr_b16 a[26:27], v152 offset:16896
  v_exp_f32 v209, v209
  v_mfma_f32_16x16x32_bf16 v[36:39], a[76:79], a[212:215], v[36:39]
  ds_read_b64_tr_b16 a[28:29], v153 offset:16384
  v_rcp_f32 v198, v198
  v_mfma_f32_16x16x32_bf16 v[56:59], a[80:83], a[212:215], v[56:59]
  ds_read_b64_tr_b16 a[30:31], v153 offset:16896
  v_add_f32 v202, 1.0, v202
  v_mfma_f32_16x16x32_bf16 v[12:15], a[84:87], a[216:219], v[12:15]
  s_waitcnt lgkmcnt(0)
  v_rcp_f32 v199, v199
  s_add_u32 s11, s23, 393216
  s_sub_u32 s5, s11, 458752
  s_min_u32 s11, s11, s5
  v_mfma_f32_16x16x32_bf16 v[32:35], a[88:91], a[216:219], v[32:35]
  ds_read_b128 a[200:203], v135 offset:49152
  v_add_f32 v203, 1.0, v203
  v_exp_f32 v210, v210
  v_mfma_f32_16x16x32_bf16 v[52:55], a[92:95], a[216:219], v[52:55]
  s_add_u32 m0, s10, 81920
  s_nop 0
  buffer_load_dwordx4 v158, s[48:51], s11 offen offset:0 lds
  ds_read_b128 a[204:207], v135 offset:51200
  v_add_f32 v204, 1.0, v204
  v_add_f32 v205, 1.0, v205
  v_rcp_f32 v200, v200
  v_mfma_f32_16x16x32_bf16 v[16:19], a[84:87], a[220:223], v[16:19]
  buffer_load_dwordx4 v159, s[48:51], s11 offen offset:1024 lds
  v_exp_f32 v211, v211
  v_mfma_f32_16x16x32_bf16 v[36:39], a[88:91], a[220:223], v[36:39]
  buffer_load_dwordx4 v160, s[48:51], s11 offen offset:2048 lds
  v_add_f32 v206, 1.0, v206
  v_add_f32 v207, 1.0, v207
  v_rcp_f32 v201, v201
  v_pk_mul_f32 v[194:195], v[194:195], v[4:5]
  v_pk_mul_f32 v[196:197], v[196:197], v[6:7]
  v_pk_mul_f32 v[198:199], v[198:199], v[8:9]
  v_pk_mul_f32 v[200:201], v[200:201], v[10:11]
  v_mfma_f32_16x16x32_bf16 v[56:59], a[92:95], a[220:223], v[56:59]
  buffer_load_dwordx4 v161, s[48:51], s11 offen offset:3072 lds
  v_exp_f32 v212, v212
  v_mfma_f32_16x16x32_bf16 v[12:15], a[96:99], a[192:195], v[12:15]
  ds_read_b64_tr_b16 a[32:33], v154 offset:16384
  v_add_f32 v208, 1.0, v208
  v_cvt_pk_bf16_f32 v4, v194, v195
  v_mfma_f32_16x16x32_bf16 v[32:35], a[100:103], a[192:195], v[32:35]
  ds_read_b128 a[208:211], v134 offset:53248
  v_add_f32 v209, 1.0, v209
  v_exp_f32 v213, v213
  v_cvt_pk_bf16_f32 v6, v198, v199
  v_mfma_f32_16x16x32_bf16 v[52:55], a[104:107], a[192:195], v[52:55]
  ds_read_b64_tr_b16 a[34:35], v154 offset:16896
  ds_read_b128 a[212:215], v134 offset:55296
  v_rcp_f32 v202, v202
  v_min_u32 v4, -2, v4
  v_mfma_f32_16x16x32_bf16 v[16:19], a[96:99], a[196:199], v[16:19]
  ds_read_b64_tr_b16 a[36:37], v155 offset:16384
  v_min_u32 v6, -2, v6
  v_exp_f32 v214, v214
  v_mfma_f32_16x16x32_bf16 v[36:39], a[100:103], a[196:199], v[36:39]
  s_waitcnt lgkmcnt(5)
  ds_read_b64_tr_b16 a[38:39], v155 offset:16896
  v_rcp_f32 v203, v203
  v_cvt_pk_bf16_f32 v5, v196, v197
  v_mfma_f32_16x16x32_bf16 v[56:59], a[104:107], a[196:199], v[56:59]
  ds_read_b64_tr_b16 a[40:41], v156 offset:16384
  v_cvt_pk_bf16_f32 v7, v200, v201
  v_exp_f32 v215, v215
  v_mfma_f32_16x16x32_bf16 v[12:15], a[108:111], a[200:203], v[12:15]
  ds_read_b64_tr_b16 a[42:43], v156 offset:16896
  v_rcp_f32 v204, v204
  v_mfma_f32_16x16x32_bf16 v[32:35], a[112:115], a[200:203], v[32:35]
  ds_read_b128 a[216:219], v135 offset:53248
  ds_read_b64_tr_b16 a[44:45], v157 offset:16384
  v_permlane16_swap_b32 v4, v6
  v_exp_f32 v216, v216
  v_mfma_f32_16x16x32_bf16 v[52:55], a[116:119], a[200:203], v[52:55]
  ds_read_b64_tr_b16 a[46:47], v157 offset:16896
  ds_read_b128 a[220:223], v135 offset:55296
  v_rcp_f32 v205, v205
  v_mfma_f32_16x16x32_bf16 v[16:19], a[108:111], a[204:207], v[16:19]
  s_waitcnt lgkmcnt(1)
  v_permlane16_swap_b32 v5, v7
  s_add_u32 s11, s23, 425984
  s_sub_u32 s5, s11, 458752
  s_min_u32 s11, s11, s5
  v_mfma_f32_16x16x32_bf16 v[36:39], a[112:115], a[204:207], v[36:39]
  v_exp_f32 v217, v217
  v_rcp_f32 v206, v206
  s_add_u32 s4, s25, 2
  s_waitcnt vmcnt(10)
  v_subrev_u32 v1, s4, v168
  v_cmp_lt_u32 vcc, 3, v1
  s_nop 0
  s_and_b32 s4, vcc_lo, s77
  s_cbranch_scc1 L_c2f
L_c2fok:
  v_mfma_f32_16x16x32_bf16 v[56:59], a[116:119], a[204:207], v[56:59]
  s_add_u32 m0, s10, 147456
  s_add_u32 s69, s78, 245760
  buffer_store_dwordx4 v[4:7], v163, s[36:39], s69 offen sc1
  buffer_load_dwordx4 v158, s[48:51], s11 offen offset:0 lds
  v_mfma_f32_16x16x32_bf16 v[12:15], a[120:123], a[208:211], v[12:15]
  ds_read_b128 a[192:195], v134 offset:57344
  buffer_load_dwordx4 v159, s[48:51], s11 offen offset:1024 lds
  v_add_f32 v210, 1.0, v210
  v_rcp_f32 v207, v207
  v_mfma_f32_16x16x32_bf16 v[32:35], a[124:127], a[208:211], v[32:35]
  buffer_load_dwordx4 v160, s[48:51], s11 offen offset:2048 lds
  v_add_f32 v211, 1.0, v211
  v_add_f32 v212, 1.0, v212
  v_mfma_f32_16x16x32_bf16 v[52:55], a[128:131], a[208:211], v[52:55]
  buffer_load_dwordx4 v161, s[48:51], s11 offen offset:3072 lds
  ds_read_b128 a[196:199], v134 offset:59392
  v_rcp_f32 v208, v208
  v_mfma_f32_16x16x32_bf16 v[16:19], a[120:123], a[212:215], v[16:19]
  s_waitcnt lgkmcnt(2)
  v_add_f32 v213, 1.0, v213
  v_add_f32 v214, 1.0, v214
  v_mfma_f32_16x16x32_bf16 v[36:39], a[124:127], a[212:215], v[36:39]
  buffer_load_dwordx4 a[48:51], v162, s[16:19], 0 offen offset:0 sc1
  v_rcp_f32 v209, v209
  v_pk_mul_f32 v[202:203], v[202:203], v[24:25]
  v_pk_mul_f32 v[204:205], v[204:205], v[26:27]
  v_pk_mul_f32 v[206:207], v[206:207], v[28:29]
  v_pk_mul_f32 v[208:209], v[208:209], v[30:31]
  v_mfma_f32_16x16x32_bf16 v[56:59], a[128:131], a[212:215], v[56:59]
  v_add_f32 v215, 1.0, v215
  v_add_f32 v216, 1.0, v216
  v_mfma_f32_16x16x32_bf16 v[12:15], a[132:135], a[216:219], v[12:15]
  ds_read_b128 a[200:203], v135 offset:57344
  buffer_load_dwordx4 a[52:55], v162, s[16:19], s59 offen offset:1024 sc1
  v_cvt_pk_bf16_f32 v24, v202, v203
  v_mfma_f32_16x16x32_bf16 v[32:35], a[136:139], a[216:219], v[32:35]
  v_add_f32 v217, 1.0, v217
  v_cvt_pk_bf16_f32 v26, v206, v207
  v_mfma_f32_16x16x32_bf16 v[52:55], a[140:143], a[216:219], v[52:55]
  ds_read_b128 a[204:207], v135 offset:59392
  buffer_load_dwordx4 a[56:59], v162, s[16:19], s60 offen offset:1024 sc1
  v_rcp_f32 v210, v210
  v_mfma_f32_16x16x32_bf16 v[16:19], a[132:135], a[220:223], v[16:19]
  s_waitcnt lgkmcnt(2)
  v_min_u32 v24, -2, v24
  v_min_u32 v26, -2, v26
  v_mfma_f32_16x16x32_bf16 v[36:39], a[136:139], a[220:223], v[36:39]
  buffer_load_dwordx4 a[60:63], v162, s[16:19], s61 offen offset:1024 sc1
  v_rcp_f32 v211, v211
  v_mfma_f32_16x16x32_bf16 v[56:59], a[140:143], a[220:223], v[56:59]
  v_cvt_pk_bf16_f32 v25, v204, v205
  v_cvt_pk_bf16_f32 v27, v208, v209
  v_mfma_f32_16x16x32_bf16 v[12:15], a[144:147], a[192:195], v[12:15]
  buffer_load_dwordx4 a[64:67], v162, s[16:19], s62 offen offset:1024 sc1
  v_rcp_f32 v212, v212
  v_mfma_f32_16x16x32_bf16 v[32:35], a[148:151], a[192:195], v[32:35]
  ds_read_b128 a[208:211], v134 offset:61440
  v_permlane16_swap_b32 v24, v26
  v_mfma_f32_16x16x32_bf16 v[52:55], a[152:155], a[192:195], v[52:55]
  ds_read_b128 a[212:215], v134 offset:63488
  buffer_load_dwordx4 a[68:71], v162, s[16:19], s63 offen offset:1024 sc1
  v_rcp_f32 v213, v213
  v_mfma_f32_16x16x32_bf16 v[16:19], a[144:147], a[196:199], v[16:19]
  s_waitcnt lgkmcnt(2)
  v_permlane16_swap_b32 v25, v27
  v_mfma_f32_16x16x32_bf16 v[36:39], a[148:151], a[196:199], v[36:39]
  buffer_load_dwordx4 a[72:75], v162, s[16:19], s64 offen offset:1024 sc1
  v_rcp_f32 v214, v214
  v_mfma_f32_16x16x32_bf16 v[56:59], a[152:155], a[196:199], v[56:59]
  s_add_u32 s69, s79, 245760
  buffer_store_dwordx4 v[24:27], v163, s[36:39], s69 offen sc1
  v_mfma_f32_16x16x32_bf16 v[12:15], a[156:159], a[200:203], v[12:15]
  buffer_load_dwordx4 a[76:79], v162, s[16:19], s65 offen offset:1024 sc1
  v_rcp_f32 v215, v215
  v_mfma_f32_16x16x32_bf16 v[32:35], a[160:163], a[200:203], v[32:35]
  ds_read_b128 a[216:219], v135 offset:61440
  v_mfma_f32_16x16x32_bf16 v[52:55], a[164:167], a[200:203], v[52:55]
  ds_read_b128 a[220:223], v135 offset:63488
  buffer_load_dwordx4 a[80:83], v162, s[16:19], s66 offen offset:1024 sc1
  v_rcp_f32 v216, v216
  v_mfma_f32_16x16x32_bf16 v[16:19], a[156:159], a[204:207], v[16:19]
  s_waitcnt lgkmcnt(2)
  buffer_load_dword v168, v166, s[16:19], s21 offen sc1
  v_rcp_f32 v217, v217
  v_pk_mul_f32 v[210:211], v[210:211], v[44:45]
  v_pk_mul_f32 v[212:213], v[212:213], v[46:47]
  v_pk_mul_f32 v[214:215], v[214:215], v[48:49]
  v_pk_mul_f32 v[216:217], v[216:217], v[50:51]
  v_mfma_f32_16x16x32_bf16 v[36:39], a[160:163], a[204:207], v[36:39]
  buffer_load_dwordx4 a[84:87], v162, s[16:19], s67 offen offset:1024 sc1
  v_mfma_f32_16x16x32_bf16 v[56:59], a[164:167], a[204:207], v[56:59]
  v_cvt_pk_bf16_f32 v44, v210, v211
  v_cvt_pk_bf16_f32 v46, v214, v215
  v_mfma_f32_16x16x32_bf16 v[12:15], a[168:171], a[208:211], v[12:15]
  buffer_load_dwordx4 a[88:91], v162, s[16:19], s68 offen offset:1024 sc1
  v_mfma_f32_16x16x32_bf16 v[32:35], a[172:175], a[208:211], v[32:35]
  v_min_u32 v44, -2, v44
  v_min_u32 v46, -2, v46
  v_mfma_f32_16x16x32_bf16 v[52:55], a[176:179], a[208:211], v[52:55]
  buffer_load_dwordx4 a[92:95], v162, s[16:19], s70 offen offset:1024 sc1
  v_mfma_f32_16x16x32_bf16 v[16:19], a[168:171], a[212:215], v[16:19]
  s_waitcnt lgkmcnt(0)
  v_cvt_pk_bf16_f32 v45, v212, v213
  v_cvt_pk_bf16_f32 v47, v216, v217
  v_mfma_f32_16x16x32_bf16 v[36:39], a[172:175], a[212:215], v[36:39]
  buffer_load_dwordx4 a[96:99], v162, s[16:19], s71 offen offset:1024 sc1
  v_mfma_f32_16x16x32_bf16 v[56:59], a[176:179], a[212:215], v[56:59]
  v_permlane16_swap_b32 v44, v46
  v_mfma_f32_16x16x32_bf16 v[12:15], a[180:183], a[216:219], v[12:15]
  buffer_load_dwordx4 a[100:103], v162, s[16:19], s72 offen offset:1024 sc1
  v_mfma_f32_16x16x32_bf16 v[32:35], a[184:187], a[216:219], v[32:35]
  v_permlane16_swap_b32 v45, v47
  v_mfma_f32_16x16x32_bf16 v[52:55], a[188:191], a[216:219], v[52:55]
  buffer_load_dwordx4 a[104:107], v162, s[16:19], s73 offen offset:1024 sc1
  v_mfma_f32_16x16x32_bf16 v[16:19], a[180:183], a[220:223], v[16:19]
  s_add_u32 s69, s80, 245760
  buffer_store_dwordx4 v[44:47], v163, s[36:39], s69 offen sc1
  v_mfma_f32_16x16x32_bf16 v[36:39], a[184:187], a[220:223], v[36:39]
  v_add_u32 v162, 122880, v162
  v_mfma_f32_16x16x32_bf16 v[56:59], a[188:191], a[220:223], v[56:59]
  s_waitcnt vmcnt(17)
  v_mfma_f32_16x16x32_bf16 v[8:11], v[84:87], a[48:51], 0
  v_lshlrev_b32 v172, 16, v184
  v_and_b32 v173, 0xffff0000, v184
  v_pk_fma_f32 v[194:195], v[190:191], v[244:245], v[224:225] op_sel:[1,0,0] op_sel_hi:[1,1,1]
  v_pk_fma_f32 v[196:197], v[190:191], v[246:247], v[226:227] op_sel:[1,0,0] op_sel_hi:[1,1,1]
  v_pk_fma_f32 v[198:199], v[192:193], v[244:245], v[224:225] op_sel:[1,0,0] op_sel_hi:[1,1,1]
  v_pk_fma_f32 v[200:201], v[192:193], v[246:247], v[226:227] op_sel:[1,0,0] op_sel_hi:[1,1,1]
  v_pk_fma_f32 v[12:13], v[190:191], v[12:13], v[194:195] op_sel:[0,0,0] op_sel_hi:[0,1,1]
  v_pk_fma_f32 v[14:15], v[190:191], v[14:15], v[196:197] op_sel:[0,0,0] op_sel_hi:[0,1,1]
  v_pk_fma_f32 v[16:17], v[192:193], v[16:17], v[198:199] op_sel:[0,0,0] op_sel_hi:[0,1,1]
  v_pk_fma_f32 v[18:19], v[192:193], v[18:19], v[200:201] op_sel:[0,0,0] op_sel_hi:[0,1,1]
  v_pk_mul_f32 v[194:195], v[12:13], v[12:13]
  v_pk_mul_f32 v[196:197], v[14:15], v[14:15]
  v_pk_mul_f32 v[198:199], v[16:17], v[16:17]
  v_pk_mul_f32 v[200:201], v[18:19], v[18:19]
  v_pk_fma_f32 v[194:195], v[194:195], v[236:237], v[236:237] op_sel:[0,0,1] op_sel_hi:[1,0,1]
  v_pk_fma_f32 v[196:197], v[196:197], v[236:237], v[236:237] op_sel:[0,0,1] op_sel_hi:[1,0,1]
  v_pk_fma_f32 v[198:199], v[198:199], v[236:237], v[236:237] op_sel:[0,0,1] op_sel_hi:[1,0,1]
  v_pk_fma_f32 v[200:201], v[200:201], v[236:237], v[236:237] op_sel:[0,0,1] op_sel_hi:[1,0,1]
  v_pk_mul_f32 v[194:195], v[194:195], v[12:13]
  v_pk_mul_f32 v[196:197], v[196:197], v[14:15]
  v_pk_mul_f32 v[198:199], v[198:199], v[16:17]
  v_pk_mul_f32 v[200:201], v[200:201], v[18:19]
  v_mfma_f32_16x16x32_bf16 v[24:27], v[88:91], a[48:51], 0
  v_exp_f32 v194, v194
  v_mfma_f32_16x16x32_bf16 v[28:31], v[92:95], a[48:51], 0
  v_exp_f32 v195, v195
  s_waitcnt vmcnt(16)
  v_mfma_f32_16x16x32_bf16 v[8:11], v[100:103], a[52:55], v[8:11]
  v_exp_f32 v196, v196
  s_add_u32 s4, s25, 3
  s_waitcnt vmcnt(7)
  v_subrev_u32 v1, s4, v168
  v_cmp_lt_u32 vcc, 2, v1
  s_nop 0
  s_and_b32 s4, vcc_lo, s77
  s_cbranch_scc1 L_c3f
L_c3fok:
  v_mfma_f32_16x16x32_bf16 v[24:27], v[104:107], a[52:55], v[24:27]
  v_exp_f32 v197, v197
  v_mfma_f32_16x16x32_bf16 v[28:31], v[108:111], a[52:55], v[28:31]
  v_lshlrev_b32 v174, 16, v185
  v_and_b32 v175, 0xffff0000, v185
  v_exp_f32 v198, v198
  v_mfma_f32_16x16x32_bf16 v[8:11], v[116:119], a[56:59], v[8:11]
  v_exp_f32 v199, v199
  v_pk_fma_f32 v[202:203], v[190:191], v[248:249], v[228:229] op_sel:[1,0,0] op_sel_hi:[1,1,1]
  v_pk_fma_f32 v[204:205], v[190:191], v[250:251], v[230:231] op_sel:[1,0,0] op_sel_hi:[1,1,1]
  v_pk_fma_f32 v[206:207], v[192:193], v[248:249], v[228:229] op_sel:[1,0,0] op_sel_hi:[1,1,1]
  v_pk_fma_f32 v[208:209], v[192:193], v[250:251], v[230:231] op_sel:[1,0,0] op_sel_hi:[1,1,1]
  v_pk_fma_f32 v[32:33], v[190:191], v[32:33], v[202:203] op_sel:[0,0,0] op_sel_hi:[0,1,1]
  v_pk_fma_f32 v[34:35], v[190:191], v[34:35], v[204:205] op_sel:[0,0,0] op_sel_hi:[0,1,1]
  v_pk_fma_f32 v[36:37], v[192:193], v[36:37], v[206:207] op_sel:[0,0,0] op_sel_hi:[0,1,1]
  v_pk_fma_f32 v[38:39], v[192:193], v[38:39], v[208:209] op_sel:[0,0,0] op_sel_hi:[0,1,1]
  v_pk_mul_f32 v[202:203], v[32:33], v[32:33]
  v_pk_mul_f32 v[204:205], v[34:35], v[34:35]
  v_pk_mul_f32 v[206:207], v[36:37], v[36:37]
  v_pk_mul_f32 v[208:209], v[38:39], v[38:39]
  v_pk_fma_f32 v[202:203], v[202:203], v[236:237], v[236:237] op_sel:[0,0,1] op_sel_hi:[1,0,1]
  v_pk_fma_f32 v[204:205], v[204:205], v[236:237], v[236:237] op_sel:[0,0,1] op_sel_hi:[1,0,1]
  v_pk_fma_f32 v[206:207], v[206:207], v[236:237], v[236:237] op_sel:[0,0,1] op_sel_hi:[1,0,1]
  v_pk_fma_f32 v[208:209], v[208:209], v[236:237], v[236:237] op_sel:[0,0,1] op_sel_hi:[1,0,1]
  v_pk_mul_f32 v[202:203], v[202:203], v[32:33]
  v_pk_mul_f32 v[204:205], v[204:205], v[34:35]
  v_pk_mul_f32 v[206:207], v[206:207], v[36:37]
  v_pk_mul_f32 v[208:209], v[208:209], v[38:39]
  v_mfma_f32_16x16x32_bf16 v[24:27], v[120:123], a[56:59], v[24:27]
  v_lshlrev_b32 v4, 16, v176
  v_and_b32 v5, 0xffff0000, v176
  v_exp_f32 v200, v200
  v_exp_f32 v201, v201
  v_mfma_f32_16x16x32_bf16 v[28:31], v[124:127], a[56:59], v[28:31]
  v_lshlrev_b32 v6, 16, v177
  v_add_f32 v194, 1.0, v194
  v_mfma_f32_16x16x32_bf16 v[8:11], a[244:247], a[60:63], v[8:11]
  v_add_f32 v195, 1.0, v195
  v_and_b32 v7, 0xffff0000, v177
  v_exp_f32 v202, v202
  v_add_f32 v196, 1.0, v196
  v_add_f32 v197, 1.0, v197
  v_exp_f32 v203, v203
  v_mfma_f32_16x16x32_bf16 v[24:27], a[248:251], a[60:63], v[24:27]
  v_add_f32 v4, v4, v172
  v_add_f32 v198, 1.0, v198
  v_add_f32 v199, 1.0, v199
  v_exp_f32 v204, v204
  v_add_f32 v200, 1.0, v200
  v_add_f32 v5, v5, v173
  v_add_f32 v6, v6, v174
  v_add_f32 v7, v7, v175
  v_mfma_f32_16x16x32_bf16 v[28:31], a[252:255], a[60:63], v[28:31]
  buffer_load_dwordx4 v[64:67], v162, s[16:19], 0 offen offset:0 sc1
  v_add_f32 v201, 1.0, v201
  v_exp_f32 v205, v205
  v_rcp_f32 v194, v194
  v_exp_f32 v206, v206
  v_mfma_f32_16x16x32_bf16 v[4:7], v[80:83], a[48:51], v[4:7]
  v_rcp_f32 v195, v195
  v_exp_f32 v207, v207
  v_rcp_f32 v196, v196
  v_pk_fma_f32 v[210:211], v[190:191], v[252:253], v[232:233] op_sel:[1,0,0] op_sel_hi:[1,1,1]
  v_pk_fma_f32 v[212:213], v[190:191], v[254:255], v[234:235] op_sel:[1,0,0] op_sel_hi:[1,1,1]
  v_pk_fma_f32 v[214:215], v[192:193], v[252:253], v[232:233] op_sel:[1,0,0] op_sel_hi:[1,1,1]
  v_pk_fma_f32 v[216:217], v[192:193], v[254:255], v[234:235] op_sel:[1,0,0] op_sel_hi:[1,1,1]
  v_pk_fma_f32 v[52:53], v[190:191], v[52:53], v[210:211] op_sel:[0,0,0] op_sel_hi:[0,1,1]
  v_pk_fma_f32 v[54:55], v[190:191], v[54:55], v[212:213] op_sel:[0,0,0] op_sel_hi:[0,1,1]
  v_pk_fma_f32 v[56:57], v[192:193], v[56:57], v[214:215] op_sel:[0,0,0] op_sel_hi:[0,1,1]
  v_pk_fma_f32 v[58:59], v[192:193], v[58:59], v[216:217] op_sel:[0,0,0] op_sel_hi:[0,1,1]
  v_pk_mul_f32 v[210:211], v[52:53], v[52:53]
  v_pk_mul_f32 v[212:213], v[54:55], v[54:55]
  v_pk_mul_f32 v[214:215], v[56:57], v[56:57]
  v_pk_mul_f32 v[216:217], v[58:59], v[58:59]
  v_pk_fma_f32 v[210:211], v[210:211], v[236:237], v[236:237] op_sel:[0,0,1] op_sel_hi:[1,0,1]
  v_pk_fma_f32 v[212:213], v[212:213], v[236:237], v[236:237] op_sel:[0,0,1] op_sel_hi:[1,0,1]
  v_pk_fma_f32 v[214:215], v[214:215], v[236:237], v[236:237] op_sel:[0,0,1] op_sel_hi:[1,0,1]
  v_pk_fma_f32 v[216:217], v[216:217], v[236:237], v[236:237] op_sel:[0,0,1] op_sel_hi:[1,0,1]
  v_pk_mul_f32 v[210:211], v[210:211], v[52:53]
  v_pk_mul_f32 v[212:213], v[212:213], v[54:55]
  v_pk_mul_f32 v[214:215], v[214:215], v[56:57]
  v_pk_mul_f32 v[216:217], v[216:217], v[58:59]
  v_mfma_f32_16x16x32_bf16 v[4:7], v[96:99], a[52:55], v[4:7]
  buffer_load_dwordx4 v[68:71], v162, s[16:19], s59 offen offset:1024 sc1
  v_exp_f32 v208, v208
  v_rcp_f32 v197, v197
  v_mfma_f32_16x16x32_bf16 v[4:7], v[112:115], a[56:59], v[4:7]
  v_exp_f32 v209, v209
  v_rcp_f32 v198, v198
  v_add_f32 v202, 1.0, v202
  v_rcp_f32 v199, v199
  v_mfma_f32_16x16x32_bf16 v[4:7], a[240:243], a[60:63], v[4:7]
  v_add_f32 v203, 1.0, v203
  v_add_f32 v204, 1.0, v204
  v_exp_f32 v210, v210
  v_rcp_f32 v200, v200
  v_add_f32 v205, 1.0, v205
  v_exp_f32 v211, v211
  v_mfma_f32_16x16x32_bf16 v[4:7], a[224:227], a[64:67], v[4:7]
  buffer_load_dwordx4 v[72:75], v162, s[16:19], s60 offen offset:1024 sc1
  v_add_f32 v206, 1.0, v206
  v_add_f32 v207, 1.0, v207
  v_rcp_f32 v201, v201
  v_exp_f32 v212, v212
  v_add_f32 v208, 1.0, v208
  v_pk_mul_f32 v[194:195], v[194:195], v[12:13]
  v_pk_mul_f32 v[196:197], v[196:197], v[14:15]
  v_pk_mul_f32 v[198:199], v[198:199], v[16:17]
  v_pk_mul_f32 v[200:201], v[200:201], v[18:19]
  v_mfma_f32_16x16x32_bf16 v[8:11], a[228:231], a[64:67], v[8:11]
  v_cvt_pk_bf16_f32 v12, v194, v195
  v_add_f32 v209, 1.0, v209
  v_exp_f32 v213, v213
  v_cvt_pk_bf16_f32 v14, v198, v199
  v_rcp_f32 v202, v202
  v_min_u32 v12, -2, v12
  v_exp_f32 v214, v214
  v_mfma_f32_16x16x32_bf16 v[24:27], a[232:235], a[64:67], v[24:27]
  buffer_load_dwordx4 v[128:131], v162, s[16:19], s61 offen offset:1024 sc1
  v_min_u32 v14, -2, v14
  v_cvt_pk_bf16_f32 v13, v196, v197
  v_rcp_f32 v203, v203
  v_exp_f32 v215, v215
  v_cvt_pk_bf16_f32 v15, v200, v201
  v_rcp_f32 v204, v204
  v_mfma_f32_16x16x32_bf16 v[28:31], a[236:239], a[64:67], v[28:31]
  v_permlane16_swap_b32 v12, v14
  v_exp_f32 v216, v216
  v_rcp_f32 v205, v205
  v_permlane16_swap_b32 v13, v15
  v_mfma_f32_16x16x32_bf16 v[4:7], a[0:3], a[68:71], v[4:7]
  s_add_u32 s69, s78, 368640
  buffer_store_dwordx4 v[12:15], v163, s[36:39], s69 offen sc1
  v_exp_f32 v217, v217
  v_rcp_f32 v206, v206
  v_add_f32 v210, 1.0, v210
  v_mfma_f32_16x16x32_bf16 v[8:11], a[4:7], a[68:71], v[8:11]
  buffer_load_dwordx4 v[136:139], v162, s[16:19], s62 offen offset:1024 sc1
  v_rcp_f32 v207, v207
  v_add_f32 v211, 1.0, v211
  v_add_f32 v212, 1.0, v212
  v_rcp_f32 v208, v208
  v_add_f32 v213, 1.0, v213
  v_mfma_f32_16x16x32_bf16 v[24:27], a[8:11], a[68:71], v[24:27]
  v_add_f32 v214, 1.0, v214
  v_add_f32 v215, 1.0, v215
  v_rcp_f32 v209, v209
  v_add_f32 v216, 1.0, v216
  v_pk_mul_f32 v[202:203], v[202:203], v[32:33]
  v_pk_mul_f32 v[204:205], v[204:205], v[34:35]
  v_pk_mul_f32 v[206:207], v[206:207], v[36:37]
  v_pk_mul_f32 v[208:209], v[208:209], v[38:39]
  v_mfma_f32_16x16x32_bf16 v[28:31], a[12:15], a[68:71], v[28:31]
  buffer_load_dwordx4 v[20:23], v162, s[16:19], s63 offen offset:1024 sc1
  v_add_f32 v217, 1.0, v217
  v_cvt_pk_bf16_f32 v32, v202, v203
  v_rcp_f32 v210, v210
  v_cvt_pk_bf16_f32 v34, v206, v207
  v_min_u32 v32, -2, v32
  v_mfma_f32_16x16x32_bf16 v[4:7], a[16:19], a[72:75], v[4:7]
  v_min_u32 v34, -2, v34
  v_cvt_pk_bf16_f32 v33, v204, v205
  v_rcp_f32 v211, v211
  v_mfma_f32_16x16x32_bf16 v[8:11], a[20:23], a[72:75], v[8:11]
  v_cvt_pk_bf16_f32 v35, v208, v209
  v_rcp_f32 v212, v212
  v_permlane16_swap_b32 v32, v34
  v_rcp_f32 v213, v213
  v_mfma_f32_16x16x32_bf16 v[24:27], a[24:27], a[72:75], v[24:27]
  buffer_load_dwordx4 v[40:43], v162, s[16:19], s64 offen offset:1024 sc1
  v_permlane16_swap_b32 v33, v35
  v_rcp_f32 v214, v214
  v_mfma_f32_16x16x32_bf16 v[28:31], a[28:31], a[72:75], v[28:31]
  s_add_u32 s69, s79, 368640
  buffer_store_dwordx4 v[32:35], v163, s[36:39], s69 offen sc1
  v_rcp_f32 v215, v215
  v_rcp_f32 v216, v216
  v_mfma_f32_16x16x32_bf16 v[4:7], a[32:35], a[76:79], v[4:7]
  buffer_load_dwordx4 v[60:63], v162, s[16:19], s65 offen offset:1024 sc1
  v_rcp_f32 v217, v217
  v_pk_mul_f32 v[210:211], v[210:211], v[52:53]
  v_pk_mul_f32 v[212:213], v[212:213], v[54:55]
  v_pk_mul_f32 v[214:215], v[214:215], v[56:57]
  v_pk_mul_f32 v[216:217], v[216:217], v[58:59]
  v_mfma_f32_16x16x32_bf16 v[8:11], a[36:39], a[76:79], v[8:11]
  v_cvt_pk_bf16_f32 v52, v210, v211
  v_cvt_pk_bf16_f32 v54, v214, v215
  v_mfma_f32_16x16x32_bf16 v[24:27], a[40:43], a[76:79], v[24:27]
  v_min_u32 v52, -2, v52
  v_min_u32 v54, -2, v54
  v_cvt_pk_bf16_f32 v53, v212, v213
  v_mfma_f32_16x16x32_bf16 v[28:31], a[44:47], a[76:79], v[28:31]
  buffer_load_dwordx4 v[132:135], v162, s[16:19], s66 offen offset:1024 sc1
  v_cvt_pk_bf16_f32 v55, v216, v217
  v_permlane16_swap_b32 v52, v54
  s_nop 0
  v_permlane16_swap_b32 v53, v55
  s_add_u32 s69, s80, 368640
  buffer_store_dwordx4 v[52:55], v163, s[36:39], s69 offen sc1
  buffer_load_dwordx4 v[44:47], v162, s[16:19], s67 offen offset:1024 sc1
  buffer_load_dwordx4 v[48:51], v162, s[16:19], s68 offen offset:1024 sc1
  ds_read_b64_tr_b16 a[108:109], v150 offset:32768
  ds_read_b64_tr_b16 a[110:111], v150 offset:33280
  ds_read_b64_tr_b16 a[112:113], v151 offset:32768
  ds_read_b64_tr_b16 a[114:115], v151 offset:33280
  ds_read_b64_tr_b16 a[116:117], v152 offset:32768
  ds_read_b64_tr_b16 a[118:119], v152 offset:33280
  ds_read_b64_tr_b16 a[120:121], v153 offset:32768
  ds_read_b64_tr_b16 a[122:123], v153 offset:33280
  s_waitcnt lgkmcnt(6)
  v_mfma_f32_16x16x32_bf16 v[4:7], a[108:111], a[80:83], v[4:7]
  ds_read_b64_tr_b16 a[124:125], v150 offset:49152
  ds_read_b64_tr_b16 a[126:127], v150 offset:49664
  ds_read_b64_tr_b16 a[128:129], v151 offset:49152
  ds_read_b64_tr_b16 a[130:131], v151 offset:49664
  ds_read_b64_tr_b16 a[132:133], v152 offset:49152
  s_waitcnt lgkmcnt(9)
  v_mfma_f32_16x16x32_bf16 v[8:11], a[112:115], a[80:83], v[8:11]
  ds_read_b64_tr_b16 a[134:135], v152 offset:49664
  ds_read_b64_tr_b16 a[136:137], v153 offset:49152
  buffer_load_dwordx4 v[12:15], v162, s[16:19], s70 offen offset:1024 sc1
  s_waitcnt lgkmcnt(9)
  v_mfma_f32_16x16x32_bf16 v[24:27], a[116:119], a[80:83], v[24:27]
  ds_read_b64_tr_b16 a[138:139], v153 offset:49664
  ds_read_b64_tr_b16 a[140:141], v146 offset:0
  s_waitcnt lgkmcnt(9)
  v_mfma_f32_16x16x32_bf16 v[28:31], a[120:123], a[80:83], v[28:31]
  ds_read_b64_tr_b16 a[142:143], v146 offset:512
  ds_read_b64_tr_b16 a[144:145], v147 offset:0
  buffer_load_dwordx4 v[16:19], v162, s[16:19], s71 offen offset:1024 sc1
  s_waitcnt vmcnt(22) lgkmcnt(9)
  v_mfma_f32_16x16x32_bf16 v[4:7], a[124:127], a[84:87], v[4:7]
  ds_read_b64_tr_b16 a[146:147], v147 offset:512
  ds_read_b64_tr_b16 a[148:149], v148 offset:0
  s_waitcnt lgkmcnt(9)
  v_mfma_f32_16x16x32_bf16 v[8:11], a[128:131], a[84:87], v[8:11]
  ds_read_b64_tr_b16 a[150:151], v148 offset:512
  ds_read_b64_tr_b16 a[152:153], v149 offset:0
  buffer_load_dwordx4 v[32:35], v162, s[16:19], s72 offen offset:1024 sc1
  s_waitcnt lgkmcnt(9)
  v_mfma_f32_16x16x32_bf16 v[24:27], a[132:135], a[84:87], v[24:27]
  ds_read_b64_tr_b16 a[154:155], v149 offset:512
  ds_read_b64_tr_b16 a[156:157], v146 offset:16384
  s_waitcnt lgkmcnt(9)
  v_mfma_f32_16x16x32_bf16 v[28:31], a[136:139], a[84:87], v[28:31]
  ds_read_b64_tr_b16 a[158:159], v146 offset:16896
  ds_read_b64_tr_b16 a[160:161], v147 offset:16384
  buffer_load_dwordx4 v[36:39], v162, s[16:19], s73 offen offset:1024 sc1
  s_waitcnt vmcnt(23) lgkmcnt(9)
  v_mfma_f32_16x16x32_bf16 v[4:7], a[140:143], a[88:91], v[4:7]
  ds_read_b64_tr_b16 a[162:163], v147 offset:16896
  ds_read_b64_tr_b16 a[164:165], v148 offset:16384
  v_add_u32 v162, 122880, v162
  s_waitcnt lgkmcnt(9)
  v_mfma_f32_16x16x32_bf16 v[8:11], a[144:147], a[88:91], v[8:11]
  ds_read_b64_tr_b16 a[166:167], v148 offset:16896
  ds_read_b64_tr_b16 a[168:169], v149 offset:16384
  s_waitcnt lgkmcnt(9)
  v_mfma_f32_16x16x32_bf16 v[24:27], a[148:151], a[88:91], v[24:27]
  ds_read_b64_tr_b16 a[170:171], v149 offset:16896
  ds_read_b64_tr_b16 a[172:173], v150 offset:0
  s_waitcnt lgkmcnt(9)
  v_mfma_f32_16x16x32_bf16 v[28:31], a[152:155], a[88:91], v[28:31]
  ds_read_b64_tr_b16 a[174:175], v150 offset:512
  ds_read_b64_tr_b16 a[176:177], v151 offset:0
  s_waitcnt vmcnt(22) lgkmcnt(9)
  v_mfma_f32_16x16x32_bf16 v[4:7], a[156:159], a[92:95], v[4:7]
  ds_read_b64_tr_b16 a[178:179], v151 offset:512
  ds_read_b64_tr_b16 a[180:181], v152 offset:0
  s_waitcnt lgkmcnt(9)
  v_mfma_f32_16x16x32_bf16 v[8:11], a[160:163], a[92:95], v[8:11]
  ds_read_b64_tr_b16 a[182:183], v152 offset:512
  ds_read_b64_tr_b16 a[184:185], v153 offset:0
  s_waitcnt lgkmcnt(9)
  v_mfma_f32_16x16x32_bf16 v[24:27], a[164:167], a[92:95], v[24:27]
  ds_read_b64_tr_b16 a[186:187], v153 offset:512
  ds_read_b64_tr_b16 a[192:193], v150 offset:16384
  s_waitcnt lgkmcnt(9)
  v_mfma_f32_16x16x32_bf16 v[28:31], a[168:171], a[92:95], v[28:31]
  ds_read_b64_tr_b16 a[194:195], v150 offset:16896
  ds_read_b64_tr_b16 a[196:197], v151 offset:16384
  s_waitcnt vmcnt(21) lgkmcnt(9)
  v_mfma_f32_16x16x32_bf16 v[4:7], a[172:175], a[96:99], v[4:7]
  ds_read_b64_tr_b16 a[198:199], v151 offset:16896
  ds_read_b64_tr_b16 a[200:201], v152 offset:16384
  s_waitcnt lgkmcnt(9)
  v_mfma_f32_16x16x32_bf16 v[8:11], a[176:179], a[96:99], v[8:11]
  ds_read_b64_tr_b16 a[202:203], v152 offset:16896
  ds_read_b64_tr_b16 a[204:205], v153 offset:16384
  s_waitcnt lgkmcnt(9)
  v_mfma_f32_16x16x32_bf16 v[24:27], a[180:183], a[96:99], v[24:27]
  ds_read_b64_tr_b16 a[206:207], v153 offset:16896
  ds_read_b64_tr_b16 a[208:209], v154 offset:16384
  s_waitcnt lgkmcnt(9)
  v_mfma_f32_16x16x32_bf16 v[28:31], a[184:187], a[96:99], v[28:31]
  ds_read_b64_tr_b16 a[210:211], v154 offset:16896
  ds_read_b64_tr_b16 a[212:213], v155 offset:16384
  s_waitcnt vmcnt(20) lgkmcnt(9)
  v_mfma_f32_16x16x32_bf16 v[4:7], a[192:195], a[100:103], v[4:7]
  ds_read_b64_tr_b16 a[214:215], v155 offset:16896
  ds_read_b64_tr_b16 a[216:217], v156 offset:16384
  v_lshlrev_b32 v194, 16, v178
  s_waitcnt lgkmcnt(9)
  v_mfma_f32_16x16x32_bf16 v[8:11], a[196:199], a[100:103], v[8:11]
  ds_read_b64_tr_b16 a[218:219], v156 offset:16896
  ds_read_b64_tr_b16 a[220:221], v157 offset:16384
  v_and_b32 v195, 0xffff0000, v178
  s_waitcnt lgkmcnt(9)
  v_mfma_f32_16x16x32_bf16 v[24:27], a[200:203], a[100:103], v[24:27]
  ds_read_b64_tr_b16 a[222:223], v157 offset:16896
  v_lshlrev_b32 v196, 16, v179
  s_waitcnt lgkmcnt(8)
  v_mfma_f32_16x16x32_bf16 v[28:31], a[204:207], a[100:103], v[28:31]
  v_and_b32 v197, 0xffff0000, v179
  s_waitcnt vmcnt(19) lgkmcnt(6)
  v_mfma_f32_16x16x32_bf16 v[4:7], a[208:211], a[104:107], v[4:7]
  v_add_f32 v194, v194, v172
  s_waitcnt lgkmcnt(4)
  v_mfma_f32_16x16x32_bf16 v[8:11], a[212:215], a[104:107], v[8:11]
  s_waitcnt lgkmcnt(2)
  v_mfma_f32_16x16x32_bf16 v[24:27], a[216:219], a[104:107], v[24:27]
  v_add_f32 v195, v195, v173
  s_waitcnt lgkmcnt(0)
  v_mfma_f32_16x16x32_bf16 v[28:31], a[220:223], a[104:107], v[28:31]
  s_waitcnt vmcnt(17)
  v_mfma_f32_16x16x32_bf16 v[198:201], v[84:87], v[64:67], 0
  v_add_f32 v196, v196, v174
  v_mfma_f32_16x16x32_bf16 v[202:205], v[88:91], v[64:67], 0
  v_mfma_f32_16x16x32_bf16 v[206:209], v[92:95], v[64:67], 0
  v_add_f32 v197, v197, v175
  s_waitcnt vmcnt(16)
  v_mfma_f32_16x16x32_bf16 v[198:201], v[100:103], v[68:71], v[198:201]
  v_mfma_f32_16x16x32_bf16 v[202:205], v[104:107], v[68:71], v[202:205]
  v_mfma_f32_16x16x32_bf16 v[206:209], v[108:111], v[68:71], v[206:209]
  s_waitcnt vmcnt(15)
  v_mfma_f32_16x16x32_bf16 v[198:201], v[116:119], v[72:75], v[198:201]
  v_mfma_f32_16x16x32_bf16 v[202:205], v[120:123], v[72:75], v[202:205]
  v_mfma_f32_16x16x32_bf16 v[206:209], v[124:127], v[72:75], v[206:209]
  buffer_load_dwordx4 a[48:51], v162, s[16:19], 0 offen offset:0 sc1
  s_waitcnt vmcnt(15)
  v_mfma_f32_16x16x32_bf16 v[198:201], a[244:247], v[128:131], v[198:201]
  v_mfma_f32_16x16x32_bf16 v[202:205], a[248:251], v[128:131], v[202:205]
  buffer_load_dwordx4 a[52:55], v162, s[16:19], s59 offen offset:1024 sc1
  v_mfma_f32_16x16x32_bf16 v[206:209], a[252:255], v[128:131], v[206:209]
  v_lshlrev_b32 v140, 3, v164
  v_lshl_add_u32 v140, v165, 11, v140
  v_mfma_f32_16x16x32_bf16 v[194:197], v[80:83], v[64:67], v[194:197]
  v_lshlrev_b32 v144, 4, v2
  v_add_u32 v144, 65536, v144
  v_mfma_f32_16x16x32_bf16 v[194:197], v[96:99], v[68:71], v[194:197]
  buffer_load_dwordx4 a[56:59], v162, s[16:19], s60 offen offset:1024 sc1
  v_mfma_f32_16x16x32_bf16 v[194:197], v[112:115], v[72:75], v[194:197]
  v_add_u32 v141, s10, v144
  v_mfma_f32_16x16x32_bf16 v[194:197], a[240:243], v[128:131], v[194:197]
  buffer_load_dwordx4 a[60:63], v162, s[16:19], s61 offen offset:1024 sc1
  s_waitcnt vmcnt(16)
  v_mfma_f32_16x16x32_bf16 v[194:197], a[224:227], v[136:139], v[194:197]
  v_mfma_f32_16x16x32_bf16 v[198:201], a[228:231], v[136:139], v[198:201]
  v_mfma_f32_16x16x32_bf16 v[202:205], a[232:235], v[136:139], v[202:205]
  buffer_load_dwordx4 a[64:67], v162, s[16:19], s62 offen offset:1024 sc1
  v_mfma_f32_16x16x32_bf16 v[206:209], a[236:239], v[136:139], v[206:209]
  s_sub_u32 s4, s26, 1
  s_and_b32 s4, s4, 3
  s_lshl_b32 s4, s4, 12
  s_add_u32 s4, s4, 0
  v_add_u32 v142, s4, v144
  s_waitcnt vmcnt(16)
  v_mfma_f32_16x16x32_bf16 v[194:197], a[0:3], v[20:23], v[194:197]
  buffer_load_dwordx4 a[68:71], v162, s[16:19], s63 offen offset:1024 sc1
  v_mfma_f32_16x16x32_bf16 v[198:201], a[4:7], v[20:23], v[198:201]
  v_mfma_f32_16x16x32_bf16 v[202:205], a[8:11], v[20:23], v[202:205]
  v_mfma_f32_16x16x32_bf16 v[206:209], a[12:15], v[20:23], v[206:209]
  buffer_load_dwordx4 a[72:75], v162, s[16:19], s64 offen offset:1024 sc1
  s_waitcnt vmcnt(17)
  v_mfma_f32_16x16x32_bf16 v[194:197], a[16:19], v[40:43], v[194:197]
  s_sub_u32 s4, s26, 2
  s_and_b32 s4, s4, 3
  s_lshl_b32 s4, s4, 12
  s_add_u32 s4, s4, 1024
  v_add_u32 v143, s4, v144
  v_mfma_f32_16x16x32_bf16 v[198:201], a[20:23], v[40:43], v[198:201]
  buffer_load_dwordx4 a[76:79], v162, s[16:19], s65 offen offset:1024 sc1
  v_mfma_f32_16x16x32_bf16 v[202:205], a[24:27], v[40:43], v[202:205]
  v_mfma_f32_16x16x32_bf16 v[206:209], a[28:31], v[40:43], v[206:209]
  s_waitcnt vmcnt(16)
  v_mfma_f32_16x16x32_bf16 v[194:197], a[32:35], v[60:63], v[194:197]
  buffer_load_dwordx4 a[80:83], v162, s[16:19], s66 offen offset:1024 sc1
  v_mfma_f32_16x16x32_bf16 v[198:201], a[36:39], v[60:63], v[198:201]
  s_sub_u32 s4, s26, 3
  s_and_b32 s4, s4, 3
  s_lshl_b32 s4, s4, 12
  s_add_u32 s4, s4, 2048
  v_add_u32 v144, s4, v144
  v_mfma_f32_16x16x32_bf16 v[202:205], a[40:43], v[60:63], v[202:205]
  buffer_load_dwordx4 a[84:87], v162, s[16:19], s67 offen offset:1024 sc1
  v_mfma_f32_16x16x32_bf16 v[206:209], a[44:47], v[60:63], v[206:209]
  ds_write_b128 v141, v[8:11] offset:0
  s_waitcnt vmcnt(17)
  v_mfma_f32_16x16x32_bf16 v[194:197], a[108:111], v[132:135], v[194:197]
  ds_write_b128 v141, v[24:27] offset:1024
  v_mfma_f32_16x16x32_bf16 v[198:201], a[112:115], v[132:135], v[198:201]
  buffer_load_dwordx4 a[88:91], v162, s[16:19], s68 offen offset:1024 sc1
  v_mfma_f32_16x16x32_bf16 v[202:205], a[116:119], v[132:135], v[202:205]
  v_mfma_f32_16x16x32_bf16 v[206:209], a[120:123], v[132:135], v[206:209]
  buffer_load_dwordx4 a[92:95], v162, s[16:19], s70 offen offset:1024 sc1
  s_waitcnt vmcnt(17)
  v_mfma_f32_16x16x32_bf16 v[194:197], a[124:127], v[44:47], v[194:197]
  ds_write_b128 v141, v[28:31] offset:2048
  v_mfma_f32_16x16x32_bf16 v[198:201], a[128:131], v[44:47], v[198:201]
  v_mfma_f32_16x16x32_bf16 v[202:205], a[132:135], v[44:47], v[202:205]
  buffer_load_dwordx4 a[96:99], v162, s[16:19], s71 offen offset:1024 sc1
  v_mfma_f32_16x16x32_bf16 v[206:209], a[136:139], v[44:47], v[206:209]
  v_lshlrev_b32 v210, 16, v180
  v_and_b32 v211, 0xffff0000, v180
  s_waitcnt vmcnt(17)
  v_mfma_f32_16x16x32_bf16 v[194:197], a[140:143], v[48:51], v[194:197]
  buffer_load_dwordx4 a[100:103], v162, s[16:19], s72 offen offset:1024 sc1
  v_mfma_f32_16x16x32_bf16 v[198:201], a[144:147], v[48:51], v[198:201]
  v_lshlrev_b32 v212, 16, v181
  v_and_b32 v213, 0xffff0000, v181
  v_mfma_f32_16x16x32_bf16 v[202:205], a[148:151], v[48:51], v[202:205]
  v_add_f32 v210, v210, v172
  v_mfma_f32_16x16x32_bf16 v[206:209], a[152:155], v[48:51], v[206:209]
  buffer_load_dwordx4 a[104:107], v162, s[16:19], s73 offen offset:1024 sc1
  s_waitcnt vmcnt(18)
  v_mfma_f32_16x16x32_bf16 v[194:197], a[156:159], v[12:15], v[194:197]
  v_add_u32 v162, 122880, v162
  v_add_f32 v211, v211, v173
  v_mfma_f32_16x16x32_bf16 v[198:201], a[160:163], v[12:15], v[198:201]
  v_add_f32 v212, v212, v174
  v_add_f32 v213, v213, v175
  v_mfma_f32_16x16x32_bf16 v[202:205], a[164:167], v[12:15], v[202:205]
  v_lshlrev_b32 v226, 16, v182
  v_mfma_f32_16x16x32_bf16 v[206:209], a[168:171], v[12:15], v[206:209]
  v_and_b32 v227, 0xffff0000, v182
  s_waitcnt vmcnt(17)
  v_mfma_f32_16x16x32_bf16 v[194:197], a[172:175], v[16:19], v[194:197]
  v_lshlrev_b32 v228, 16, v183
  v_mfma_f32_16x16x32_bf16 v[198:201], a[176:179], v[16:19], v[198:201]
  v_and_b32 v229, 0xffff0000, v183
  v_mfma_f32_16x16x32_bf16 v[202:205], a[180:183], v[16:19], v[202:205]
  v_add_f32 v226, v226, v172
  v_mfma_f32_16x16x32_bf16 v[206:209], a[184:187], v[16:19], v[206:209]
  v_add_f32 v227, v227, v173
  s_waitcnt vmcnt(16)
  v_mfma_f32_16x16x32_bf16 v[194:197], a[192:195], v[32:35], v[194:197]
  s_waitcnt vmcnt(14)
  v_accvgpr_read_b32 v1, a48
  v_add_f32 v228, v228, v174
  v_mfma_f32_16x16x32_bf16 v[198:201], a[196:199], v[32:35], v[198:201]
  v_accvgpr_read_b32 v3, a50
  v_max_u32 v168, v1, v3
  v_mfma_f32_16x16x32_bf16 v[202:205], a[200:203], v[32:35], v[202:205]
  s_waitcnt vmcnt(13)
  v_accvgpr_read_b32 v1, a52
  v_accvgpr_read_b32 v3, a54
  v_mfma_f32_16x16x32_bf16 v[206:209], a[204:207], v[32:35], v[206:209]
  v_max3_u32 v168, v1, v3, v168
  s_waitcnt vmcnt(12)
  v_accvgpr_read_b32 v1, a56
  v_mfma_f32_16x16x32_bf16 v[194:197], a[208:211], v[36:39], v[194:197]
  v_accvgpr_read_b32 v3, a58
  v_max3_u32 v168, v1, v3, v168
  v_mfma_f32_16x16x32_bf16 v[198:201], a[212:215], v[36:39], v[198:201]
  s_waitcnt vmcnt(11)
  v_accvgpr_read_b32 v1, a60
  v_accvgpr_read_b32 v3, a62
  v_mfma_f32_16x16x32_bf16 v[202:205], a[216:219], v[36:39], v[202:205]
  v_max3_u32 v168, v1, v3, v168
  v_add_f32 v229, v229, v175
  v_mfma_f32_16x16x32_bf16 v[206:209], a[220:223], v[36:39], v[206:209]
  v_cmp_eq_u32 vcc, -1, v168
  s_cbranch_vccnz L_h2g0f
L_h2g0fok:
  v_mfma_f32_16x16x32_bf16 v[210:213], v[80:83], a[48:51], v[210:213]
  v_mfma_f32_16x16x32_bf16 v[214:217], v[84:87], a[48:51], 0
  v_mfma_f32_16x16x32_bf16 v[218:221], v[88:91], a[48:51], 0
  v_mfma_f32_16x16x32_bf16 v[222:225], v[92:95], a[48:51], 0
  v_mfma_f32_16x16x32_bf16 v[210:213], v[96:99], a[52:55], v[210:213]
  v_mfma_f32_16x16x32_bf16 v[214:217], v[100:103], a[52:55], v[214:217]
  v_mfma_f32_16x16x32_bf16 v[218:221], v[104:107], a[52:55], v[218:221]
  v_mfma_f32_16x16x32_bf16 v[222:225], v[108:111], a[52:55], v[222:225]
  v_mfma_f32_16x16x32_bf16 v[210:213], v[112:115], a[56:59], v[210:213]
  s_waitcnt vmcnt(10)
  v_accvgpr_read_b32 v1, a64
  v_mfma_f32_16x16x32_bf16 v[214:217], v[116:119], a[56:59], v[214:217]
  buffer_load_dwordx4 v[64:67], v162, s[16:19], 0 offen offset:0 sc1
  v_accvgpr_read_b32 v3, a66
  v_max_u32 v168, v1, v3
  v_mfma_f32_16x16x32_bf16 v[218:221], v[120:123], a[56:59], v[218:221]
  s_waitcnt vmcnt(10)
  v_accvgpr_read_b32 v1, a68
  v_accvgpr_read_b32 v3, a70
  v_mfma_f32_16x16x32_bf16 v[222:225], v[124:127], a[56:59], v[222:225]
  buffer_load_dwordx4 v[68:71], v162, s[16:19], s59 offen offset:1024 sc1
  v_max3_u32 v168, v1, v3, v168
  s_waitcnt vmcnt(10)
  v_accvgpr_read_b32 v1, a72
  v_mfma_f32_16x16x32_bf16 v[210:213], a[240:243], a[60:63], v[210:213]
  v_accvgpr_read_b32 v3, a74
  v_max3_u32 v168, v1, v3, v168
  v_mfma_f32_16x16x32_bf16 v[214:217], a[244:247], a[60:63], v[214:217]
  s_waitcnt vmcnt(9)
  v_accvgpr_read_b32 v1, a76
  v_accvgpr_read_b32 v3, a78
  v_mfma_f32_16x16x32_bf16 v[218:221], a[248:251], a[60:63], v[218:221]
  buffer_load_dwordx4 v[72:75], v162, s[16:19], s60 offen offset:1024 sc1
  v_max3_u32 v168, v1, v3, v168
  v_mfma_f32_16x16x32_bf16 v[222:225], a[252:255], a[60:63], v[222:225]
  v_cmp_eq_u32 vcc, -1, v168
  s_cbranch_vccnz L_h2g1f
L_h2g1fok:
  v_mfma_f32_16x16x32_bf16 v[210:213], a[224:227], a[64:67], v[210:213]
  buffer_load_dwordx4 v[128:131], v162, s[16:19], s61 offen offset:1024 sc1
  v_mfma_f32_16x16x32_bf16 v[214:217], a[228:231], a[64:67], v[214:217]
  ds_write_b128 v141, v[198:201] offset:16384
  v_mfma_f32_16x16x32_bf16 v[218:221], a[232:235], a[64:67], v[218:221]
  buffer_load_dwordx4 v[136:139], v162, s[16:19], s62 offen offset:1024 sc1
  v_mfma_f32_16x16x32_bf16 v[222:225], a[236:239], a[64:67], v[222:225]
  ds_write_b128 v141, v[202:205] offset:17408
  v_mfma_f32_16x16x32_bf16 v[210:213], a[0:3], a[68:71], v[210:213]
  buffer_load_dwordx4 v[20:23], v162, s[16:19], s63 offen offset:1024 sc1
  v_mfma_f32_16x16x32_bf16 v[214:217], a[4:7], a[68:71], v[214:217]
  ds_write_b128 v141, v[206:209] offset:18432
  v_mfma_f32_16x16x32_bf16 v[218:221], a[8:11], a[68:71], v[218:221]
  v_mfma_f32_16x16x32_bf16 v[222:225], a[12:15], a[68:71], v[222:225]
  buffer_load_dwordx4 v[40:43], v162, s[16:19], s64 offen offset:1024 sc1
  v_mfma_f32_16x16x32_bf16 v[210:213], a[16:19], a[72:75], v[210:213]
  s_waitcnt vmcnt(13)
  v_accvgpr_read_b32 v1, a80
  v_mfma_f32_16x16x32_bf16 v[214:217], a[20:23], a[72:75], v[214:217]
  v_accvgpr_read_b32 v3, a82
  v_max_u32 v168, v1, v3
  v_mfma_f32_16x16x32_bf16 v[218:221], a[24:27], a[72:75], v[218:221]
  buffer_load_dwordx4 v[60:63], v162, s[16:19], s65 offen offset:1024 sc1
  s_waitcnt vmcnt(13)
  v_accvgpr_read_b32 v1, a84
  v_accvgpr_read_b32 v3, a86
  v_mfma_f32_16x16x32_bf16 v[222:225], a[28:31], a[72:75], v[222:225]
  v_max3_u32 v168, v1, v3, v168
  s_waitcnt vmcnt(12)
  v_accvgpr_read_b32 v1, a88
  v_mfma_f32_16x16x32_bf16 v[210:213], a[32:35], a[76:79], v[210:213]
  v_accvgpr_read_b32 v3, a90
  v_max3_u32 v168, v1, v3, v168
  v_mfma_f32_16x16x32_bf16 v[214:217], a[36:39], a[76:79], v[214:217]
  buffer_load_dwordx4 v[132:135], v162, s[16:19], s66 offen offset:1024 sc1
  s_waitcnt vmcnt(12)
  v_accvgpr_read_b32 v1, a92
  v_accvgpr_read_b32 v3, a94
  v_mfma_f32_16x16x32_bf16 v[218:221], a[40:43], a[76:79], v[218:221]
  v_max3_u32 v168, v1, v3, v168
  v_mfma_f32_16x16x32_bf16 v[222:225], a[44:47], a[76:79], v[222:225]
  buffer_load_dwordx4 v[44:47], v162, s[16:19], s67 offen offset:1024 sc1
  v_cmp_eq_u32 vcc, -1, v168
  s_cbranch_vccnz L_h2g2f
L_h2g2fok:
  v_mfma_f32_16x16x32_bf16 v[210:213], a[108:111], a[80:83], v[210:213]
  v_mfma_f32_16x16x32_bf16 v[214:217], a[112:115], a[80:83], v[214:217]
  buffer_load_dwordx4 v[48:51], v162, s[16:19], s68 offen offset:1024 sc1
  v_mfma_f32_16x16x32_bf16 v[218:221], a[116:119], a[80:83], v[218:221]
  v_mfma_f32_16x16x32_bf16 v[222:225], a[120:123], a[80:83], v[222:225]
  buffer_load_dwordx4 v[12:15], v162, s[16:19], s70 offen offset:1024 sc1
  v_mfma_f32_16x16x32_bf16 v[210:213], a[124:127], a[84:87], v[210:213]
  v_mfma_f32_16x16x32_bf16 v[214:217], a[128:131], a[84:87], v[214:217]
  v_mfma_f32_16x16x32_bf16 v[218:221], a[132:135], a[84:87], v[218:221]
  buffer_load_dwordx4 v[16:19], v162, s[16:19], s71 offen offset:1024 sc1
  v_mfma_f32_16x16x32_bf16 v[222:225], a[136:139], a[84:87], v[222:225]
  v_mfma_f32_16x16x32_bf16 v[210:213], a[140:143], a[88:91], v[210:213]
  buffer_load_dwordx4 v[32:35], v162, s[16:19], s72 offen offset:1024 sc1
  v_mfma_f32_16x16x32_bf16 v[214:217], a[144:147], a[88:91], v[214:217]
  v_mfma_f32_16x16x32_bf16 v[218:221], a[148:151], a[88:91], v[218:221]
  s_waitcnt vmcnt(16)
  v_accvgpr_read_b32 v1, a96
  v_accvgpr_read_b32 v3, a98
  v_mfma_f32_16x16x32_bf16 v[222:225], a[152:155], a[88:91], v[222:225]
  v_max_u32 v168, v1, v3
  s_waitcnt vmcnt(15)
  v_accvgpr_read_b32 v1, a100
  v_mfma_f32_16x16x32_bf16 v[210:213], a[156:159], a[92:95], v[210:213]
  buffer_load_dwordx4 v[36:39], v162, s[16:19], s73 offen offset:1024 sc1
  v_accvgpr_read_b32 v3, a102
  v_max3_u32 v168, v1, v3, v168
  v_mfma_f32_16x16x32_bf16 v[214:217], a[160:163], a[92:95], v[214:217]
  s_waitcnt vmcnt(15)
  v_accvgpr_read_b32 v1, a104
  v_accvgpr_read_b32 v3, a106
  v_mfma_f32_16x16x32_bf16 v[218:221], a[164:167], a[92:95], v[218:221]
  v_max3_u32 v168, v1, v3, v168
  v_mfma_f32_16x16x32_bf16 v[222:225], a[168:171], a[92:95], v[222:225]
  v_cmp_eq_u32 vcc, -1, v168
  s_cbranch_vccnz L_h2g3f
L_h2g3fok:
  v_mfma_f32_16x16x32_bf16 v[210:213], a[172:175], a[96:99], v[210:213]
  v_mfma_f32_16x16x32_bf16 v[214:217], a[176:179], a[96:99], v[214:217]
  v_mfma_f32_16x16x32_bf16 v[218:221], a[180:183], a[96:99], v[218:221]
  v_mfma_f32_16x16x32_bf16 v[222:225], a[184:187], a[96:99], v[222:225]
  v_mfma_f32_16x16x32_bf16 v[210:213], a[192:195], a[100:103], v[210:213]
  v_mfma_f32_16x16x32_bf16 v[214:217], a[196:199], a[100:103], v[214:217]
  v_mfma_f32_16x16x32_bf16 v[218:221], a[200:203], a[100:103], v[218:221]
  v_mfma_f32_16x16x32_bf16 v[222:225], a[204:207], a[100:103], v[222:225]
  v_mfma_f32_16x16x32_bf16 v[210:213], a[208:211], a[104:107], v[210:213]
  s_waitcnt vmcnt(14)
  v_max_u32 v168, v64, v66
  v_mfma_f32_16x16x32_bf16 v[214:217], a[212:215], a[104:107], v[214:217]
  s_waitcnt vmcnt(13)
  v_max3_u32 v168, v68, v70, v168
  s_waitcnt vmcnt(12)
  v_max3_u32 v168, v72, v74, v168
  v_mfma_f32_16x16x32_bf16 v[218:221], a[216:219], a[104:107], v[218:221]
  s_waitcnt vmcnt(11)
  v_max3_u32 v168, v128, v130, v168
  v_mfma_f32_16x16x32_bf16 v[222:225], a[220:223], a[104:107], v[222:225]
  v_cmp_eq_u32 vcc, -1, v168
  s_cbranch_vccnz L_h3g0f
L_h3g0fok:
  v_mfma_f32_16x16x32_bf16 v[226:229], v[80:83], v[64:67], v[226:229]
  v_mfma_f32_16x16x32_bf16 v[230:233], v[84:87], v[64:67], 0
  v_mfma_f32_16x16x32_bf16 v[234:237], v[88:91], v[64:67], 0
  ds_write_b128 v141, v[214:217] offset:32768
  v_mfma_f32_16x16x32_bf16 v[238:241], v[92:95], v[64:67], 0
  ds_write_b128 v141, v[218:221] offset:33792
  v_mfma_f32_16x16x32_bf16 v[226:229], v[96:99], v[68:71], v[226:229]
  v_mfma_f32_16x16x32_bf16 v[230:233], v[100:103], v[68:71], v[230:233]
  v_mfma_f32_16x16x32_bf16 v[234:237], v[104:107], v[68:71], v[234:237]
  ds_write_b128 v141, v[222:225] offset:34816
  v_mfma_f32_16x16x32_bf16 v[238:241], v[108:111], v[68:71], v[238:241]
  v_mfma_f32_16x16x32_bf16 v[226:229], v[112:115], v[72:75], v[226:229]
  v_mfma_f32_16x16x32_bf16 v[230:233], v[116:119], v[72:75], v[230:233]
  v_mfma_f32_16x16x32_bf16 v[234:237], v[120:123], v[72:75], v[234:237]
  s_waitcnt lgkmcnt(0)
  s_barrier
  v_mfma_f32_16x16x32_bf16 v[238:241], v[124:127], v[72:75], v[238:241]
  ds_read_b128 v[8:11], v142 offset:0
  v_mfma_f32_16x16x32_bf16 v[226:229], a[240:243], v[128:131], v[226:229]
  ds_read_b128 v[24:27], v143 offset:0
  s_waitcnt vmcnt(10)
  v_max_u32 v168, v136, v138
  v_mfma_f32_16x16x32_bf16 v[230:233], a[244:247], v[128:131], v[230:233]
  s_waitcnt vmcnt(9)
  v_max3_u32 v168, v20, v22, v168
  s_waitcnt vmcnt(8)
  v_max3_u32 v168, v40, v42, v168
  v_mfma_f32_16x16x32_bf16 v[234:237], a[248:251], v[128:131], v[234:237]
  ds_read_b128 v[28:31], v144 offset:0
  s_waitcnt vmcnt(7)
  v_max3_u32 v168, v60, v62, v168
  v_mfma_f32_16x16x32_bf16 v[238:241], a[252:255], v[128:131], v[238:241]
  v_cmp_eq_u32 vcc, -1, v168
  s_cbranch_vccnz L_h3g1f
L_h3g1fok:
  v_mfma_f32_16x16x32_bf16 v[226:229], a[224:227], v[136:139], v[226:229]
  ds_read_b128 v[198:201], v142 offset:16384
  v_mfma_f32_16x16x32_bf16 v[230:233], a[228:231], v[136:139], v[230:233]
  ds_read_b128 v[202:205], v143 offset:16384
  v_mfma_f32_16x16x32_bf16 v[234:237], a[232:235], v[136:139], v[234:237]
  ds_read_b128 v[206:209], v144 offset:16384
  v_mfma_f32_16x16x32_bf16 v[238:241], a[236:239], v[136:139], v[238:241]
  ds_read_b128 v[214:217], v142 offset:32768
  v_mfma_f32_16x16x32_bf16 v[226:229], a[0:3], v[20:23], v[226:229]
  ds_read_b128 v[218:221], v143 offset:32768
  v_mfma_f32_16x16x32_bf16 v[230:233], a[4:7], v[20:23], v[230:233]
  ds_read_b128 v[222:225], v144 offset:32768
  s_waitcnt lgkmcnt(7)
  v_add_f32 v8, v8, v24
  v_mfma_f32_16x16x32_bf16 v[234:237], a[8:11], v[20:23], v[234:237]
  v_add_f32 v9, v9, v25
  v_add_f32 v10, v10, v26
  v_mfma_f32_16x16x32_bf16 v[238:241], a[12:15], v[20:23], v[238:241]
  v_add_f32 v11, v11, v27
  s_waitcnt lgkmcnt(6)
  v_add_f32 v4, v4, v28
  v_mfma_f32_16x16x32_bf16 v[226:229], a[16:19], v[40:43], v[226:229]
  v_add_f32 v5, v5, v29
  v_add_f32 v6, v6, v30
  v_mfma_f32_16x16x32_bf16 v[230:233], a[20:23], v[40:43], v[230:233]
  v_add_f32 v7, v7, v31
  v_add_f32 v4, v4, v8
  v_mfma_f32_16x16x32_bf16 v[234:237], a[24:27], v[40:43], v[234:237]
  v_add_f32 v5, v5, v9
  v_add_f32 v6, v6, v10
  v_mfma_f32_16x16x32_bf16 v[238:241], a[28:31], v[40:43], v[238:241]
  v_add_f32 v7, v7, v11
  v_cvt_pk_bf16_f32 v4, v4, v5
  v_mfma_f32_16x16x32_bf16 v[226:229], a[32:35], v[60:63], v[226:229]
  s_waitcnt vmcnt(6)
  v_max_u32 v168, v132, v134
  v_cvt_pk_bf16_f32 v5, v6, v7
  v_mfma_f32_16x16x32_bf16 v[230:233], a[36:39], v[60:63], v[230:233]
  s_waitcnt vmcnt(5)
  v_max3_u32 v168, v44, v46, v168
  s_waitcnt vmcnt(4)
  v_max3_u32 v168, v48, v50, v168
  v_mfma_f32_16x16x32_bf16 v[234:237], a[40:43], v[60:63], v[234:237]
  s_waitcnt vmcnt(3)
  v_max3_u32 v168, v12, v14, v168
  v_mfma_f32_16x16x32_bf16 v[238:241], a[44:47], v[60:63], v[238:241]
  v_cmp_eq_u32 vcc, -1, v168
  s_cbranch_vccnz L_h3g2f
L_h3g2fok:
  v_mfma_f32_16x16x32_bf16 v[226:229], a[108:111], v[132:135], v[226:229]
  s_mov_b32 s4, 0
  buffer_store_dwordx2 v[4:5], v140, s[52:55], s4 offen
  v_mfma_f32_16x16x32_bf16 v[230:233], a[112:115], v[132:135], v[230:233]
  s_waitcnt lgkmcnt(4)
  v_add_f32 v198, v198, v202
  v_add_f32 v199, v199, v203
  v_mfma_f32_16x16x32_bf16 v[234:237], a[116:119], v[132:135], v[234:237]
  v_add_f32 v200, v200, v204
  v_add_f32 v201, v201, v205
  v_mfma_f32_16x16x32_bf16 v[238:241], a[120:123], v[132:135], v[238:241]
  s_waitcnt lgkmcnt(3)
  v_add_f32 v194, v194, v206
  v_add_f32 v195, v195, v207
  v_mfma_f32_16x16x32_bf16 v[226:229], a[124:127], v[44:47], v[226:229]
  v_add_f32 v196, v196, v208
  v_add_f32 v197, v197, v209
  v_mfma_f32_16x16x32_bf16 v[230:233], a[128:131], v[44:47], v[230:233]
  v_add_f32 v194, v194, v198
  v_add_f32 v195, v195, v199
  v_mfma_f32_16x16x32_bf16 v[234:237], a[132:135], v[44:47], v[234:237]
  v_add_f32 v196, v196, v200
  v_add_f32 v197, v197, v201
  v_mfma_f32_16x16x32_bf16 v[238:241], a[136:139], v[44:47], v[238:241]
  v_cvt_pk_bf16_f32 v194, v194, v195
  v_cvt_pk_bf16_f32 v195, v196, v197
  v_mfma_f32_16x16x32_bf16 v[226:229], a[140:143], v[48:51], v[226:229]
  s_mov_b32 s4, 65536
  buffer_store_dwordx2 v[194:195], v140, s[52:55], s4 offen
  v_mfma_f32_16x16x32_bf16 v[230:233], a[144:147], v[48:51], v[230:233]
  v_mfma_f32_16x16x32_bf16 v[234:237], a[148:151], v[48:51], v[234:237]
  s_waitcnt lgkmcnt(1)
  v_add_f32 v214, v214, v218
  v_mfma_f32_16x16x32_bf16 v[238:241], a[152:155], v[48:51], v[238:241]
  v_add_f32 v215, v215, v219
  v_add_f32 v216, v216, v220
  v_mfma_f32_16x16x32_bf16 v[226:229], a[156:159], v[12:15], v[226:229]
  v_add_f32 v217, v217, v221
  v_mfma_f32_16x16x32_bf16 v[230:233], a[160:163], v[12:15], v[230:233]
  s_waitcnt vmcnt(4)
  v_max_u32 v168, v16, v18
  s_waitcnt vmcnt(3)
  v_max3_u32 v168, v32, v34, v168
  v_mfma_f32_16x16x32_bf16 v[234:237], a[164:167], v[12:15], v[234:237]
  s_waitcnt vmcnt(2)
  v_max3_u32 v168, v36, v38, v168
  s_waitcnt lgkmcnt(0)
  v_add_f32 v210, v210, v222
  v_mfma_f32_16x16x32_bf16 v[238:241], a[168:171], v[12:15], v[238:241]
  v_cmp_eq_u32 vcc, -1, v168
  s_cbranch_vccnz L_h3g3f
L_h3g3fok:
  v_mfma_f32_16x16x32_bf16 v[226:229], a[172:175], v[16:19], v[226:229]
  v_add_f32 v211, v211, v223
  v_add_f32 v212, v212, v224
  v_mfma_f32_16x16x32_bf16 v[230:233], a[176:179], v[16:19], v[230:233]
  v_add_f32 v213, v213, v225
  v_add_f32 v210, v210, v214
  v_mfma_f32_16x16x32_bf16 v[234:237], a[180:183], v[16:19], v[234:237]
  v_add_f32 v211, v211, v215
  v_add_f32 v212, v212, v216
  v_mfma_f32_16x16x32_bf16 v[238:241], a[184:187], v[16:19], v[238:241]
  v_add_f32 v213, v213, v217
  v_cvt_pk_bf16_f32 v210, v210, v211
  v_mfma_f32_16x16x32_bf16 v[226:229], a[192:195], v[32:35], v[226:229]
  v_cvt_pk_bf16_f32 v211, v212, v213
  v_mfma_f32_16x16x32_bf16 v[230:233], a[196:199], v[32:35], v[230:233]
  s_mov_b32 s4, 131072
  buffer_store_dwordx2 v[210:211], v140, s[52:55], s4 offen
  v_mfma_f32_16x16x32_bf16 v[234:237], a[200:203], v[32:35], v[234:237]
  v_mfma_f32_16x16x32_bf16 v[238:241], a[204:207], v[32:35], v[238:241]
  v_mfma_f32_16x16x32_bf16 v[226:229], a[208:211], v[36:39], v[226:229]
  v_mfma_f32_16x16x32_bf16 v[230:233], a[212:215], v[36:39], v[230:233]
  v_mfma_f32_16x16x32_bf16 v[234:237], a[216:219], v[36:39], v[234:237]
  v_mfma_f32_16x16x32_bf16 v[238:241], a[220:223], v[36:39], v[238:241]
  s_nop 5
  ds_write_b128 v141, v[230:233] offset:49152
  ds_write_b128 v141, v[234:237] offset:50176
  ds_write_b128 v141, v[238:241] offset:51200
  s_waitcnt lgkmcnt(0)
  s_barrier
  ds_read_b128 v[230:233], v142 offset:49152
  ds_read_b128 v[234:237], v143 offset:49152
  ds_read_b128 v[238:241], v144 offset:49152
  s_waitcnt lgkmcnt(1)
  v_pk_add_f32 v[230:231], v[230:231], v[234:235]
  v_pk_add_f32 v[232:233], v[232:233], v[236:237]
  s_waitcnt lgkmcnt(0)
  v_pk_add_f32 v[226:227], v[226:227], v[238:239]
  v_pk_add_f32 v[228:229], v[228:229], v[240:241]
  v_pk_add_f32 v[226:227], v[226:227], v[230:231]
  v_pk_add_f32 v[228:229], v[228:229], v[232:233]
  v_cvt_pk_bf16_f32 v226, v226, v227
  v_cvt_pk_bf16_f32 v227, v228, v229
  s_mov_b32 s4, 196608
  buffer_store_dwordx2 v[226:227], v140, s[52:55], s4 offen
  s_endpgm

L_epf:
  s_sub_u32 s81, s81, 1
  s_cselect_b32 s81, 0, s81
  s_cbranch_scc1 L_epfok
  buffer_load_dword v167, v166, s[84:87], 0 offen offset:0 sc1
  s_waitcnt vmcnt(0)
  v_readlane_b32 s24, v167, s27
  v_readlane_b32 s25, v167, s5
  s_nop 1
  s_min_u32 s4, s24, s25
  s_cmp_eq_u32 s4, 0
  s_cbranch_scc1 L_epf
  s_branch L_epfok

L_h2g0f:
  s_sub_u32 s81, s81, 1
  s_cselect_b32 s81, 0, s81
  s_cbranch_scc1 L_h2g0fok
  v_subrev_u32 v167, 122880, v162
  s_waitcnt vmcnt(0)
  v_accvgpr_read_b32 v1, a48
  v_accvgpr_read_b32 v3, a50
  v_max_u32 v168, v1, v3
  v_cmp_eq_u32 vcc, -1, v168
  s_cbranch_vccz L_h2g0fs0
  buffer_load_dwordx4 a[48:51], v167, s[16:19], 0 offen offset:0 sc1
L_h2g0fs0:
  v_accvgpr_read_b32 v1, a52
  v_accvgpr_read_b32 v3, a54
  v_max_u32 v168, v1, v3
  v_cmp_eq_u32 vcc, -1, v168
  s_cbranch_vccz L_h2g0fs1
  buffer_load_dwordx4 a[52:55], v167, s[16:19], s59 offen offset:1024 sc1
L_h2g0fs1:
  v_accvgpr_read_b32 v1, a56
  v_accvgpr_read_b32 v3, a58
  v_max_u32 v168, v1, v3
  v_cmp_eq_u32 vcc, -1, v168
  s_cbranch_vccz L_h2g0fs2
  buffer_load_dwordx4 a[56:59], v167, s[16:19], s60 offen offset:1024 sc1
L_h2g0fs2:
  v_accvgpr_read_b32 v1, a60
  v_accvgpr_read_b32 v3, a62
  v_max_u32 v168, v1, v3
  v_cmp_eq_u32 vcc, -1, v168
  s_cbranch_vccz L_h2g0fs3
  buffer_load_dwordx4 a[60:63], v167, s[16:19], s61 offen offset:1024 sc1
L_h2g0fs3:
  v_accvgpr_read_b32 v1, a64
  v_accvgpr_read_b32 v3, a66
  v_max_u32 v168, v1, v3
  v_cmp_eq_u32 vcc, -1, v168
  s_cbranch_vccz L_h2g0fs4
  buffer_load_dwordx4 a[64:67], v167, s[16:19], s62 offen offset:1024 sc1
L_h2g0fs4:
  v_accvgpr_read_b32 v1, a68
  v_accvgpr_read_b32 v3, a70
  v_max_u32 v168, v1, v3
  v_cmp_eq_u32 vcc, -1, v168
  s_cbranch_vccz L_h2g0fs5
  buffer_load_dwordx4 a[68:71], v167, s[16:19], s63 offen offset:1024 sc1
L_h2g0fs5:
  v_accvgpr_read_b32 v1, a72
  v_accvgpr_read_b32 v3, a74
  v_max_u32 v168, v1, v3
  v_cmp_eq_u32 vcc, -1, v168
  s_cbranch_vccz L_h2g0fs6
  buffer_load_dwordx4 a[72:75], v167, s[16:19], s64 offen offset:1024 sc1
L_h2g0fs6:
  v_accvgpr_read_b32 v1, a76
  v_accvgpr_read_b32 v3, a78
  v_max_u32 v168, v1, v3
  v_cmp_eq_u32 vcc, -1, v168
  s_cbranch_vccz L_h2g0fs7
  buffer_load_dwordx4 a[76:79], v167, s[16:19], s65 offen offset:1024 sc1
L_h2g0fs7:
  v_accvgpr_read_b32 v1, a80
  v_accvgpr_read_b32 v3, a82
  v_max_u32 v168, v1, v3
  v_cmp_eq_u32 vcc, -1, v168
  s_cbranch_vccz L_h2g0fs8
  buffer_load_dwordx4 a[80:83], v167, s[16:19], s66 offen offset:1024 sc1
L_h2g0fs8:
  v_accvgpr_read_b32 v1, a84
  v_accvgpr_read_b32 v3, a86
  v_max_u32 v168, v1, v3
  v_cmp_eq_u32 vcc, -1, v168
  s_cbranch_vccz L_h2g0fs9
  buffer_load_dwordx4 a[84:87], v167, s[16:19], s67 offen offset:1024 sc1
L_h2g0fs9:
  v_accvgpr_read_b32 v1, a88
  v_accvgpr_read_b32 v3, a90
  v_max_u32 v168, v1, v3
  v_cmp_eq_u32 vcc, -1, v168
  s_cbranch_vccz L_h2g0fs10
  buffer_load_dwordx4 a[88:91], v167, s[16:19], s68 offen offset:1024 sc1
L_h2g0fs10:
  v_accvgpr_read_b32 v1, a92
  v_accvgpr_read_b32 v3, a94
  v_max_u32 v168, v1, v3
  v_cmp_eq_u32 vcc, -1, v168
  s_cbranch_vccz L_h2g0fs11
  buffer_load_dwordx4 a[92:95], v167, s[16:19], s70 offen offset:1024 sc1
L_h2g0fs11:
  v_accvgpr_read_b32 v1, a96
  v_accvgpr_read_b32 v3, a98
  v_max_u32 v168, v1, v3
  v_cmp_eq_u32 vcc, -1, v168
  s_cbranch_vccz L_h2g0fs12
  buffer_load_dwordx4 a[96:99], v167, s[16:19], s71 offen offset:1024 sc1
L_h2g0fs12:
  v_accvgpr_read_b32 v1, a100
  v_accvgpr_read_b32 v3, a102
  v_max_u32 v168, v1, v3
  v_cmp_eq_u32 vcc, -1, v168
  s_cbranch_vccz L_h2g0fs13
  buffer_load_dwordx4 a[100:103], v167, s[16:19], s72 offen offset:1024 sc1
L_h2g0fs13:
  v_accvgpr_read_b32 v1, a104
  v_accvgpr_read_b32 v3, a106
  v_max_u32 v168, v1, v3
  v_cmp_eq_u32 vcc, -1, v168
  s_cbranch_vccz L_h2g0fs14
  buffer_load_dwordx4 a[104:107], v167, s[16:19], s73 offen offset:1024 sc1
L_h2g0fs14:
  s_waitcnt vmcnt(0)
  v_accvgpr_read_b32 v1, a48
  v_accvgpr_read_b32 v3, a50
  v_max_u32 v168, v1, v3
  v_accvgpr_read_b32 v1, a52
  v_accvgpr_read_b32 v3, a54
  v_max3_u32 v168, v1, v3, v168
  v_accvgpr_read_b32 v1, a56
  v_accvgpr_read_b32 v3, a58
  v_max3_u32 v168, v1, v3, v168
  v_accvgpr_read_b32 v1, a60
  v_accvgpr_read_b32 v3, a62
  v_max3_u32 v168, v1, v3, v168
  v_cmp_eq_u32 vcc, -1, v168
  s_cbranch_vccnz L_h2g0f
  s_branch L_h2g0fok

L_h2g1f:
  s_sub_u32 s81, s81, 1
  s_cselect_b32 s81, 0, s81
  s_cbranch_scc1 L_h2g1fok
  v_subrev_u32 v167, 122880, v162
  s_waitcnt vmcnt(0)
  v_accvgpr_read_b32 v1, a64
  v_accvgpr_read_b32 v3, a66
  v_max_u32 v168, v1, v3
  v_cmp_eq_u32 vcc, -1, v168
  s_cbranch_vccz L_h2g1fs4
  buffer_load_dwordx4 a[64:67], v167, s[16:19], s62 offen offset:1024 sc1
L_h2g1fs4:
  v_accvgpr_read_b32 v1, a68
  v_accvgpr_read_b32 v3, a70
  v_max_u32 v168, v1, v3
  v_cmp_eq_u32 vcc, -1, v168
  s_cbranch_vccz L_h2g1fs5
  buffer_load_dwordx4 a[68:71], v167, s[16:19], s63 offen offset:1024 sc1
L_h2g1fs5:
  v_accvgpr_read_b32 v1, a72
  v_accvgpr_read_b32 v3, a74
  v_max_u32 v168, v1, v3
  v_cmp_eq_u32 vcc, -1, v168
  s_cbranch_vccz L_h2g1fs6
  buffer_load_dwordx4 a[72:75], v167, s[16:19], s64 offen offset:1024 sc1
L_h2g1fs6:
  v_accvgpr_read_b32 v1, a76
  v_accvgpr_read_b32 v3, a78
  v_max_u32 v168, v1, v3
  v_cmp_eq_u32 vcc, -1, v168
  s_cbranch_vccz L_h2g1fs7
  buffer_load_dwordx4 a[76:79], v167, s[16:19], s65 offen offset:1024 sc1
L_h2g1fs7:
  v_accvgpr_read_b32 v1, a80
  v_accvgpr_read_b32 v3, a82
  v_max_u32 v168, v1, v3
  v_cmp_eq_u32 vcc, -1, v168
  s_cbranch_vccz L_h2g1fs8
  buffer_load_dwordx4 a[80:83], v167, s[16:19], s66 offen offset:1024 sc1
L_h2g1fs8:
  v_accvgpr_read_b32 v1, a84
  v_accvgpr_read_b32 v3, a86
  v_max_u32 v168, v1, v3
  v_cmp_eq_u32 vcc, -1, v168
  s_cbranch_vccz L_h2g1fs9
  buffer_load_dwordx4 a[84:87], v167, s[16:19], s67 offen offset:1024 sc1
L_h2g1fs9:
  v_accvgpr_read_b32 v1, a88
  v_accvgpr_read_b32 v3, a90
  v_max_u32 v168, v1, v3
  v_cmp_eq_u32 vcc, -1, v168
  s_cbranch_vccz L_h2g1fs10
  buffer_load_dwordx4 a[88:91], v167, s[16:19], s68 offen offset:1024 sc1
L_h2g1fs10:
  v_accvgpr_read_b32 v1, a92
  v_accvgpr_read_b32 v3, a94
  v_max_u32 v168, v1, v3
  v_cmp_eq_u32 vcc, -1, v168
  s_cbranch_vccz L_h2g1fs11
  buffer_load_dwordx4 a[92:95], v167, s[16:19], s70 offen offset:1024 sc1
L_h2g1fs11:
  v_accvgpr_read_b32 v1, a96
  v_accvgpr_read_b32 v3, a98
  v_max_u32 v168, v1, v3
  v_cmp_eq_u32 vcc, -1, v168
  s_cbranch_vccz L_h2g1fs12
  buffer_load_dwordx4 a[96:99], v167, s[16:19], s71 offen offset:1024 sc1
L_h2g1fs12:
  v_accvgpr_read_b32 v1, a100
  v_accvgpr_read_b32 v3, a102
  v_max_u32 v168, v1, v3
  v_cmp_eq_u32 vcc, -1, v168
  s_cbranch_vccz L_h2g1fs13
  buffer_load_dwordx4 a[100:103], v167, s[16:19], s72 offen offset:1024 sc1
L_h2g1fs13:
  v_accvgpr_read_b32 v1, a104
  v_accvgpr_read_b32 v3, a106
  v_max_u32 v168, v1, v3
  v_cmp_eq_u32 vcc, -1, v168
  s_cbranch_vccz L_h2g1fs14
  buffer_load_dwordx4 a[104:107], v167, s[16:19], s73 offen offset:1024 sc1
L_h2g1fs14:
  s_waitcnt vmcnt(0)
  v_accvgpr_read_b32 v1, a64
  v_accvgpr_read_b32 v3, a66
  v_max_u32 v168, v1, v3
  v_accvgpr_read_b32 v1, a68
  v_accvgpr_read_b32 v3, a70
  v_max3_u32 v168, v1, v3, v168
  v_accvgpr_read_b32 v1, a72
  v_accvgpr_read_b32 v3, a74
  v_max3_u32 v168, v1, v3, v168
  v_accvgpr_read_b32 v1, a76
  v_accvgpr_read_b32 v3, a78
  v_max3_u32 v168, v1, v3, v168
  v_cmp_eq_u32 vcc, -1, v168
  s_cbranch_vccnz L_h2g1f
  s_branch L_h2g1fok

L_h2g2f:
  s_sub_u32 s81, s81, 1
  s_cselect_b32 s81, 0, s81
  s_cbranch_scc1 L_h2g2fok
  v_subrev_u32 v167, 122880, v162
  s_waitcnt vmcnt(0)
  v_accvgpr_read_b32 v1, a80
  v_accvgpr_read_b32 v3, a82
  v_max_u32 v168, v1, v3
  v_cmp_eq_u32 vcc, -1, v168
  s_cbranch_vccz L_h2g2fs8
  buffer_load_dwordx4 a[80:83], v167, s[16:19], s66 offen offset:1024 sc1
L_h2g2fs8:
  v_accvgpr_read_b32 v1, a84
  v_accvgpr_read_b32 v3, a86
  v_max_u32 v168, v1, v3
  v_cmp_eq_u32 vcc, -1, v168
  s_cbranch_vccz L_h2g2fs9
  buffer_load_dwordx4 a[84:87], v167, s[16:19], s67 offen offset:1024 sc1
L_h2g2fs9:
  v_accvgpr_read_b32 v1, a88
  v_accvgpr_read_b32 v3, a90
  v_max_u32 v168, v1, v3
  v_cmp_eq_u32 vcc, -1, v168
  s_cbranch_vccz L_h2g2fs10
  buffer_load_dwordx4 a[88:91], v167, s[16:19], s68 offen offset:1024 sc1
L_h2g2fs10:
  v_accvgpr_read_b32 v1, a92
  v_accvgpr_read_b32 v3, a94
  v_max_u32 v168, v1, v3
  v_cmp_eq_u32 vcc, -1, v168
  s_cbranch_vccz L_h2g2fs11
  buffer_load_dwordx4 a[92:95], v167, s[16:19], s70 offen offset:1024 sc1
L_h2g2fs11:
  v_accvgpr_read_b32 v1, a96
  v_accvgpr_read_b32 v3, a98
  v_max_u32 v168, v1, v3
  v_cmp_eq_u32 vcc, -1, v168
  s_cbranch_vccz L_h2g2fs12
  buffer_load_dwordx4 a[96:99], v167, s[16:19], s71 offen offset:1024 sc1
L_h2g2fs12:
  v_accvgpr_read_b32 v1, a100
  v_accvgpr_read_b32 v3, a102
  v_max_u32 v168, v1, v3
  v_cmp_eq_u32 vcc, -1, v168
  s_cbranch_vccz L_h2g2fs13
  buffer_load_dwordx4 a[100:103], v167, s[16:19], s72 offen offset:1024 sc1
L_h2g2fs13:
  v_accvgpr_read_b32 v1, a104
  v_accvgpr_read_b32 v3, a106
  v_max_u32 v168, v1, v3
  v_cmp_eq_u32 vcc, -1, v168
  s_cbranch_vccz L_h2g2fs14
  buffer_load_dwordx4 a[104:107], v167, s[16:19], s73 offen offset:1024 sc1
L_h2g2fs14:
  s_waitcnt vmcnt(0)
  v_accvgpr_read_b32 v1, a80
  v_accvgpr_read_b32 v3, a82
  v_max_u32 v168, v1, v3
  v_accvgpr_read_b32 v1, a84
  v_accvgpr_read_b32 v3, a86
  v_max3_u32 v168, v1, v3, v168
  v_accvgpr_read_b32 v1, a88
  v_accvgpr_read_b32 v3, a90
  v_max3_u32 v168, v1, v3, v168
  v_accvgpr_read_b32 v1, a92
  v_accvgpr_read_b32 v3, a94
  v_max3_u32 v168, v1, v3, v168
  v_cmp_eq_u32 vcc, -1, v168
  s_cbranch_vccnz L_h2g2f
  s_branch L_h2g2fok

L_h2g3f:
  s_sub_u32 s81, s81, 1
  s_cselect_b32 s81, 0, s81
  s_cbranch_scc1 L_h2g3fok
  v_subrev_u32 v167, 122880, v162
  s_waitcnt vmcnt(0)
  v_accvgpr_read_b32 v1, a96
  v_accvgpr_read_b32 v3, a98
  v_max_u32 v168, v1, v3
  v_cmp_eq_u32 vcc, -1, v168
  s_cbranch_vccz L_h2g3fs12
  buffer_load_dwordx4 a[96:99], v167, s[16:19], s71 offen offset:1024 sc1
L_h2g3fs12:
  v_accvgpr_read_b32 v1, a100
  v_accvgpr_read_b32 v3, a102
  v_max_u32 v168, v1, v3
  v_cmp_eq_u32 vcc, -1, v168
  s_cbranch_vccz L_h2g3fs13
  buffer_load_dwordx4 a[100:103], v167, s[16:19], s72 offen offset:1024 sc1
L_h2g3fs13:
  v_accvgpr_read_b32 v1, a104
  v_accvgpr_read_b32 v3, a106
  v_max_u32 v168, v1, v3
  v_cmp_eq_u32 vcc, -1, v168
  s_cbranch_vccz L_h2g3fs14
  buffer_load_dwordx4 a[104:107], v167, s[16:19], s73 offen offset:1024 sc1
L_h2g3fs14:
  s_waitcnt vmcnt(0)
  v_accvgpr_read_b32 v1, a96
  v_accvgpr_read_b32 v3, a98
  v_max_u32 v168, v1, v3
  v_accvgpr_read_b32 v1, a100
  v_accvgpr_read_b32 v3, a102
  v_max3_u32 v168, v1, v3, v168
  v_accvgpr_read_b32 v1, a104
  v_accvgpr_read_b32 v3, a106
  v_max3_u32 v168, v1, v3, v168
  v_cmp_eq_u32 vcc, -1, v168
  s_cbranch_vccnz L_h2g3f
  s_branch L_h2g3fok

L_h3g0f:
  s_sub_u32 s81, s81, 1
  s_cselect_b32 s81, 0, s81
  s_cbranch_scc1 L_h3g0fok
  v_subrev_u32 v167, 0, v162
  s_waitcnt vmcnt(0)
  v_max_u32 v168, v64, v66
  v_cmp_eq_u32 vcc, -1, v168
  s_cbranch_vccz L_h3g0fs0
  buffer_load_dwordx4 v[64:67], v167, s[16:19], 0 offen offset:0 sc1
L_h3g0fs0:
  v_max_u32 v168, v68, v70
  v_cmp_eq_u32 vcc, -1, v168
  s_cbranch_vccz L_h3g0fs1
  buffer_load_dwordx4 v[68:71], v167, s[16:19], s59 offen offset:1024 sc1
L_h3g0fs1:
  v_max_u32 v168, v72, v74
  v_cmp_eq_u32 vcc, -1, v168
  s_cbranch_vccz L_h3g0fs2
  buffer_load_dwordx4 v[72:75], v167, s[16:19], s60 offen offset:1024 sc1
L_h3g0fs2:
  v_max_u32 v168, v128, v130
  v_cmp_eq_u32 vcc, -1, v168
  s_cbranch_vccz L_h3g0fs3
  buffer_load_dwordx4 v[128:131], v167, s[16:19], s61 offen offset:1024 sc1
L_h3g0fs3:
  v_max_u32 v168, v136, v138
  v_cmp_eq_u32 vcc, -1, v168
  s_cbranch_vccz L_h3g0fs4
  buffer_load_dwordx4 v[136:139], v167, s[16:19], s62 offen offset:1024 sc1
L_h3g0fs4:
  v_max_u32 v168, v20, v22
  v_cmp_eq_u32 vcc, -1, v168
  s_cbranch_vccz L_h3g0fs5
  buffer_load_dwordx4 v[20:23], v167, s[16:19], s63 offen offset:1024 sc1
L_h3g0fs5:
  v_max_u32 v168, v40, v42
  v_cmp_eq_u32 vcc, -1, v168
  s_cbranch_vccz L_h3g0fs6
  buffer_load_dwordx4 v[40:43], v167, s[16:19], s64 offen offset:1024 sc1
L_h3g0fs6:
  v_max_u32 v168, v60, v62
  v_cmp_eq_u32 vcc, -1, v168
  s_cbranch_vccz L_h3g0fs7
  buffer_load_dwordx4 v[60:63], v167, s[16:19], s65 offen offset:1024 sc1
L_h3g0fs7:
  v_max_u32 v168, v132, v134
  v_cmp_eq_u32 vcc, -1, v168
  s_cbranch_vccz L_h3g0fs8
  buffer_load_dwordx4 v[132:135], v167, s[16:19], s66 offen offset:1024 sc1
L_h3g0fs8:
  v_max_u32 v168, v44, v46
  v_cmp_eq_u32 vcc, -1, v168
  s_cbranch_vccz L_h3g0fs9
  buffer_load_dwordx4 v[44:47], v167, s[16:19], s67 offen offset:1024 sc1
L_h3g0fs9:
  v_max_u32 v168, v48, v50
  v_cmp_eq_u32 vcc, -1, v168
  s_cbranch_vccz L_h3g0fs10
  buffer_load_dwordx4 v[48:51], v167, s[16:19], s68 offen offset:1024 sc1
L_h3g0fs10:
  v_max_u32 v168, v12, v14
  v_cmp_eq_u32 vcc, -1, v168
  s_cbranch_vccz L_h3g0fs11
  buffer_load_dwordx4 v[12:15], v167, s[16:19], s70 offen offset:1024 sc1
L_h3g0fs11:
  v_max_u32 v168, v16, v18
  v_cmp_eq_u32 vcc, -1, v168
  s_cbranch_vccz L_h3g0fs12
  buffer_load_dwordx4 v[16:19], v167, s[16:19], s71 offen offset:1024 sc1
L_h3g0fs12:
  v_max_u32 v168, v32, v34
  v_cmp_eq_u32 vcc, -1, v168
  s_cbranch_vccz L_h3g0fs13
  buffer_load_dwordx4 v[32:35], v167, s[16:19], s72 offen offset:1024 sc1
L_h3g0fs13:
  v_max_u32 v168, v36, v38
  v_cmp_eq_u32 vcc, -1, v168
  s_cbranch_vccz L_h3g0fs14
  buffer_load_dwordx4 v[36:39], v167, s[16:19], s73 offen offset:1024 sc1
L_h3g0fs14:
  s_waitcnt vmcnt(0)
  v_max_u32 v168, v64, v66
  v_max3_u32 v168, v68, v70, v168
  v_max3_u32 v168, v72, v74, v168
  v_max3_u32 v168, v128, v130, v168
  v_cmp_eq_u32 vcc, -1, v168
  s_cbranch_vccnz L_h3g0f
  s_branch L_h3g0fok

L_h3g1f:
  s_sub_u32 s81, s81, 1
  s_cselect_b32 s81, 0, s81
  s_cbranch_scc1 L_h3g1fok
  v_subrev_u32 v167, 0, v162
  s_waitcnt vmcnt(0)
  v_max_u32 v168, v136, v138
  v_cmp_eq_u32 vcc, -1, v168
  s_cbranch_vccz L_h3g1fs4
  buffer_load_dwordx4 v[136:139], v167, s[16:19], s62 offen offset:1024 sc1
L_h3g1fs4:
  v_max_u32 v168, v20, v22
  v_cmp_eq_u32 vcc, -1, v168
  s_cbranch_vccz L_h3g1fs5
  buffer_load_dwordx4 v[20:23], v167, s[16:19], s63 offen offset:1024 sc1
L_h3g1fs5:
  v_max_u32 v168, v40, v42
  v_cmp_eq_u32 vcc, -1, v168
  s_cbranch_vccz L_h3g1fs6
  buffer_load_dwordx4 v[40:43], v167, s[16:19], s64 offen offset:1024 sc1
L_h3g1fs6:
  v_max_u32 v168, v60, v62
  v_cmp_eq_u32 vcc, -1, v168
  s_cbranch_vccz L_h3g1fs7
  buffer_load_dwordx4 v[60:63], v167, s[16:19], s65 offen offset:1024 sc1
L_h3g1fs7:
  v_max_u32 v168, v132, v134
  v_cmp_eq_u32 vcc, -1, v168
  s_cbranch_vccz L_h3g1fs8
  buffer_load_dwordx4 v[132:135], v167, s[16:19], s66 offen offset:1024 sc1
L_h3g1fs8:
  v_max_u32 v168, v44, v46
  v_cmp_eq_u32 vcc, -1, v168
  s_cbranch_vccz L_h3g1fs9
  buffer_load_dwordx4 v[44:47], v167, s[16:19], s67 offen offset:1024 sc1
L_h3g1fs9:
  v_max_u32 v168, v48, v50
  v_cmp_eq_u32 vcc, -1, v168
  s_cbranch_vccz L_h3g1fs10
  buffer_load_dwordx4 v[48:51], v167, s[16:19], s68 offen offset:1024 sc1
L_h3g1fs10:
  v_max_u32 v168, v12, v14
  v_cmp_eq_u32 vcc, -1, v168
  s_cbranch_vccz L_h3g1fs11
  buffer_load_dwordx4 v[12:15], v167, s[16:19], s70 offen offset:1024 sc1
L_h3g1fs11:
  v_max_u32 v168, v16, v18
  v_cmp_eq_u32 vcc, -1, v168
  s_cbranch_vccz L_h3g1fs12
  buffer_load_dwordx4 v[16:19], v167, s[16:19], s71 offen offset:1024 sc1
L_h3g1fs12:
  v_max_u32 v168, v32, v34
  v_cmp_eq_u32 vcc, -1, v168
  s_cbranch_vccz L_h3g1fs13
  buffer_load_dwordx4 v[32:35], v167, s[16:19], s72 offen offset:1024 sc1
L_h3g1fs13:
  v_max_u32 v168, v36, v38
  v_cmp_eq_u32 vcc, -1, v168
  s_cbranch_vccz L_h3g1fs14
  buffer_load_dwordx4 v[36:39], v167, s[16:19], s73 offen offset:1024 sc1
L_h3g1fs14:
  s_waitcnt vmcnt(0)
  v_max_u32 v168, v136, v138
  v_max3_u32 v168, v20, v22, v168
  v_max3_u32 v168, v40, v42, v168
  v_max3_u32 v168, v60, v62, v168
  v_cmp_eq_u32 vcc, -1, v168
  s_cbranch_vccnz L_h3g1f
  s_branch L_h3g1fok

L_h3g2f:
  s_sub_u32 s81, s81, 1
  s_cselect_b32 s81, 0, s81
  s_cbranch_scc1 L_h3g2fok
  v_subrev_u32 v167, 0, v162
  s_waitcnt vmcnt(0)
  v_max_u32 v168, v132, v134
  v_cmp_eq_u32 vcc, -1, v168
  s_cbranch_vccz L_h3g2fs8
  buffer_load_dwordx4 v[132:135], v167, s[16:19], s66 offen offset:1024 sc1
L_h3g2fs8:
  v_max_u32 v168, v44, v46
  v_cmp_eq_u32 vcc, -1, v168
  s_cbranch_vccz L_h3g2fs9
  buffer_load_dwordx4 v[44:47], v167, s[16:19], s67 offen offset:1024 sc1
L_h3g2fs9:
  v_max_u32 v168, v48, v50
  v_cmp_eq_u32 vcc, -1, v168
  s_cbranch_vccz L_h3g2fs10
  buffer_load_dwordx4 v[48:51], v167, s[16:19], s68 offen offset:1024 sc1
L_h3g2fs10:
  v_max_u32 v168, v12, v14
  v_cmp_eq_u32 vcc, -1, v168
  s_cbranch_vccz L_h3g2fs11
  buffer_load_dwordx4 v[12:15], v167, s[16:19], s70 offen offset:1024 sc1
L_h3g2fs11:
  v_max_u32 v168, v16, v18
  v_cmp_eq_u32 vcc, -1, v168
  s_cbranch_vccz L_h3g2fs12
  buffer_load_dwordx4 v[16:19], v167, s[16:19], s71 offen offset:1024 sc1
L_h3g2fs12:
  v_max_u32 v168, v32, v34
  v_cmp_eq_u32 vcc, -1, v168
  s_cbranch_vccz L_h3g2fs13
  buffer_load_dwordx4 v[32:35], v167, s[16:19], s72 offen offset:1024 sc1
L_h3g2fs13:
  v_max_u32 v168, v36, v38
  v_cmp_eq_u32 vcc, -1, v168
  s_cbranch_vccz L_h3g2fs14
  buffer_load_dwordx4 v[36:39], v167, s[16:19], s73 offen offset:1024 sc1
L_h3g2fs14:
  s_waitcnt vmcnt(0)
  v_max_u32 v168, v132, v134
  v_max3_u32 v168, v44, v46, v168
  v_max3_u32 v168, v48, v50, v168
  v_max3_u32 v168, v12, v14, v168
  v_cmp_eq_u32 vcc, -1, v168
  s_cbranch_vccnz L_h3g2f
  s_branch L_h3g2fok

L_h3g3f:
  s_sub_u32 s81, s81, 1
  s_cselect_b32 s81, 0, s81
  s_cbranch_scc1 L_h3g3fok
  v_subrev_u32 v167, 0, v162
  s_waitcnt vmcnt(0)
  v_max_u32 v168, v16, v18
  v_cmp_eq_u32 vcc, -1, v168
  s_cbranch_vccz L_h3g3fs12
  buffer_load_dwordx4 v[16:19], v167, s[16:19], s71 offen offset:1024 sc1
L_h3g3fs12:
  v_max_u32 v168, v32, v34
  v_cmp_eq_u32 vcc, -1, v168
  s_cbranch_vccz L_h3g3fs13
  buffer_load_dwordx4 v[32:35], v167, s[16:19], s72 offen offset:1024 sc1
L_h3g3fs13:
  v_max_u32 v168, v36, v38
  v_cmp_eq_u32 vcc, -1, v168
  s_cbranch_vccz L_h3g3fs14
  buffer_load_dwordx4 v[36:39], v167, s[16:19], s73 offen offset:1024 sc1
L_h3g3fs14:
  s_waitcnt vmcnt(0)
  v_max_u32 v168, v16, v18
  v_max3_u32 v168, v32, v34, v168
  v_max3_u32 v168, v36, v38, v168
  v_cmp_eq_u32 vcc, -1, v168
  s_cbranch_vccnz L_h3g3f
  s_branch L_h3g3fok

L_stf:
  s_sub_u32 s81, s81, 1
  s_cselect_b32 s81, 0, s81
  s_cbranch_scc1 L_stfok
  buffer_load_dword v168, v166, s[16:19], s22 offen sc1
  s_waitcnt vmcnt(0)
  s_add_u32 s4, s24, 1
  v_subrev_u32 v1, s4, v168
  v_cmp_lt_u32 vcc, 4, v1
  s_nop 0
  s_and_b32 s4, vcc_lo, 0xffff
  s_cbranch_scc1 L_stf
  s_branch L_stfok

L_c2f:
  s_sub_u32 s81, s81, 1
  s_cselect_b32 s81, 0, s81
  s_cbranch_scc1 L_c2fok
  buffer_load_dword v168, v166, s[16:19], s21 offen sc1
  s_waitcnt vmcnt(0)
  s_add_u32 s4, s25, 2
  v_subrev_u32 v1, s4, v168
  v_cmp_lt_u32 vcc, 3, v1
  s_nop 0
  s_and_b32 s4, vcc_lo, s77
  s_cbranch_scc1 L_c2f
  s_branch L_c2fok

L_c3f:
  s_sub_u32 s81, s81, 1
  s_cselect_b32 s81, 0, s81
  s_cbranch_scc1 L_c3fok
  buffer_load_dword v168, v166, s[16:19], s21 offen sc1
  s_waitcnt vmcnt(0)
  s_add_u32 s4, s25, 3
  v_subrev_u32 v1, s4, v168
  v_cmp_lt_u32 vcc, 2, v1
  s_nop 0
  s_and_b32 s4, vcc_lo, s77
  s_cbranch_scc1 L_c3f
  s_branch L_c3fok
L_end:
  s_endpgm
.section .rodata,"a"
.p2align 6
.amdhsa_kernel parallel_sum__sliding_local_dilated__dense_activation_gelu__prompt_kernel
  .amdhsa_next_free_vgpr 512
  .amdhsa_next_free_sgpr 102
  .amdhsa_accum_offset 256
  .amdhsa_group_segment_fixed_size 0
  .amdhsa_kernarg_size 88
  .amdhsa_user_sgpr_count 2
  .amdhsa_user_sgpr_kernarg_segment_ptr 1
  .amdhsa_system_sgpr_workgroup_id_x 1
.end_amdhsa_kernel
```
